```python
import torch

def _softmax(x, axis=-1):
    return torch.softmax(x, dim=axis)

def _gelu(x):
    return torch.nn.functional.gelu(x, approximate='tanh')

def _silu(x):
    return torch.nn.functional.silu(x)

def _sigmoid(x):
    return torch.sigmoid(x)

def _layernorm(x, axis=-1, eps=1e-05):
    m = x.mean(dim=axis, keepdim=True)
    v = x.var(dim=axis, keepdim=True, unbiased=False)
    return (x - m) / torch.sqrt(v + eps)

def _scatter_add(tgt, idx, src, axis=0):
    return tgt.clone().index_add_(axis, idx, src)

def _segment_sum(src, seg, n):
    out = torch.zeros((n,) + src.shape[1:], dtype=src.dtype)
    return out.index_add_(0, seg, src)

def _pad(x, pw):
    flat = tuple((v for pair in reversed(pw) for v in pair))
    return torch.nn.functional.pad(x, flat)
kernel_name = 'gated_mix__memory_aug_recurrent_mem_tr__linear_attn_block__prompt'

def setup_inputs():

    _w = lambda a: (lambda t: t.to(torch.bfloat16) if t.is_floating_point() else t)(torch.as_tensor(a))

    def _A_setup():
        B, S, Dm = (1, 2048, 576)
        H, Dh = (32, 128)
        M, seg = (8, 32)
        seg = min(seg, S)
        S = S // seg * seg
        return {'x': _w((lambda *s: torch.randn(*s, dtype=torch.bfloat16) * 0.05)(B, S, Dm)), 'mem0': _w((lambda *s: torch.randn(*s, dtype=torch.bfloat16) * 0.8)(B, M, Dm)), 'Wq': _w((lambda *s: torch.randn(*s, dtype=torch.bfloat16) * 3.2)(Dm, H, Dh) * Dm ** (-0.5)), 'Wk': _w((lambda *s: torch.randn(*s, dtype=torch.bfloat16) * 3.2)(Dm, H, Dh) * Dm ** (-0.5)), 'Wv': _w((lambda *s: torch.randn(*s, dtype=torch.bfloat16) * 0.8)(Dm, H, Dh) * Dm ** (-0.5)), 'Wo': _w((lambda *s: torch.randn(*s, dtype=torch.bfloat16) * 0.8)(H, Dh, Dm) * (H * Dh) ** (-0.5)), 'seg_len': seg}
    _A_in = _A_setup()

    def _B_setup():
        B, S, D = (1, 2048, 576)
        return {'x': _w((lambda *s: torch.randn(*s, dtype=torch.bfloat16) * 0.05)(B, S, D)), 'wqkv': _w((lambda *s: torch.randn(*s, dtype=torch.bfloat16) * 0.8)(D, 3 * D)), 'wo': _w((lambda *s: torch.randn(*s, dtype=torch.bfloat16) * 0.2)(D, D))}
    _B_in = _B_setup()
    return {'A_x': _A_in['x'], 'A_mem0': _A_in['mem0'], 'A_Wq': _A_in['Wq'], 'A_Wk': _A_in['Wk'], 'A_Wv': _A_in['Wv'], 'A_Wo': _A_in['Wo'], 'A_seg_len': _A_in['seg_len'], 'B_x': _B_in['x'], 'B_wqkv': _B_in['wqkv'], 'B_wo': _B_in['wo'], 'gate_w': _w((lambda *s: torch.randn(*s, dtype=torch.bfloat16) * 0.05)(576) * 16.0)}

def reference(A_x, A_mem0, A_Wq, A_Wk, A_Wv, A_Wo, A_seg_len, B_x, B_wqkv, B_wo, gate_w):

    def _A_ref(x, mem0, Wq, Wk, Wv, Wo, seg_len):
        B, S, Dm = x.shape
        H, Dh = (Wq.shape[1], Wq.shape[2])
        M = mem0.shape[1]
        scale = Dh ** (-0.5)
        n_seg = S // seg_len
        L = M + seg_len
        idx = torch.arange(L)
        mask = (idx[:, None] < M) | (idx[:, None] >= idx[None, :])
        mem = mem0
        outs = []
        for s in range(n_seg):
            xs = x[:, s * seg_len:(s + 1) * seg_len, :].clone()
            h = torch.concatenate([mem, xs], axis=1)
            q = torch.einsum('btd,dhe->bhte', h, Wq)
            k = torch.einsum('btd,dhe->bhte', h, Wk)
            v = torch.einsum('btd,dhe->bhte', h, Wv)
            scores = torch.einsum('bhqe,bhke->bhqk', q, k) * scale
            scores = torch.where(mask[None, None], scores, -1000000000.0)
            p = _softmax(scores, axis=-1)
            o = torch.einsum('bhqk,bhke->bhqe', p, v)
            o = torch.einsum('bhte,hed->btd', o, Wo)
            mem = o[:, :M, :].clone()
            outs.append(o[:, M:, :])
        return torch.concatenate(outs, axis=1)

    def _B_ref(x, wqkv, wo):
        B, S, D = x.shape
        H = 32
        Dh = D // H
        qkv = (lambda x, *d: x.permute(*d))((x @ wqkv).reshape(B, S, 3, H, Dh), 2, 0, 3, 1, 4)
        q, k, v = (qkv[0], qkv[1], qkv[2])
        phi = lambda t: torch.where(t > 0, t + 1, torch.exp(t)) + 1e-06
        pq, pk = (phi(q), phi(k))
        kv = torch.einsum('bhsd,bhse->bhde', pk, v)
        z = torch.einsum('bhsd->bhd', pk)
        num = torch.einsum('bhqd,bhde->bhqe', pq, kv)
        den = torch.einsum('bhqd,bhd->bhq', pq, z)[..., None] + 1e-06
        o = num / den
        return (lambda x, *d: x.permute(*d))(o, 0, 2, 1, 3).reshape(B, S, D) @ wo
    x = A_x
    g = _sigmoid((x * gate_w).sum(-1, keepdims=True))
    a = _A_ref(x, A_mem0, A_Wq, A_Wk, A_Wv, A_Wo, A_seg_len)
    b = _B_ref(x, B_wqkv, B_wo)
    return g * a + (1 - g) * b
```

```asm
; @launch grid=(256,1,1) block=(256,1,1) lds=163840
.amdgcn_target "amdgcn-amd-amdhsa--gfx950"
.text
.globl gated_mix__memory_aug_recurrent_mem_tr__linear_attn_block__prompt_kernel
.p2align 8
.type gated_mix__memory_aug_recurrent_mem_tr__linear_attn_block__prompt_kernel,@function
gated_mix__memory_aug_recurrent_mem_tr__linear_attn_block__prompt_kernel:
    s_cmp_ge_u32 s2, 256
    s_cbranch_scc1 L_end
    s_load_dwordx16 s[64:79], s[0:1], 0
    s_load_dwordx8 s[80:87], s[0:1], 64
    s_load_dwordx4 s[88:91], s[0:1], 96
    s_getreg_b32 s3, hwreg(HW_REG_XCC_ID)
    s_and_b32 s3, s3, 7
    v_lshrrev_b32 v1, 6, v0
    v_and_b32 v0, 63, v0
    s_waitcnt lgkmcnt(0)
    s_mov_b32 s4, s88
    s_mov_b32 s5, s89
    s_mov_b32 s6, 256
    s_mov_b32 s7, 0x00020000
    v_readfirstlane_b32 s93, v1
    s_lshl_b32 s94, s3, 2
    s_add_u32 s94, s94, 128
    s_cmp_eq_u32 s3, 0
    s_cselect_b32 s94, 0, s94
    v_mov_b32 v11, 1
    v_mov_b32 v12, 0
    s_cmp_lg_u32 s93, 0
    s_cbranch_scc1 L_wtk
    s_mov_b64 exec, 1
    buffer_atomic_add v11, off, s[4:7], s94 sc0
    s_waitcnt vmcnt(0)
    ds_write_b32 v12, v11
    s_waitcnt lgkmcnt(0)
    s_mov_b64 exec, -1
L_wtk:
    s_barrier
    ds_read_b32 v11, v12
    s_waitcnt lgkmcnt(0)
    v_readfirstlane_b32 s92, v11
    s_nop 3
    s_barrier
    s_cmp_lt_u32 s92, 32
    s_cbranch_scc1 L_role_ok
    v_lshlrev_b32 v10, 2, v0
    v_add_u32 v10, 128, v10
    v_cmp_eq_u32 vcc, 0, v0
    s_nop 1
    v_cndmask_b32 v10, v10, v12, vcc
    s_mov_b32 s95, 0
L_ovf:
    buffer_load_dword v11, v10, s[4:7], 0 offen sc1
    s_waitcnt vmcnt(0)
    s_mov_b32 s94, 0
    v_readlane_b32 s8, v11, 0
    v_readlane_b32 s9, v11, 1
    v_readlane_b32 s10, v11, 2
    v_readlane_b32 s11, v11, 3
    v_readlane_b32 s12, v11, 4
    v_readlane_b32 s13, v11, 5
    v_readlane_b32 s14, v11, 6
    v_readlane_b32 s15, v11, 7
    s_add_u32 s94, s94, s8
    s_add_u32 s94, s94, s9
    s_add_u32 s94, s94, s10
    s_add_u32 s94, s94, s11
    s_add_u32 s94, s94, s12
    s_add_u32 s94, s94, s13
    s_add_u32 s94, s94, s14
    s_add_u32 s94, s94, s15
    s_add_u32 s95, s95, 1
    s_cmp_gt_u32 s95, 300000
    s_cbranch_scc1 L_end
    s_sleep 8
    s_cmp_lt_u32 s94, 256
    s_cbranch_scc1 L_ovf
    s_sub_u32 s92, s92, 32
    s_max_u32 s94, s8, 32
    s_sub_u32 s94, s94, 32
    s_cmp_gt_u32 s3, 0
    s_cselect_b32 s94, s94, 0
    s_add_u32 s92, s92, s94
    s_max_u32 s94, s9, 32
    s_sub_u32 s94, s94, 32
    s_cmp_gt_u32 s3, 1
    s_cselect_b32 s94, s94, 0
    s_add_u32 s92, s92, s94
    s_max_u32 s94, s10, 32
    s_sub_u32 s94, s94, 32
    s_cmp_gt_u32 s3, 2
    s_cselect_b32 s94, s94, 0
    s_add_u32 s92, s92, s94
    s_max_u32 s94, s11, 32
    s_sub_u32 s94, s94, 32
    s_cmp_gt_u32 s3, 3
    s_cselect_b32 s94, s94, 0
    s_add_u32 s92, s92, s94
    s_max_u32 s94, s12, 32
    s_sub_u32 s94, s94, 32
    s_cmp_gt_u32 s3, 4
    s_cselect_b32 s94, s94, 0
    s_add_u32 s92, s92, s94
    s_max_u32 s94, s13, 32
    s_sub_u32 s94, s94, 32
    s_cmp_gt_u32 s3, 5
    s_cselect_b32 s94, s94, 0
    s_add_u32 s92, s92, s94
    s_max_u32 s94, s14, 32
    s_sub_u32 s94, s94, 32
    s_cmp_gt_u32 s3, 6
    s_cselect_b32 s94, s94, 0
    s_add_u32 s92, s92, s94
    s_min_u32 s94, s8, 32
    s_sub_u32 s95, 32, s94
    s_mov_b32 s3, 0
    s_cmp_lt_u32 s92, s95
    s_cbranch_scc1 L_vac
    s_sub_u32 s92, s92, s95
    s_min_u32 s94, s9, 32
    s_sub_u32 s95, 32, s94
    s_mov_b32 s3, 1
    s_cmp_lt_u32 s92, s95
    s_cbranch_scc1 L_vac
    s_sub_u32 s92, s92, s95
    s_min_u32 s94, s10, 32
    s_sub_u32 s95, 32, s94
    s_mov_b32 s3, 2
    s_cmp_lt_u32 s92, s95
    s_cbranch_scc1 L_vac
    s_sub_u32 s92, s92, s95
    s_min_u32 s94, s11, 32
    s_sub_u32 s95, 32, s94
    s_mov_b32 s3, 3
    s_cmp_lt_u32 s92, s95
    s_cbranch_scc1 L_vac
    s_sub_u32 s92, s92, s95
    s_min_u32 s94, s12, 32
    s_sub_u32 s95, 32, s94
    s_mov_b32 s3, 4
    s_cmp_lt_u32 s92, s95
    s_cbranch_scc1 L_vac
    s_sub_u32 s92, s92, s95
    s_min_u32 s94, s13, 32
    s_sub_u32 s95, 32, s94
    s_mov_b32 s3, 5
    s_cmp_lt_u32 s92, s95
    s_cbranch_scc1 L_vac
    s_sub_u32 s92, s92, s95
    s_min_u32 s94, s14, 32
    s_sub_u32 s95, 32, s94
    s_mov_b32 s3, 6
    s_cmp_lt_u32 s92, s95
    s_cbranch_scc1 L_vac
    s_sub_u32 s92, s92, s95
    s_min_u32 s94, s15, 32
    s_sub_u32 s95, 32, s94
    s_mov_b32 s3, 7
    s_cmp_lt_u32 s92, s95
    s_cbranch_scc1 L_vac
    s_sub_u32 s92, s92, s95
    s_branch L_end
L_vac:
    s_add_u32 s92, s92, s94
L_role_ok:
    s_cmp_lg_u32 s3, 0
    s_cbranch_scc1 L_worker
    s_mov_b32 s28, s66
    s_mov_b32 s29, s67
    s_mov_b32 s30, 9216
    s_mov_b32 s31, 0x00020000
    s_mov_b32 s12, s68
    s_mov_b32 s13, s69
    s_mov_b32 s14, 4718592
    s_mov_b32 s15, 0x00020000
    s_mov_b32 s16, s70
    s_mov_b32 s17, s71
    s_mov_b32 s18, 4718592
    s_mov_b32 s19, 0x00020000
    s_mov_b32 s20, s72
    s_mov_b32 s21, s73
    s_mov_b32 s22, 4718592
    s_mov_b32 s23, 0x00020000
    s_mov_b32 s24, s74
    s_mov_b32 s25, s75
    s_mov_b32 s26, 4718592
    s_mov_b32 s27, 0x00020000
    s_mov_b32 s32, s88
    s_mov_b32 s33, s89
    s_mov_b32 s34, 256
    s_mov_b32 s35, 0x00020000
    s_mov_b32 s8, s90
    s_mov_b32 s9, s91
    s_mov_b32 s10, 268435456
    s_mov_b32 s11, 0x00020000
    v_readfirstlane_b32 s37, v1
    s_mov_b32 s36, s92
    s_nop 0
    s_lshl_b32 s43, s36, 2
    s_add_u32 s43, s43, s37
    s_lshr_b32 s72, s36, 3
    s_lshl_b32 s72, s72, 4
    s_and_b32 s39, s36, 7
    s_add_u32 s72, s72, s39
    s_lshl_b32 s39, s37, 3
    s_add_u32 s72, s72, s39
    s_lshl_b32 s39, s37, 5
    s_add_u32 s39, s39, s36
    s_cmp_ge_u32 s37, 2
    s_cselect_b32 s72, s39, s72
    s_mov_b32 s57, 0x05040100
    s_mov_b32 s58, 0x07060302
    v_lshlrev_b32 v0, 4, v0
    v_lshrrev_b32 v62, 4, v0
    v_and_b32 v60, 15, v62
    v_lshrrev_b32 v61, 4, v62
    v_and_b32 v63, 2, v62
    v_mov_b32 v1, 0x00444444
    v_mov_b32 v64, 0x0049EEEE
    v_cmp_ne_u32 vcc, 0, v63
    s_nop 1
    v_cndmask_b32 v1, v1, v64, vcc
    s_mov_b64 s[6:7], vcc
    s_not_b64 s[4:5], vcc
    s_mov_b32 s78, 0x3f803f80
    s_mov_b32 s79, 0x3f803f80
    s_lshl_b32 s68, s37, 11
    s_xor_b32 s69, s68, 2048
    s_xor_b32 s70, s68, 4096
    s_xor_b32 s71, s68, 6144
    s_lshl_b32 s55, s37, 8
    s_add_u32 s55, s55, 8192
    s_lshl_b32 s48, s37, 10
    s_add_u32 s48, s48, 9216
    s_lshl_b32 s49, s37, 2
    s_add_u32 s49, s49, 13312
    v_lshlrev_b32 v63, 7, v61
    v_lshl_add_u32 v63, v60, 2, v63
    v_add_u32 v3, s48, v63
    v_lshrrev_b32 v63, 2, v60
    v_and_b32 v64, 1, v60
    v_lshl_add_u32 v65, v63, 1, v64
    v_lshlrev_b32 v63, 6, v65
    v_lshl_add_u32 v63, v61, 4, v63
    v_add_u32 v4, s48, v63
    v_lshrrev_b32 v63, 2, v60
    v_lshlrev_b32 v63, 7, v63
    v_lshl_add_u32 v63, v61, 4, v63
    v_add_u32 v63, 512, v63
    v_add_u32 v5, s48, v63
    v_lshl_add_u32 v63, v61, 3, v65
    v_lshlrev_b32 v63, 4, v63
    v_add_u32 v11, 14336, v63
    v_lshrrev_b32 v63, 2, v60
    v_lshlrev_b32 v63, 3, v63
    v_lshl_add_u32 v63, v61, 1, v63
    v_lshlrev_b32 v63, 4, v63
    v_and_b32 v64, 3, v60
    v_lshl_add_u32 v63, v64, 2, v63
    s_lshl_b32 s39, s37, 9
    s_add_u32 s39, s39, 14336
    v_add_u32 v6, s39, v63
    v_lshrrev_b32 v63, 2, v60
    v_lshlrev_b32 v63, 1, v63
    v_lshl_add_u32 v63, v61, 3, v63
    v_and_b32 v64, 1, v60
    v_add_u32 v63, v63, v64
    v_lshlrev_b32 v63, 3, v63
    v_and_b32 v64, 2, v60
    v_lshl_add_u32 v63, v64, 1, v63
    s_mul_i32 s39, s37, 1792
    s_sub_u32 s39, 8192, s39
    v_add_u32 v7, s39, v63
    s_cmp_eq_u32 s37, 2
    s_cselect_b32 s40, 1, 3
    s_cselect_b32 s41, 1, 7
    s_lshl_b32 s39, s72, 7
    s_lshl_b32 s80, s36, 5
    s_add_u32 s80, s80, 8192
    s_cmp_eq_u32 s37, 2
    s_cselect_b32 s74, s80, s39
    v_lshrrev_b32 v63, s40, v60
    v_lshl_add_u32 v63, v63, 2, v61
    v_mul_u32_u24 v63, 9344, v63
    v_and_b32 v64, s41, v60
    v_lshl_add_u32 v64, v64, 4, v63
    v_add_u32 v8, s74, v64
    v_lshrrev_b32 v64, 2, v60
    v_cmp_eq_u32 s[100:101], 0, v64
    v_cmp_eq_u32 s[2:3], 1, v64
    v_and_b32 v63, s41, v60
    v_lshlrev_b32 v63, 4, v63
    v_and_b32 v64, 1, v61
    v_lshl_add_u32 v63, v64, 3, v63
    v_add_u32 v66, s74, v63
    v_bfe_u32 v63, v66, 8, 2
    v_bfe_u32 v64, v66, 3, 1
    v_lshl_add_u32 v65, v63, 1, v64
    v_lshrrev_b32 v67, 11, v66
    v_lshlrev_b32 v67, 4, v67
    v_bfe_u32 v63, v66, 4, 4
    v_add_u32 v67, v67, v63
    v_bfe_u32 v69, v66, 10, 1
    v_bfe_u32 v63, v66, 8, 2
    v_bfe_u32 v64, v66, 5, 1
    v_lshl_add_u32 v70, v63, 1, v64
    v_add_u32 v70, 64, v70
    v_bfe_u32 v63, v66, 6, 2
    v_bfe_u32 v64, v66, 3, 1
    v_lshl_add_u32 v71, v63, 1, v64
    v_bfe_u32 v72, v66, 4, 1
    v_cmp_le_u32 vcc, 0x2000, v66
    s_nop 1
    v_cndmask_b32 v67, v67, v70, vcc
    v_cndmask_b32 v65, v65, v71, vcc
    v_cndmask_b32 v69, v69, v72, vcc
    v_mul_u32_u24 v68, 1152, v65
    v_lshl_add_u32 v68, v67, 4, v68
    v_lshl_add_u32 v68, v69, 3, v68
    v_lshrrev_b32 v63, 10, v66
    v_bfe_u32 v64, v66, 5, 3
    v_lshl_add_u32 v63, v63, 3, v64
    v_bfe_u32 v64, v66, 4, 1
    v_cndmask_b32 v67, v63, v67, vcc
    v_cndmask_b32 v69, v64, v69, vcc
    v_lshrrev_b32 v63, 1, v65
    v_lshlrev_b32 v63, 2, v63
    v_and_b32 v64, 1, v67
    v_lshl_add_u32 v63, v64, 1, v63
    v_and_b32 v64, 1, v65
    v_add_u32 v63, v63, v64
    v_lshlrev_b32 v63, 4, v63
    v_lshrrev_b32 v64, 1, v67
    v_lshl_add_u32 v63, v64, 8, v63
    v_lshl_add_u32 v9, v69, 3, v63
    v_cmp_ge_u32 s[80:81], s41, v60
    v_cmp_gt_u32 s[82:83], 2, v61
    s_nop 0
    s_and_b64 vcc, s[80:81], s[82:83]
    s_cmp_lt_u32 s37, 3
    s_cselect_b64 vcc, vcc, 0
    s_cselect_b64 s[80:81], -1, 0
    v_mov_b32 v63, 1073741824
    v_cndmask_b32 v9, v63, v9, vcc
    v_cndmask_b32 v68, v63, v68, vcc
    v_cndmask_b32 v8, v63, v8, s[80:81]
    v_and_b32 v63, 1, v60
    v_cmp_eq_u32 s[76:77], 0, v63
    s_mov_b32 s56, 0x3e0293ee
    s_mov_b32 s64, 60817408
    s_cmp_eq_u32 s37, 2
    s_cselect_b32 s65, s64, 60892160
    s_cselect_b32 s66, s64, 60966912
    s_cselect_b32 s67, s64, 61041664
    s_mul_i32 s47, s36, 9344
    s_add_u32 s47, s47, 60817408
    s_add_u32 s47, s47, s68
    s_lshl_b32 s50, s36, 14
    s_add_u32 s73, s50, 1048576
    s_lshl_b32 s39, s37, 12
    s_add_u32 s73, s73, s39
    s_add_u32 s50, s50, s68
    s_add_u32 s50, s50, 0
    s_add_u32 s51, s50, 8192
    s_lshl_b32 s52, s43, 10
    s_add_u32 s52, s52, 50331648
    buffer_load_dwordx2 v[28:29], v68, s[28:31], 0 offen
    v_mov_b32 v30, v9
    v_mov_b32 v31, v8
    v_mov_b32 v24, -1
    v_mov_b32 v25, -1
    v_mov_b32 v26, -1
    v_mov_b32 v27, -1
    v_lshrrev_b32 v0, 4, v0
    v_mov_b32 v6, v0
    v_and_b32 v4, 15, v6
    v_lshrrev_b32 v5, 4, v6
    v_lshlrev_b32 v0, 4, v6
    v_lshrrev_b32 v7, 1, v5
    v_lshlrev_b32 v7, 4, v7
    v_and_b32 v8, 1, v5
    v_lshlrev_b32 v8, 2, v8
    v_add_u32 v7, v7, v8
    v_lshlrev_b32 v10, 13, v7
    v_lshl_add_u32 v10, v4, 2, v10
    v_mul_u32_u24 v9, 1152, v7
    s_mul_i32 s39, s37, 36864
    s_add_u32 s39, s39, 16384
    v_add_u32 v2, s39, v0
    v_lshlrev_b32 v12, 7, v7
    v_lshl_add_u32 v12, v4, 2, v12
    s_and_b32 s39, s37, 1
    s_lshl_b32 s39, s39, 6
    v_add_u32 v12, s39, v12
    s_lshl_b32 s39, s37, 12
    s_and_b32 s40, s39, 0x2000
    v_add_u32 v3, s40, v12
    v_add_u32 v1, 4096, v3
    v_xor_b32 v15, 4096, v12
    v_add_u32 v12, s39, v12
    v_xor_b32 v15, 4096, v12
    v_add_u32 v11, s39, v0
    v_lshrrev_b32 v7, 3, v6
    v_lshlrev_b32 v10, 13, v7
    v_and_b32 v8, 7, v6
    v_lshl_add_u32 v10, v8, 4, v10
    v_lshrrev_b32 v7, 5, v6
    v_lshl_add_u32 v7, v7, 15, v10
    s_lshl_b32 s42, s36, 8
    s_lshr_b32 s39, s37, 1
    s_lshl_b32 s39, s39, 7
    s_add_u32 s42, s42, s39
    v_mul_u32_u24 v9, 4608, v5
    v_lshl_add_u32 v13, v4, 4, v9
    s_lshl_b32 s39, s37, 8
    v_add_u32 v13, s39, v13
    v_lshl_add_u32 v14, v4, 1, v9
    s_lshl_b32 s39, s37, 5
    s_add_u32 s39, s39, 1024
    v_add_u32 v14, s39, v14
    s_mul_i32 s40, s36, 147456
    s_add_u32 s41, s40, 0
    buffer_load_dwordx4 v[128:131], v13, s[24:27], s41 offen
    buffer_load_dwordx4 v[132:135], v13, s[24:27], s41 offen offset:1152
    s_add_u32 s41, s40, 2304
    buffer_load_dwordx4 v[136:139], v13, s[24:27], s41 offen
    buffer_load_dwordx4 v[140:143], v13, s[24:27], s41 offen offset:1152
    s_add_u32 s41, s40, 18432
    buffer_load_dwordx4 v[144:147], v13, s[24:27], s41 offen
    buffer_load_dwordx4 v[148:151], v13, s[24:27], s41 offen offset:1152
    s_add_u32 s41, s40, 20736
    buffer_load_dwordx4 v[152:155], v13, s[24:27], s41 offen
    buffer_load_dwordx4 v[156:159], v13, s[24:27], s41 offen offset:1152
    s_add_u32 s41, s40, 36864
    buffer_load_dwordx4 v[160:163], v13, s[24:27], s41 offen
    buffer_load_dwordx4 v[164:167], v13, s[24:27], s41 offen offset:1152
    s_add_u32 s41, s40, 39168
    buffer_load_dwordx4 v[168:171], v13, s[24:27], s41 offen
    buffer_load_dwordx4 v[172:175], v13, s[24:27], s41 offen offset:1152
    s_add_u32 s41, s40, 55296
    buffer_load_dwordx4 v[176:179], v13, s[24:27], s41 offen
    buffer_load_dwordx4 v[180:183], v13, s[24:27], s41 offen offset:1152
    s_add_u32 s41, s40, 57600
    buffer_load_dwordx4 v[184:187], v13, s[24:27], s41 offen
    buffer_load_dwordx4 v[188:191], v13, s[24:27], s41 offen offset:1152
    s_add_u32 s41, s40, 0
    buffer_load_ushort v88, v14, s[24:27], s41 offen
    buffer_load_ushort v89, v14, s[24:27], s41 offen offset:1152
    s_add_u32 s41, s40, 73728
    buffer_load_ushort v90, v14, s[24:27], s41 offen
    buffer_load_ushort v91, v14, s[24:27], s41 offen offset:1152
    s_add_u32 s41, s40, 2304
    buffer_load_ushort v92, v14, s[24:27], s41 offen
    buffer_load_ushort v93, v14, s[24:27], s41 offen offset:1152
    s_add_u32 s41, s40, 76032
    buffer_load_ushort v94, v14, s[24:27], s41 offen
    buffer_load_ushort v95, v14, s[24:27], s41 offen offset:1152
    s_add_u32 s41, s40, 18432
    buffer_load_ushort v96, v14, s[24:27], s41 offen
    buffer_load_ushort v97, v14, s[24:27], s41 offen offset:1152
    s_add_u32 s41, s40, 92160
    buffer_load_ushort v98, v14, s[24:27], s41 offen
    buffer_load_ushort v99, v14, s[24:27], s41 offen offset:1152
    s_add_u32 s41, s40, 20736
    buffer_load_ushort v100, v14, s[24:27], s41 offen
    buffer_load_ushort v101, v14, s[24:27], s41 offen offset:1152
    s_add_u32 s41, s40, 94464
    buffer_load_ushort v102, v14, s[24:27], s41 offen
    buffer_load_ushort v103, v14, s[24:27], s41 offen offset:1152
    s_add_u32 s41, s40, 36864
    buffer_load_ushort v104, v14, s[24:27], s41 offen
    buffer_load_ushort v105, v14, s[24:27], s41 offen offset:1152
    s_add_u32 s41, s40, 110592
    buffer_load_ushort v106, v14, s[24:27], s41 offen
    buffer_load_ushort v107, v14, s[24:27], s41 offen offset:1152
    s_add_u32 s41, s40, 39168
    buffer_load_ushort v108, v14, s[24:27], s41 offen
    buffer_load_ushort v109, v14, s[24:27], s41 offen offset:1152
    s_add_u32 s41, s40, 112896
    buffer_load_ushort v110, v14, s[24:27], s41 offen
    buffer_load_ushort v111, v14, s[24:27], s41 offen offset:1152
    s_add_u32 s41, s40, 55296
    buffer_load_ushort v112, v14, s[24:27], s41 offen
    buffer_load_ushort v113, v14, s[24:27], s41 offen offset:1152
    s_add_u32 s41, s40, 129024
    buffer_load_ushort v114, v14, s[24:27], s41 offen
    buffer_load_ushort v115, v14, s[24:27], s41 offen offset:1152
    s_add_u32 s41, s40, 57600
    buffer_load_ushort v116, v14, s[24:27], s41 offen
    buffer_load_ushort v117, v14, s[24:27], s41 offen offset:1152
    s_add_u32 s41, s40, 131328
    buffer_load_ushort v118, v14, s[24:27], s41 offen
    buffer_load_ushort v119, v14, s[24:27], s41 offen offset:1152
    s_add_u32 s41, s40, 73728
    buffer_load_dwordx4 v[192:195], v13, s[24:27], s41 offen
    buffer_load_dwordx4 v[196:199], v13, s[24:27], s41 offen offset:1152
    s_add_u32 s41, s40, 76032
    buffer_load_dwordx4 v[200:203], v13, s[24:27], s41 offen
    buffer_load_dwordx4 v[204:207], v13, s[24:27], s41 offen offset:1152
    s_add_u32 s41, s40, 92160
    buffer_load_dwordx4 v[208:211], v13, s[24:27], s41 offen
    buffer_load_dwordx4 v[212:215], v13, s[24:27], s41 offen offset:1152
    s_add_u32 s41, s40, 94464
    buffer_load_dwordx4 v[216:219], v13, s[24:27], s41 offen
    buffer_load_dwordx4 v[220:223], v13, s[24:27], s41 offen offset:1152
    s_add_u32 s41, s40, 110592
    buffer_load_dwordx4 v[224:227], v13, s[24:27], s41 offen
    buffer_load_dwordx4 v[228:231], v13, s[24:27], s41 offen offset:1152
    s_add_u32 s41, s40, 112896
    buffer_load_dwordx4 v[232:235], v13, s[24:27], s41 offen
    buffer_load_dwordx4 v[236:239], v13, s[24:27], s41 offen offset:1152
    s_add_u32 s41, s40, 129024
    buffer_load_dwordx4 v[240:243], v13, s[24:27], s41 offen
    buffer_load_dwordx4 v[244:247], v13, s[24:27], s41 offen offset:1152
    s_add_u32 s41, s40, 131328
    buffer_load_dwordx4 v[248:251], v13, s[24:27], s41 offen
    buffer_load_dwordx4 v[252:255], v13, s[24:27], s41 offen offset:1152
    buffer_store_dwordx4 v[24:27], v31, s[8:11], s64 offen sc1
    buffer_store_dwordx4 v[24:27], v31, s[8:11], s65 offen sc1
    buffer_store_dwordx4 v[24:27], v31, s[8:11], s66 offen sc1
    buffer_store_dwordx4 v[24:27], v31, s[8:11], s67 offen sc1
    s_mov_b32 s39, 61875200
    buffer_store_dwordx2 v[24:25], v30, s[8:11], s39 offen sc1
    s_mov_b32 s39, 61884416
    buffer_store_dwordx2 v[24:25], v30, s[8:11], s39 offen sc1
    s_mov_b32 s39, 61893632
    buffer_store_dwordx2 v[24:25], v30, s[8:11], s39 offen sc1
    s_xor_b32 s84, s37, 0
    s_lshl_b32 s84, s84, 20
    s_add_u32 s84, s84, s42
    s_xor_b32 s85, s37, 2
    s_lshl_b32 s85, s85, 20
    s_add_u32 s85, s85, s42
    s_and_b32 s86, s37, 1
    s_lshl_b32 s86, s86, 18
    s_add_u32 s86, s86, s42
    s_add_u32 s41, s84, 0
    buffer_load_dwordx4 v[64:67], v7, s[12:15], s41 offen
    s_add_u32 s41, s84, 131072
    buffer_load_dwordx4 v[68:71], v7, s[12:15], s41 offen
    s_add_u32 s41, s84, 262144
    buffer_load_dwordx4 v[72:75], v7, s[12:15], s41 offen
    s_add_u32 s41, s84, 393216
    buffer_load_dwordx4 v[76:79], v7, s[12:15], s41 offen
    s_add_u32 s41, s84, 524288
    buffer_load_dwordx4 v[48:51], v7, s[12:15], s41 offen
    s_add_u32 s41, s84, 655360
    buffer_load_dwordx4 v[52:55], v7, s[12:15], s41 offen
    s_add_u32 s41, s84, 786432
    buffer_load_dwordx4 v[56:59], v7, s[12:15], s41 offen
    s_add_u32 s41, s84, 917504
    buffer_load_dwordx4 v[60:63], v7, s[12:15], s41 offen
    s_waitcnt vmcnt(63)
    s_mov_b32 s39, 61865984
    buffer_store_dwordx2 v[28:29], v30, s[8:11], s39 offen sc1
    s_waitcnt vmcnt(32)
    v_lshl_or_b32 v80, v89, 16, v88
    v_lshl_or_b32 v81, v91, 16, v90
    v_lshl_or_b32 v82, v93, 16, v92
    v_lshl_or_b32 v83, v95, 16, v94
    v_lshl_or_b32 v84, v97, 16, v96
    v_lshl_or_b32 v85, v99, 16, v98
    v_lshl_or_b32 v86, v101, 16, v100
    v_lshl_or_b32 v87, v103, 16, v102
    v_lshl_or_b32 v16, v105, 16, v104
    v_lshl_or_b32 v17, v107, 16, v106
    v_lshl_or_b32 v18, v109, 16, v108
    v_lshl_or_b32 v19, v111, 16, v110
    v_lshl_or_b32 v20, v113, 16, v112
    v_lshl_or_b32 v21, v115, 16, v114
    v_lshl_or_b32 v22, v117, 16, v116
    v_lshl_or_b32 v23, v119, 16, v118
    ds_write_b128 v2, v[16:19] offset:30720
    ds_write_b128 v2, v[20:23] offset:31744
    v_perm_b32 v88, v132, v128, s57
    v_perm_b32 v89, v132, v128, s58
    v_perm_b32 v90, v140, v136, s57
    v_perm_b32 v91, v140, v136, s58
    v_perm_b32 v92, v148, v144, s57
    v_perm_b32 v93, v148, v144, s58
    v_perm_b32 v94, v156, v152, s57
    v_perm_b32 v95, v156, v152, s58
    v_perm_b32 v96, v133, v129, s57
    v_perm_b32 v97, v133, v129, s58
    v_perm_b32 v98, v141, v137, s57
    v_perm_b32 v99, v141, v137, s58
    v_perm_b32 v100, v149, v145, s57
    v_perm_b32 v101, v149, v145, s58
    v_perm_b32 v102, v157, v153, s57
    v_perm_b32 v103, v157, v153, s58
    v_perm_b32 v104, v134, v130, s57
    v_perm_b32 v105, v134, v130, s58
    v_perm_b32 v106, v142, v138, s57
    v_perm_b32 v107, v142, v138, s58
    v_perm_b32 v108, v150, v146, s57
    v_perm_b32 v109, v150, v146, s58
    v_perm_b32 v110, v158, v154, s57
    v_perm_b32 v111, v158, v154, s58
    v_perm_b32 v112, v135, v131, s57
    v_perm_b32 v113, v135, v131, s58
    v_perm_b32 v114, v143, v139, s57
    v_perm_b32 v115, v143, v139, s58
    v_perm_b32 v116, v151, v147, s57
    v_perm_b32 v117, v151, v147, s58
    v_perm_b32 v118, v159, v155, s57
    v_perm_b32 v119, v159, v155, s58
    v_perm_b32 v16, v164, v160, s57
    v_perm_b32 v17, v164, v160, s58
    v_perm_b32 v18, v172, v168, s57
    v_perm_b32 v19, v172, v168, s58
    v_perm_b32 v20, v180, v176, s57
    v_perm_b32 v21, v180, v176, s58
    v_perm_b32 v22, v188, v184, s57
    v_perm_b32 v23, v188, v184, s58
    ds_write_b128 v2, v[16:19] offset:32768
    ds_write_b128 v2, v[20:23] offset:33792
    v_perm_b32 v120, v165, v161, s57
    v_perm_b32 v121, v165, v161, s58
    v_perm_b32 v122, v173, v169, s57
    v_perm_b32 v123, v173, v169, s58
    v_perm_b32 v124, v181, v177, s57
    v_perm_b32 v125, v181, v177, s58
    v_perm_b32 v126, v189, v185, s57
    v_perm_b32 v127, v189, v185, s58
    v_perm_b32 v128, v166, v162, s57
    v_perm_b32 v129, v166, v162, s58
    v_perm_b32 v130, v174, v170, s57
    v_perm_b32 v131, v174, v170, s58
    v_perm_b32 v132, v182, v178, s57
    v_perm_b32 v133, v182, v178, s58
    v_perm_b32 v134, v190, v186, s57
    v_perm_b32 v135, v190, v186, s58
    v_perm_b32 v136, v167, v163, s57
    v_perm_b32 v137, v167, v163, s58
    v_perm_b32 v138, v175, v171, s57
    v_perm_b32 v139, v175, v171, s58
    v_perm_b32 v140, v183, v179, s57
    v_perm_b32 v141, v183, v179, s58
    v_perm_b32 v142, v191, v187, s57
    v_perm_b32 v143, v191, v187, s58
    s_waitcnt vmcnt(24)
    v_perm_b32 v144, v196, v192, s57
    v_perm_b32 v145, v196, v192, s58
    v_perm_b32 v146, v204, v200, s57
    v_perm_b32 v147, v204, v200, s58
    v_perm_b32 v148, v212, v208, s57
    v_perm_b32 v149, v212, v208, s58
    v_perm_b32 v150, v220, v216, s57
    v_perm_b32 v151, v220, v216, s58
    v_perm_b32 v152, v197, v193, s57
    v_perm_b32 v153, v197, v193, s58
    v_perm_b32 v154, v205, v201, s57
    v_perm_b32 v155, v205, v201, s58
    v_perm_b32 v156, v213, v209, s57
    v_perm_b32 v157, v213, v209, s58
    v_perm_b32 v158, v221, v217, s57
    v_perm_b32 v159, v221, v217, s58
    v_perm_b32 v160, v198, v194, s57
    v_perm_b32 v161, v198, v194, s58
    v_perm_b32 v162, v206, v202, s57
    v_perm_b32 v163, v206, v202, s58
    v_perm_b32 v164, v214, v210, s57
    v_perm_b32 v165, v214, v210, s58
    v_perm_b32 v166, v222, v218, s57
    v_perm_b32 v167, v222, v218, s58
    v_perm_b32 v168, v199, v195, s57
    v_perm_b32 v169, v199, v195, s58
    v_perm_b32 v170, v207, v203, s57
    v_perm_b32 v171, v207, v203, s58
    v_perm_b32 v172, v215, v211, s57
    v_perm_b32 v173, v215, v211, s58
    v_perm_b32 v174, v223, v219, s57
    v_perm_b32 v175, v223, v219, s58
    s_add_u32 s41, s84, 32768
    buffer_load_dwordx4 v[208:211], v7, s[12:15], s41 offen
    s_add_u32 s41, s84, 163840
    buffer_load_dwordx4 v[212:215], v7, s[12:15], s41 offen
    s_add_u32 s41, s84, 294912
    buffer_load_dwordx4 v[216:219], v7, s[12:15], s41 offen
    s_add_u32 s41, s84, 425984
    buffer_load_dwordx4 v[220:223], v7, s[12:15], s41 offen
    s_waitcnt vmcnt(20)
    v_perm_b32 v16, v228, v224, s57
    v_perm_b32 v17, v228, v224, s58
    v_perm_b32 v18, v236, v232, s57
    v_perm_b32 v19, v236, v232, s58
    v_perm_b32 v20, v244, v240, s57
    v_perm_b32 v21, v244, v240, s58
    v_perm_b32 v22, v252, v248, s57
    v_perm_b32 v23, v252, v248, s58
    ds_write_b128 v2, v[16:19] offset:34816
    ds_write_b128 v2, v[20:23] offset:35840
    v_perm_b32 v176, v229, v225, s57
    v_perm_b32 v177, v229, v225, s58
    v_perm_b32 v178, v237, v233, s57
    v_perm_b32 v179, v237, v233, s58
    v_perm_b32 v180, v245, v241, s57
    v_perm_b32 v181, v245, v241, s58
    v_perm_b32 v182, v253, v249, s57
    v_perm_b32 v183, v253, v249, s58
    v_perm_b32 v184, v230, v226, s57
    v_perm_b32 v185, v230, v226, s58
    v_perm_b32 v186, v238, v234, s57
    v_perm_b32 v187, v238, v234, s58
    v_perm_b32 v188, v246, v242, s57
    v_perm_b32 v189, v246, v242, s58
    v_perm_b32 v190, v254, v250, s57
    v_perm_b32 v191, v254, v250, s58
    v_perm_b32 v192, v231, v227, s57
    v_perm_b32 v193, v231, v227, s58
    v_perm_b32 v194, v239, v235, s57
    v_perm_b32 v195, v239, v235, s58
    v_perm_b32 v196, v247, v243, s57
    v_perm_b32 v197, v247, v243, s58
    v_perm_b32 v198, v255, v251, s57
    v_perm_b32 v199, v255, v251, s58
    s_add_u32 s41, s84, 557056
    buffer_load_dwordx4 v[240:243], v7, s[12:15], s41 offen
    s_add_u32 s41, s84, 688128
    buffer_load_dwordx4 v[244:247], v7, s[12:15], s41 offen
    s_add_u32 s41, s84, 819200
    buffer_load_dwordx4 v[248:251], v7, s[12:15], s41 offen
    s_add_u32 s41, s84, 950272
    buffer_load_dwordx4 v[252:255], v7, s[12:15], s41 offen
    s_add_u32 s41, s85, 0
    buffer_load_dwordx4 v[224:227], v7, s[12:15], s41 offen
    s_add_u32 s41, s85, 131072
    buffer_load_dwordx4 v[228:231], v7, s[12:15], s41 offen
    s_add_u32 s41, s85, 262144
    buffer_load_dwordx4 v[232:235], v7, s[12:15], s41 offen
    s_add_u32 s41, s85, 393216
    buffer_load_dwordx4 v[236:239], v7, s[12:15], s41 offen
    s_waitcnt vmcnt(17)
    s_waitcnt lgkmcnt(0)
    s_barrier
    ds_write_b128 v11, v[64:67] offset:0
    ds_write_b128 v11, v[68:71] offset:1024
    ds_write_b128 v11, v[72:75] offset:2048
    ds_write_b128 v11, v[76:79] offset:3072
    s_add_u32 s41, s85, 524288
    buffer_load_dwordx4 v[64:67], v7, s[12:15], s41 offen
    s_add_u32 s41, s85, 655360
    buffer_load_dwordx4 v[68:71], v7, s[12:15], s41 offen
    s_add_u32 s41, s85, 786432
    buffer_load_dwordx4 v[72:75], v7, s[12:15], s41 offen
    s_add_u32 s41, s85, 917504
    buffer_load_dwordx4 v[76:79], v7, s[12:15], s41 offen
    s_waitcnt lgkmcnt(0)
    s_barrier
    ds_read_b32 v32, v12 offset:0
    ds_read_b32 v33, v12 offset:128
    ds_read_b32 v34, v12 offset:1024
    ds_read_b32 v35, v12 offset:1152
    ds_read_b32 v36, v12 offset:256
    ds_read_b32 v37, v12 offset:384
    ds_read_b32 v38, v12 offset:1280
    ds_read_b32 v39, v12 offset:1408
    ds_read_b32 v40, v15 offset:0
    ds_read_b32 v41, v15 offset:128
    ds_read_b32 v42, v15 offset:1024
    ds_read_b32 v43, v15 offset:1152
    ds_read_b32 v44, v15 offset:256
    ds_read_b32 v45, v15 offset:384
    ds_read_b32 v46, v15 offset:1280
    ds_read_b32 v47, v15 offset:1408
    s_waitcnt vmcnt(17)
    s_waitcnt lgkmcnt(0)
    s_barrier
    ds_write_b128 v11, v[48:51] offset:0
    ds_write_b128 v11, v[52:55] offset:1024
    ds_write_b128 v11, v[56:59] offset:2048
    ds_write_b128 v11, v[60:63] offset:3072
    s_add_u32 s41, s85, 32768
    buffer_load_dwordx4 v[48:51], v7, s[12:15], s41 offen
    s_add_u32 s41, s85, 163840
    buffer_load_dwordx4 v[52:55], v7, s[12:15], s41 offen
    s_add_u32 s41, s85, 294912
    buffer_load_dwordx4 v[56:59], v7, s[12:15], s41 offen
    s_add_u32 s41, s85, 425984
    buffer_load_dwordx4 v[60:63], v7, s[12:15], s41 offen
    v_perm_b32 v16, v33, v32, s57
    v_perm_b32 v17, v35, v34, s57
    v_perm_b32 v18, v37, v36, s57
    v_perm_b32 v19, v39, v38, s57
    ds_write_b128 v2, v[16:19] offset:0
    v_perm_b32 v20, v33, v32, s58
    v_perm_b32 v21, v35, v34, s58
    v_perm_b32 v22, v37, v36, s58
    v_perm_b32 v23, v39, v38, s58
    ds_write_b128 v2, v[20:23] offset:2048
    v_perm_b32 v24, v41, v40, s57
    v_perm_b32 v25, v43, v42, s57
    v_perm_b32 v26, v45, v44, s57
    v_perm_b32 v27, v47, v46, s57
    v_accvgpr_write_b32 a32, v24
    v_accvgpr_write_b32 a33, v25
    v_accvgpr_write_b32 a34, v26
    v_accvgpr_write_b32 a35, v27
    v_perm_b32 v28, v41, v40, s58
    v_perm_b32 v29, v43, v42, s58
    v_perm_b32 v30, v45, v44, s58
    v_perm_b32 v31, v47, v46, s58
    v_accvgpr_write_b32 a40, v28
    v_accvgpr_write_b32 a41, v29
    v_accvgpr_write_b32 a42, v30
    v_accvgpr_write_b32 a43, v31
    s_waitcnt lgkmcnt(0)
    s_barrier
    ds_read_b32 v32, v12 offset:0
    ds_read_b32 v33, v12 offset:128
    ds_read_b32 v34, v12 offset:1024
    ds_read_b32 v35, v12 offset:1152
    ds_read_b32 v36, v12 offset:256
    ds_read_b32 v37, v12 offset:384
    ds_read_b32 v38, v12 offset:1280
    ds_read_b32 v39, v12 offset:1408
    ds_read_b32 v40, v15 offset:0
    ds_read_b32 v41, v15 offset:128
    ds_read_b32 v42, v15 offset:1024
    ds_read_b32 v43, v15 offset:1152
    ds_read_b32 v44, v15 offset:256
    ds_read_b32 v45, v15 offset:384
    ds_read_b32 v46, v15 offset:1280
    ds_read_b32 v47, v15 offset:1408
    s_waitcnt vmcnt(16)
    s_waitcnt lgkmcnt(0)
    s_barrier
    s_cmp_lg_u32 s37, 0
    s_cbranch_scc1 L_arr
    v_mov_b32 v16, 1
    s_mov_b64 exec, 1
    buffer_atomic_add v16, off, s[32:35], 0 offset:4
    s_mov_b64 exec, -1
L_arr:
    ds_write_b128 v11, v[208:211] offset:0
    ds_write_b128 v11, v[212:215] offset:1024
    ds_write_b128 v11, v[216:219] offset:2048
    ds_write_b128 v11, v[220:223] offset:3072
    s_add_u32 s41, s85, 557056
    buffer_load_dwordx4 v[208:211], v7, s[12:15], s41 offen
    s_add_u32 s41, s85, 688128
    buffer_load_dwordx4 v[212:215], v7, s[12:15], s41 offen
    s_add_u32 s41, s85, 819200
    buffer_load_dwordx4 v[216:219], v7, s[12:15], s41 offen
    s_add_u32 s41, s85, 950272
    buffer_load_dwordx4 v[220:223], v7, s[12:15], s41 offen
    v_perm_b32 v16, v33, v32, s57
    v_perm_b32 v17, v35, v34, s57
    v_perm_b32 v18, v37, v36, s57
    v_perm_b32 v19, v39, v38, s57
    ds_write_b128 v2, v[16:19] offset:1024
    v_perm_b32 v20, v33, v32, s58
    v_perm_b32 v21, v35, v34, s58
    v_perm_b32 v22, v37, v36, s58
    v_perm_b32 v23, v39, v38, s58
    ds_write_b128 v2, v[20:23] offset:3072
    v_perm_b32 v24, v41, v40, s57
    v_perm_b32 v25, v43, v42, s57
    v_perm_b32 v26, v45, v44, s57
    v_perm_b32 v27, v47, v46, s57
    v_accvgpr_write_b32 a36, v24
    v_accvgpr_write_b32 a37, v25
    v_accvgpr_write_b32 a38, v26
    v_accvgpr_write_b32 a39, v27
    v_perm_b32 v28, v41, v40, s58
    v_perm_b32 v29, v43, v42, s58
    v_perm_b32 v30, v45, v44, s58
    v_perm_b32 v31, v47, v46, s58
    v_accvgpr_write_b32 a44, v28
    v_accvgpr_write_b32 a45, v29
    v_accvgpr_write_b32 a46, v30
    v_accvgpr_write_b32 a47, v31
    s_waitcnt lgkmcnt(0)
    s_barrier
    ds_read_b32 v32, v12 offset:0
    ds_read_b32 v33, v12 offset:128
    ds_read_b32 v34, v12 offset:1024
    ds_read_b32 v35, v12 offset:1152
    ds_read_b32 v36, v12 offset:256
    ds_read_b32 v37, v12 offset:384
    ds_read_b32 v38, v12 offset:1280
    ds_read_b32 v39, v12 offset:1408
    ds_read_b32 v40, v15 offset:0
    ds_read_b32 v41, v15 offset:128
    ds_read_b32 v42, v15 offset:1024
    ds_read_b32 v43, v15 offset:1152
    ds_read_b32 v44, v15 offset:256
    ds_read_b32 v45, v15 offset:384
    ds_read_b32 v46, v15 offset:1280
    ds_read_b32 v47, v15 offset:1408
    s_waitcnt vmcnt(16)
    s_waitcnt lgkmcnt(0)
    s_barrier
    ds_write_b128 v11, v[240:243] offset:0
    ds_write_b128 v11, v[244:247] offset:1024
    ds_write_b128 v11, v[248:251] offset:2048
    ds_write_b128 v11, v[252:255] offset:3072
    s_add_u32 s41, s84, 0
    buffer_load_dwordx4 v[240:243], v7, s[16:19], s41 offen
    s_add_u32 s41, s84, 131072
    buffer_load_dwordx4 v[244:247], v7, s[16:19], s41 offen
    s_add_u32 s41, s84, 262144
    buffer_load_dwordx4 v[248:251], v7, s[16:19], s41 offen
    s_add_u32 s41, s84, 393216
    buffer_load_dwordx4 v[252:255], v7, s[16:19], s41 offen
    v_perm_b32 v16, v33, v32, s57
    v_perm_b32 v17, v35, v34, s57
    v_perm_b32 v18, v37, v36, s57
    v_perm_b32 v19, v39, v38, s57
    v_accvgpr_write_b32 a8, v16
    v_accvgpr_write_b32 a9, v17
    v_accvgpr_write_b32 a10, v18
    v_accvgpr_write_b32 a11, v19
    v_perm_b32 v20, v33, v32, s58
    v_perm_b32 v21, v35, v34, s58
    v_perm_b32 v22, v37, v36, s58
    v_perm_b32 v23, v39, v38, s58
    v_accvgpr_write_b32 a16, v20
    v_accvgpr_write_b32 a17, v21
    v_accvgpr_write_b32 a18, v22
    v_accvgpr_write_b32 a19, v23
    v_perm_b32 v24, v41, v40, s57
    v_perm_b32 v25, v43, v42, s57
    v_perm_b32 v26, v45, v44, s57
    v_perm_b32 v27, v47, v46, s57
    v_accvgpr_write_b32 a56, v24
    v_accvgpr_write_b32 a57, v25
    v_accvgpr_write_b32 a58, v26
    v_accvgpr_write_b32 a59, v27
    v_perm_b32 v28, v41, v40, s58
    v_perm_b32 v29, v43, v42, s58
    v_perm_b32 v30, v45, v44, s58
    v_perm_b32 v31, v47, v46, s58
    v_accvgpr_write_b32 a64, v28
    v_accvgpr_write_b32 a65, v29
    v_accvgpr_write_b32 a66, v30
    v_accvgpr_write_b32 a67, v31
    s_waitcnt lgkmcnt(0)
    s_barrier
    ds_read_b32 v32, v12 offset:0
    ds_read_b32 v33, v12 offset:128
    ds_read_b32 v34, v12 offset:1024
    ds_read_b32 v35, v12 offset:1152
    ds_read_b32 v36, v12 offset:256
    ds_read_b32 v37, v12 offset:384
    ds_read_b32 v38, v12 offset:1280
    ds_read_b32 v39, v12 offset:1408
    ds_read_b32 v40, v15 offset:0
    ds_read_b32 v41, v15 offset:128
    ds_read_b32 v42, v15 offset:1024
    ds_read_b32 v43, v15 offset:1152
    ds_read_b32 v44, v15 offset:256
    ds_read_b32 v45, v15 offset:384
    ds_read_b32 v46, v15 offset:1280
    ds_read_b32 v47, v15 offset:1408
    s_waitcnt vmcnt(16)
    s_waitcnt lgkmcnt(0)
    s_barrier
    ds_write_b128 v11, v[224:227] offset:0
    ds_write_b128 v11, v[228:231] offset:1024
    ds_write_b128 v11, v[232:235] offset:2048
    ds_write_b128 v11, v[236:239] offset:3072
    s_add_u32 s41, s84, 524288
    buffer_load_dwordx4 v[224:227], v7, s[16:19], s41 offen
    s_add_u32 s41, s84, 655360
    buffer_load_dwordx4 v[228:231], v7, s[16:19], s41 offen
    s_add_u32 s41, s84, 786432
    buffer_load_dwordx4 v[232:235], v7, s[16:19], s41 offen
    s_add_u32 s41, s84, 917504
    buffer_load_dwordx4 v[236:239], v7, s[16:19], s41 offen
    v_perm_b32 v16, v33, v32, s57
    v_perm_b32 v17, v35, v34, s57
    v_perm_b32 v18, v37, v36, s57
    v_perm_b32 v19, v39, v38, s57
    v_accvgpr_write_b32 a12, v16
    v_accvgpr_write_b32 a13, v17
    v_accvgpr_write_b32 a14, v18
    v_accvgpr_write_b32 a15, v19
    v_perm_b32 v20, v33, v32, s58
    v_perm_b32 v21, v35, v34, s58
    v_perm_b32 v22, v37, v36, s58
    v_perm_b32 v23, v39, v38, s58
    v_accvgpr_write_b32 a20, v20
    v_accvgpr_write_b32 a21, v21
    v_accvgpr_write_b32 a22, v22
    v_accvgpr_write_b32 a23, v23
    v_perm_b32 v24, v41, v40, s57
    v_perm_b32 v25, v43, v42, s57
    v_perm_b32 v26, v45, v44, s57
    v_perm_b32 v27, v47, v46, s57
    v_accvgpr_write_b32 a60, v24
    v_accvgpr_write_b32 a61, v25
    v_accvgpr_write_b32 a62, v26
    v_accvgpr_write_b32 a63, v27
    v_perm_b32 v28, v41, v40, s58
    v_perm_b32 v29, v43, v42, s58
    v_perm_b32 v30, v45, v44, s58
    v_perm_b32 v31, v47, v46, s58
    v_accvgpr_write_b32 a68, v28
    v_accvgpr_write_b32 a69, v29
    v_accvgpr_write_b32 a70, v30
    v_accvgpr_write_b32 a71, v31
    s_waitcnt lgkmcnt(0)
    s_barrier
    ds_read_b32 v32, v12 offset:0
    ds_read_b32 v33, v12 offset:128
    ds_read_b32 v34, v12 offset:1024
    ds_read_b32 v35, v12 offset:1152
    ds_read_b32 v36, v12 offset:256
    ds_read_b32 v37, v12 offset:384
    ds_read_b32 v38, v12 offset:1280
    ds_read_b32 v39, v12 offset:1408
    ds_read_b32 v40, v15 offset:0
    ds_read_b32 v41, v15 offset:128
    ds_read_b32 v42, v15 offset:1024
    ds_read_b32 v43, v15 offset:1152
    ds_read_b32 v44, v15 offset:256
    ds_read_b32 v45, v15 offset:384
    ds_read_b32 v46, v15 offset:1280
    ds_read_b32 v47, v15 offset:1408
    s_waitcnt vmcnt(16)
    s_waitcnt lgkmcnt(0)
    s_barrier
    ds_write_b128 v11, v[64:67] offset:0
    ds_write_b128 v11, v[68:71] offset:1024
    ds_write_b128 v11, v[72:75] offset:2048
    ds_write_b128 v11, v[76:79] offset:3072
    s_add_u32 s41, s84, 32768
    buffer_load_dwordx4 v[64:67], v7, s[16:19], s41 offen
    s_add_u32 s41, s84, 163840
    buffer_load_dwordx4 v[68:71], v7, s[16:19], s41 offen
    s_add_u32 s41, s84, 294912
    buffer_load_dwordx4 v[72:75], v7, s[16:19], s41 offen
    s_add_u32 s41, s84, 425984
    buffer_load_dwordx4 v[76:79], v7, s[16:19], s41 offen
    v_perm_b32 v16, v33, v32, s57
    v_perm_b32 v17, v35, v34, s57
    v_perm_b32 v18, v37, v36, s57
    v_perm_b32 v19, v39, v38, s57
    v_accvgpr_write_b32 a80, v16
    v_accvgpr_write_b32 a81, v17
    v_accvgpr_write_b32 a82, v18
    v_accvgpr_write_b32 a83, v19
    v_perm_b32 v20, v33, v32, s58
    v_perm_b32 v21, v35, v34, s58
    v_perm_b32 v22, v37, v36, s58
    v_perm_b32 v23, v39, v38, s58
    v_accvgpr_write_b32 a88, v20
    v_accvgpr_write_b32 a89, v21
    v_accvgpr_write_b32 a90, v22
    v_accvgpr_write_b32 a91, v23
    v_perm_b32 v24, v41, v40, s57
    v_perm_b32 v25, v43, v42, s57
    v_perm_b32 v26, v45, v44, s57
    v_perm_b32 v27, v47, v46, s57
    v_accvgpr_write_b32 a128, v24
    v_accvgpr_write_b32 a129, v25
    v_accvgpr_write_b32 a130, v26
    v_accvgpr_write_b32 a131, v27
    v_perm_b32 v28, v41, v40, s58
    v_perm_b32 v29, v43, v42, s58
    v_perm_b32 v30, v45, v44, s58
    v_perm_b32 v31, v47, v46, s58
    v_accvgpr_write_b32 a136, v28
    v_accvgpr_write_b32 a137, v29
    v_accvgpr_write_b32 a138, v30
    v_accvgpr_write_b32 a139, v31
    s_waitcnt lgkmcnt(0)
    s_barrier
    ds_read_b32 v32, v12 offset:0
    ds_read_b32 v33, v12 offset:128
    ds_read_b32 v34, v12 offset:1024
    ds_read_b32 v35, v12 offset:1152
    ds_read_b32 v36, v12 offset:256
    ds_read_b32 v37, v12 offset:384
    ds_read_b32 v38, v12 offset:1280
    ds_read_b32 v39, v12 offset:1408
    ds_read_b32 v40, v15 offset:0
    ds_read_b32 v41, v15 offset:128
    ds_read_b32 v42, v15 offset:1024
    ds_read_b32 v43, v15 offset:1152
    ds_read_b32 v44, v15 offset:256
    ds_read_b32 v45, v15 offset:384
    ds_read_b32 v46, v15 offset:1280
    ds_read_b32 v47, v15 offset:1408
    s_waitcnt vmcnt(16)
    s_waitcnt lgkmcnt(0)
    s_barrier
    ds_write_b128 v11, v[48:51] offset:0
    ds_write_b128 v11, v[52:55] offset:1024
    ds_write_b128 v11, v[56:59] offset:2048
    ds_write_b128 v11, v[60:63] offset:3072
    s_add_u32 s41, s84, 557056
    buffer_load_dwordx4 v[48:51], v7, s[16:19], s41 offen
    s_add_u32 s41, s84, 688128
    buffer_load_dwordx4 v[52:55], v7, s[16:19], s41 offen
    s_add_u32 s41, s84, 819200
    buffer_load_dwordx4 v[56:59], v7, s[16:19], s41 offen
    s_add_u32 s41, s84, 950272
    buffer_load_dwordx4 v[60:63], v7, s[16:19], s41 offen
    v_perm_b32 v16, v33, v32, s57
    v_perm_b32 v17, v35, v34, s57
    v_perm_b32 v18, v37, v36, s57
    v_perm_b32 v19, v39, v38, s57
    v_accvgpr_write_b32 a84, v16
    v_accvgpr_write_b32 a85, v17
    v_accvgpr_write_b32 a86, v18
    v_accvgpr_write_b32 a87, v19
    v_perm_b32 v20, v33, v32, s58
    v_perm_b32 v21, v35, v34, s58
    v_perm_b32 v22, v37, v36, s58
    v_perm_b32 v23, v39, v38, s58
    v_accvgpr_write_b32 a92, v20
    v_accvgpr_write_b32 a93, v21
    v_accvgpr_write_b32 a94, v22
    v_accvgpr_write_b32 a95, v23
    v_perm_b32 v24, v41, v40, s57
    v_perm_b32 v25, v43, v42, s57
    v_perm_b32 v26, v45, v44, s57
    v_perm_b32 v27, v47, v46, s57
    v_accvgpr_write_b32 a132, v24
    v_accvgpr_write_b32 a133, v25
    v_accvgpr_write_b32 a134, v26
    v_accvgpr_write_b32 a135, v27
    v_perm_b32 v28, v41, v40, s58
    v_perm_b32 v29, v43, v42, s58
    v_perm_b32 v30, v45, v44, s58
    v_perm_b32 v31, v47, v46, s58
    v_accvgpr_write_b32 a140, v28
    v_accvgpr_write_b32 a141, v29
    v_accvgpr_write_b32 a142, v30
    v_accvgpr_write_b32 a143, v31
    s_waitcnt lgkmcnt(0)
    s_barrier
    ds_read_b32 v32, v12 offset:0
    ds_read_b32 v33, v12 offset:128
    ds_read_b32 v34, v12 offset:1024
    ds_read_b32 v35, v12 offset:1152
    ds_read_b32 v36, v12 offset:256
    ds_read_b32 v37, v12 offset:384
    ds_read_b32 v38, v12 offset:1280
    ds_read_b32 v39, v12 offset:1408
    ds_read_b32 v40, v15 offset:0
    ds_read_b32 v41, v15 offset:128
    ds_read_b32 v42, v15 offset:1024
    ds_read_b32 v43, v15 offset:1152
    ds_read_b32 v44, v15 offset:256
    ds_read_b32 v45, v15 offset:384
    ds_read_b32 v46, v15 offset:1280
    ds_read_b32 v47, v15 offset:1408
    s_waitcnt vmcnt(16)
    s_waitcnt lgkmcnt(0)
    s_barrier
    ds_write_b128 v11, v[208:211] offset:0
    ds_write_b128 v11, v[212:215] offset:1024
    ds_write_b128 v11, v[216:219] offset:2048
    ds_write_b128 v11, v[220:223] offset:3072
    s_add_u32 s41, s85, 0
    buffer_load_dwordx4 v[208:211], v7, s[16:19], s41 offen
    s_add_u32 s41, s85, 131072
    buffer_load_dwordx4 v[212:215], v7, s[16:19], s41 offen
    s_add_u32 s41, s85, 262144
    buffer_load_dwordx4 v[216:219], v7, s[16:19], s41 offen
    s_add_u32 s41, s85, 393216
    buffer_load_dwordx4 v[220:223], v7, s[16:19], s41 offen
    v_perm_b32 v16, v33, v32, s57
    v_perm_b32 v17, v35, v34, s57
    v_perm_b32 v18, v37, v36, s57
    v_perm_b32 v19, v39, v38, s57
    v_accvgpr_write_b32 a104, v16
    v_accvgpr_write_b32 a105, v17
    v_accvgpr_write_b32 a106, v18
    v_accvgpr_write_b32 a107, v19
    v_perm_b32 v20, v33, v32, s58
    v_perm_b32 v21, v35, v34, s58
    v_perm_b32 v22, v37, v36, s58
    v_perm_b32 v23, v39, v38, s58
    v_accvgpr_write_b32 a112, v20
    v_accvgpr_write_b32 a113, v21
    v_accvgpr_write_b32 a114, v22
    v_accvgpr_write_b32 a115, v23
    v_perm_b32 v24, v41, v40, s57
    v_perm_b32 v25, v43, v42, s57
    v_perm_b32 v26, v45, v44, s57
    v_perm_b32 v27, v47, v46, s57
    v_accvgpr_write_b32 a152, v24
    v_accvgpr_write_b32 a153, v25
    v_accvgpr_write_b32 a154, v26
    v_accvgpr_write_b32 a155, v27
    v_perm_b32 v28, v41, v40, s58
    v_perm_b32 v29, v43, v42, s58
    v_perm_b32 v30, v45, v44, s58
    v_perm_b32 v31, v47, v46, s58
    v_accvgpr_write_b32 a160, v28
    v_accvgpr_write_b32 a161, v29
    v_accvgpr_write_b32 a162, v30
    v_accvgpr_write_b32 a163, v31
    s_waitcnt lgkmcnt(0)
    s_barrier
    ds_read_b32 v32, v12 offset:0
    ds_read_b32 v33, v12 offset:128
    ds_read_b32 v34, v12 offset:1024
    ds_read_b32 v35, v12 offset:1152
    ds_read_b32 v36, v12 offset:256
    ds_read_b32 v37, v12 offset:384
    ds_read_b32 v38, v12 offset:1280
    ds_read_b32 v39, v12 offset:1408
    ds_read_b32 v40, v15 offset:0
    ds_read_b32 v41, v15 offset:128
    ds_read_b32 v42, v15 offset:1024
    ds_read_b32 v43, v15 offset:1152
    ds_read_b32 v44, v15 offset:256
    ds_read_b32 v45, v15 offset:384
    ds_read_b32 v46, v15 offset:1280
    ds_read_b32 v47, v15 offset:1408
    s_waitcnt vmcnt(16)
    s_waitcnt lgkmcnt(0)
    s_barrier
    ds_write_b128 v11, v[240:243] offset:0
    ds_write_b128 v11, v[244:247] offset:1024
    ds_write_b128 v11, v[248:251] offset:2048
    ds_write_b128 v11, v[252:255] offset:3072
    s_add_u32 s41, s85, 524288
    buffer_load_dwordx4 v[240:243], v7, s[16:19], s41 offen
    s_add_u32 s41, s85, 655360
    buffer_load_dwordx4 v[244:247], v7, s[16:19], s41 offen
    s_add_u32 s41, s85, 786432
    buffer_load_dwordx4 v[248:251], v7, s[16:19], s41 offen
    s_add_u32 s41, s85, 917504
    buffer_load_dwordx4 v[252:255], v7, s[16:19], s41 offen
    v_perm_b32 v16, v33, v32, s57
    v_perm_b32 v17, v35, v34, s57
    v_perm_b32 v18, v37, v36, s57
    v_perm_b32 v19, v39, v38, s57
    v_accvgpr_write_b32 a108, v16
    v_accvgpr_write_b32 a109, v17
    v_accvgpr_write_b32 a110, v18
    v_accvgpr_write_b32 a111, v19
    v_perm_b32 v20, v33, v32, s58
    v_perm_b32 v21, v35, v34, s58
    v_perm_b32 v22, v37, v36, s58
    v_perm_b32 v23, v39, v38, s58
    v_accvgpr_write_b32 a116, v20
    v_accvgpr_write_b32 a117, v21
    v_accvgpr_write_b32 a118, v22
    v_accvgpr_write_b32 a119, v23
    v_perm_b32 v24, v41, v40, s57
    v_perm_b32 v25, v43, v42, s57
    v_perm_b32 v26, v45, v44, s57
    v_perm_b32 v27, v47, v46, s57
    v_accvgpr_write_b32 a156, v24
    v_accvgpr_write_b32 a157, v25
    v_accvgpr_write_b32 a158, v26
    v_accvgpr_write_b32 a159, v27
    v_perm_b32 v28, v41, v40, s58
    v_perm_b32 v29, v43, v42, s58
    v_perm_b32 v30, v45, v44, s58
    v_perm_b32 v31, v47, v46, s58
    v_accvgpr_write_b32 a164, v28
    v_accvgpr_write_b32 a165, v29
    v_accvgpr_write_b32 a166, v30
    v_accvgpr_write_b32 a167, v31
    s_waitcnt lgkmcnt(0)
    s_barrier
    ds_read_b32 v32, v12 offset:0
    ds_read_b32 v33, v12 offset:128
    ds_read_b32 v34, v12 offset:1024
    ds_read_b32 v35, v12 offset:1152
    ds_read_b32 v36, v12 offset:256
    ds_read_b32 v37, v12 offset:384
    ds_read_b32 v38, v12 offset:1280
    ds_read_b32 v39, v12 offset:1408
    ds_read_b32 v40, v15 offset:0
    ds_read_b32 v41, v15 offset:128
    ds_read_b32 v42, v15 offset:1024
    ds_read_b32 v43, v15 offset:1152
    ds_read_b32 v44, v15 offset:256
    ds_read_b32 v45, v15 offset:384
    ds_read_b32 v46, v15 offset:1280
    ds_read_b32 v47, v15 offset:1408
    s_waitcnt vmcnt(16)
    s_waitcnt lgkmcnt(0)
    s_barrier
    ds_write_b128 v11, v[224:227] offset:0
    ds_write_b128 v11, v[228:231] offset:1024
    ds_write_b128 v11, v[232:235] offset:2048
    ds_write_b128 v11, v[236:239] offset:3072
    s_add_u32 s41, s85, 32768
    buffer_load_dwordx4 v[224:227], v7, s[16:19], s41 offen
    s_add_u32 s41, s85, 163840
    buffer_load_dwordx4 v[228:231], v7, s[16:19], s41 offen
    s_add_u32 s41, s85, 294912
    buffer_load_dwordx4 v[232:235], v7, s[16:19], s41 offen
    s_add_u32 s41, s85, 425984
    buffer_load_dwordx4 v[236:239], v7, s[16:19], s41 offen
    v_perm_b32 v16, v33, v32, s57
    v_perm_b32 v17, v35, v34, s57
    v_perm_b32 v18, v37, v36, s57
    v_perm_b32 v19, v39, v38, s57
    ds_write_b128 v2, v[16:19] offset:4096
    v_perm_b32 v20, v33, v32, s58
    v_perm_b32 v21, v35, v34, s58
    v_perm_b32 v22, v37, v36, s58
    v_perm_b32 v23, v39, v38, s58
    v_accvgpr_write_b32 a0, v20
    v_accvgpr_write_b32 a1, v21
    v_accvgpr_write_b32 a2, v22
    v_accvgpr_write_b32 a3, v23
    v_perm_b32 v24, v41, v40, s57
    v_perm_b32 v25, v43, v42, s57
    v_perm_b32 v26, v45, v44, s57
    v_perm_b32 v27, v47, v46, s57
    v_accvgpr_write_b32 a48, v24
    v_accvgpr_write_b32 a49, v25
    v_accvgpr_write_b32 a50, v26
    v_accvgpr_write_b32 a51, v27
    v_perm_b32 v28, v41, v40, s58
    v_perm_b32 v29, v43, v42, s58
    v_perm_b32 v30, v45, v44, s58
    v_perm_b32 v31, v47, v46, s58
    ds_write_b128 v2, v[28:31] offset:8192
    s_waitcnt lgkmcnt(0)
    s_barrier
    ds_read_b32 v32, v12 offset:0
    ds_read_b32 v33, v12 offset:128
    ds_read_b32 v34, v12 offset:1024
    ds_read_b32 v35, v12 offset:1152
    ds_read_b32 v36, v12 offset:256
    ds_read_b32 v37, v12 offset:384
    ds_read_b32 v38, v12 offset:1280
    ds_read_b32 v39, v12 offset:1408
    ds_read_b32 v40, v15 offset:0
    ds_read_b32 v41, v15 offset:128
    ds_read_b32 v42, v15 offset:1024
    ds_read_b32 v43, v15 offset:1152
    ds_read_b32 v44, v15 offset:256
    ds_read_b32 v45, v15 offset:384
    ds_read_b32 v46, v15 offset:1280
    ds_read_b32 v47, v15 offset:1408
    s_waitcnt vmcnt(16)
    s_waitcnt lgkmcnt(0)
    s_barrier
    ds_write_b128 v11, v[64:67] offset:0
    ds_write_b128 v11, v[68:71] offset:1024
    ds_write_b128 v11, v[72:75] offset:2048
    ds_write_b128 v11, v[76:79] offset:3072
    s_add_u32 s41, s85, 557056
    buffer_load_dwordx4 v[64:67], v7, s[16:19], s41 offen
    s_add_u32 s41, s85, 688128
    buffer_load_dwordx4 v[68:71], v7, s[16:19], s41 offen
    s_add_u32 s41, s85, 819200
    buffer_load_dwordx4 v[72:75], v7, s[16:19], s41 offen
    s_add_u32 s41, s85, 950272
    buffer_load_dwordx4 v[76:79], v7, s[16:19], s41 offen
    v_perm_b32 v16, v33, v32, s57
    v_perm_b32 v17, v35, v34, s57
    v_perm_b32 v18, v37, v36, s57
    v_perm_b32 v19, v39, v38, s57
    ds_write_b128 v2, v[16:19] offset:5120
    v_perm_b32 v20, v33, v32, s58
    v_perm_b32 v21, v35, v34, s58
    v_perm_b32 v22, v37, v36, s58
    v_perm_b32 v23, v39, v38, s58
    v_accvgpr_write_b32 a4, v20
    v_accvgpr_write_b32 a5, v21
    v_accvgpr_write_b32 a6, v22
    v_accvgpr_write_b32 a7, v23
    v_perm_b32 v24, v41, v40, s57
    v_perm_b32 v25, v43, v42, s57
    v_perm_b32 v26, v45, v44, s57
    v_perm_b32 v27, v47, v46, s57
    v_accvgpr_write_b32 a52, v24
    v_accvgpr_write_b32 a53, v25
    v_accvgpr_write_b32 a54, v26
    v_accvgpr_write_b32 a55, v27
    v_perm_b32 v28, v41, v40, s58
    v_perm_b32 v29, v43, v42, s58
    v_perm_b32 v30, v45, v44, s58
    v_perm_b32 v31, v47, v46, s58
    ds_write_b128 v2, v[28:31] offset:9216
    s_waitcnt lgkmcnt(0)
    s_barrier
    ds_read_b32 v32, v12 offset:0
    ds_read_b32 v33, v12 offset:128
    ds_read_b32 v34, v12 offset:1024
    ds_read_b32 v35, v12 offset:1152
    ds_read_b32 v36, v12 offset:256
    ds_read_b32 v37, v12 offset:384
    ds_read_b32 v38, v12 offset:1280
    ds_read_b32 v39, v12 offset:1408
    ds_read_b32 v40, v15 offset:0
    ds_read_b32 v41, v15 offset:128
    ds_read_b32 v42, v15 offset:1024
    ds_read_b32 v43, v15 offset:1152
    ds_read_b32 v44, v15 offset:256
    ds_read_b32 v45, v15 offset:384
    ds_read_b32 v46, v15 offset:1280
    ds_read_b32 v47, v15 offset:1408
    s_waitcnt vmcnt(16)
    s_waitcnt lgkmcnt(0)
    s_barrier
    ds_write_b128 v11, v[48:51] offset:0
    ds_write_b128 v11, v[52:55] offset:1024
    ds_write_b128 v11, v[56:59] offset:2048
    ds_write_b128 v11, v[60:63] offset:3072
    s_add_u32 s41, s84, 0
    buffer_load_dwordx4 v[48:51], v7, s[20:23], s41 offen
    s_add_u32 s41, s84, 131072
    buffer_load_dwordx4 v[52:55], v7, s[20:23], s41 offen
    s_add_u32 s41, s84, 262144
    buffer_load_dwordx4 v[56:59], v7, s[20:23], s41 offen
    s_add_u32 s41, s84, 393216
    buffer_load_dwordx4 v[60:63], v7, s[20:23], s41 offen
    v_perm_b32 v16, v33, v32, s57
    v_perm_b32 v17, v35, v34, s57
    v_perm_b32 v18, v37, v36, s57
    v_perm_b32 v19, v39, v38, s57
    v_accvgpr_write_b32 a24, v16
    v_accvgpr_write_b32 a25, v17
    v_accvgpr_write_b32 a26, v18
    v_accvgpr_write_b32 a27, v19
    v_perm_b32 v20, v33, v32, s58
    v_perm_b32 v21, v35, v34, s58
    v_perm_b32 v22, v37, v36, s58
    v_perm_b32 v23, v39, v38, s58
    ds_write_b128 v2, v[20:23] offset:6144
    v_perm_b32 v24, v41, v40, s57
    v_perm_b32 v25, v43, v42, s57
    v_perm_b32 v26, v45, v44, s57
    v_perm_b32 v27, v47, v46, s57
    v_accvgpr_write_b32 a72, v24
    v_accvgpr_write_b32 a73, v25
    v_accvgpr_write_b32 a74, v26
    v_accvgpr_write_b32 a75, v27
    v_perm_b32 v28, v41, v40, s58
    v_perm_b32 v29, v43, v42, s58
    v_perm_b32 v30, v45, v44, s58
    v_perm_b32 v31, v47, v46, s58
    ds_write_b128 v2, v[28:31] offset:10240
    s_waitcnt lgkmcnt(0)
    s_barrier
    ds_read_b32 v32, v12 offset:0
    ds_read_b32 v33, v12 offset:128
    ds_read_b32 v34, v12 offset:1024
    ds_read_b32 v35, v12 offset:1152
    ds_read_b32 v36, v12 offset:256
    ds_read_b32 v37, v12 offset:384
    ds_read_b32 v38, v12 offset:1280
    ds_read_b32 v39, v12 offset:1408
    ds_read_b32 v40, v15 offset:0
    ds_read_b32 v41, v15 offset:128
    ds_read_b32 v42, v15 offset:1024
    ds_read_b32 v43, v15 offset:1152
    ds_read_b32 v44, v15 offset:256
    ds_read_b32 v45, v15 offset:384
    ds_read_b32 v46, v15 offset:1280
    ds_read_b32 v47, v15 offset:1408
    s_waitcnt vmcnt(16)
    s_waitcnt lgkmcnt(0)
    s_barrier
    ds_write_b128 v11, v[208:211] offset:0
    ds_write_b128 v11, v[212:215] offset:1024
    ds_write_b128 v11, v[216:219] offset:2048
    ds_write_b128 v11, v[220:223] offset:3072
    s_add_u32 s41, s84, 524288
    buffer_load_dwordx4 v[208:211], v7, s[20:23], s41 offen
    s_add_u32 s41, s84, 655360
    buffer_load_dwordx4 v[212:215], v7, s[20:23], s41 offen
    s_add_u32 s41, s84, 786432
    buffer_load_dwordx4 v[216:219], v7, s[20:23], s41 offen
    s_add_u32 s41, s84, 917504
    buffer_load_dwordx4 v[220:223], v7, s[20:23], s41 offen
    v_perm_b32 v16, v33, v32, s57
    v_perm_b32 v17, v35, v34, s57
    v_perm_b32 v18, v37, v36, s57
    v_perm_b32 v19, v39, v38, s57
    v_accvgpr_write_b32 a28, v16
    v_accvgpr_write_b32 a29, v17
    v_accvgpr_write_b32 a30, v18
    v_accvgpr_write_b32 a31, v19
    v_perm_b32 v20, v33, v32, s58
    v_perm_b32 v21, v35, v34, s58
    v_perm_b32 v22, v37, v36, s58
    v_perm_b32 v23, v39, v38, s58
    ds_write_b128 v2, v[20:23] offset:7168
    v_perm_b32 v24, v41, v40, s57
    v_perm_b32 v25, v43, v42, s57
    v_perm_b32 v26, v45, v44, s57
    v_perm_b32 v27, v47, v46, s57
    v_accvgpr_write_b32 a76, v24
    v_accvgpr_write_b32 a77, v25
    v_accvgpr_write_b32 a78, v26
    v_accvgpr_write_b32 a79, v27
    v_perm_b32 v28, v41, v40, s58
    v_perm_b32 v29, v43, v42, s58
    v_perm_b32 v30, v45, v44, s58
    v_perm_b32 v31, v47, v46, s58
    ds_write_b128 v2, v[28:31] offset:11264
    s_waitcnt lgkmcnt(0)
    s_barrier
    ds_read_b32 v32, v12 offset:0
    ds_read_b32 v33, v12 offset:128
    ds_read_b32 v34, v12 offset:1024
    ds_read_b32 v35, v12 offset:1152
    ds_read_b32 v36, v12 offset:256
    ds_read_b32 v37, v12 offset:384
    ds_read_b32 v38, v12 offset:1280
    ds_read_b32 v39, v12 offset:1408
    ds_read_b32 v40, v15 offset:0
    ds_read_b32 v41, v15 offset:128
    ds_read_b32 v42, v15 offset:1024
    ds_read_b32 v43, v15 offset:1152
    ds_read_b32 v44, v15 offset:256
    ds_read_b32 v45, v15 offset:384
    ds_read_b32 v46, v15 offset:1280
    ds_read_b32 v47, v15 offset:1408
    s_waitcnt vmcnt(16)
    s_waitcnt lgkmcnt(0)
    s_barrier
    ds_write_b128 v11, v[240:243] offset:0
    ds_write_b128 v11, v[244:247] offset:1024
    ds_write_b128 v11, v[248:251] offset:2048
    ds_write_b128 v11, v[252:255] offset:3072
    s_add_u32 s41, s84, 32768
    buffer_load_dwordx4 v[240:243], v7, s[20:23], s41 offen
    s_add_u32 s41, s84, 163840
    buffer_load_dwordx4 v[244:247], v7, s[20:23], s41 offen
    s_add_u32 s41, s84, 294912
    buffer_load_dwordx4 v[248:251], v7, s[20:23], s41 offen
    s_add_u32 s41, s84, 425984
    buffer_load_dwordx4 v[252:255], v7, s[20:23], s41 offen
    v_perm_b32 v16, v33, v32, s57
    v_perm_b32 v17, v35, v34, s57
    v_perm_b32 v18, v37, v36, s57
    v_perm_b32 v19, v39, v38, s57
    v_accvgpr_write_b32 a96, v16
    v_accvgpr_write_b32 a97, v17
    v_accvgpr_write_b32 a98, v18
    v_accvgpr_write_b32 a99, v19
    v_perm_b32 v20, v33, v32, s58
    v_perm_b32 v21, v35, v34, s58
    v_perm_b32 v22, v37, v36, s58
    v_perm_b32 v23, v39, v38, s58
    ds_write_b128 v2, v[20:23] offset:12288
    v_perm_b32 v24, v41, v40, s57
    v_perm_b32 v25, v43, v42, s57
    v_perm_b32 v26, v45, v44, s57
    v_perm_b32 v27, v47, v46, s57
    v_accvgpr_write_b32 a144, v24
    v_accvgpr_write_b32 a145, v25
    v_accvgpr_write_b32 a146, v26
    v_accvgpr_write_b32 a147, v27
    v_perm_b32 v28, v41, v40, s58
    v_perm_b32 v29, v43, v42, s58
    v_perm_b32 v30, v45, v44, s58
    v_perm_b32 v31, v47, v46, s58
    ds_write_b128 v2, v[28:31] offset:16384
    s_waitcnt lgkmcnt(0)
    s_barrier
    ds_read_b32 v32, v12 offset:0
    ds_read_b32 v33, v12 offset:128
    ds_read_b32 v34, v12 offset:1024
    ds_read_b32 v35, v12 offset:1152
    ds_read_b32 v36, v12 offset:256
    ds_read_b32 v37, v12 offset:384
    ds_read_b32 v38, v12 offset:1280
    ds_read_b32 v39, v12 offset:1408
    ds_read_b32 v40, v15 offset:0
    ds_read_b32 v41, v15 offset:128
    ds_read_b32 v42, v15 offset:1024
    ds_read_b32 v43, v15 offset:1152
    ds_read_b32 v44, v15 offset:256
    ds_read_b32 v45, v15 offset:384
    ds_read_b32 v46, v15 offset:1280
    ds_read_b32 v47, v15 offset:1408
    s_waitcnt vmcnt(16)
    s_waitcnt lgkmcnt(0)
    s_barrier
    ds_write_b128 v11, v[224:227] offset:0
    ds_write_b128 v11, v[228:231] offset:1024
    ds_write_b128 v11, v[232:235] offset:2048
    ds_write_b128 v11, v[236:239] offset:3072
    s_add_u32 s41, s84, 557056
    buffer_load_dwordx4 v[224:227], v7, s[20:23], s41 offen
    s_add_u32 s41, s84, 688128
    buffer_load_dwordx4 v[228:231], v7, s[20:23], s41 offen
    s_add_u32 s41, s84, 819200
    buffer_load_dwordx4 v[232:235], v7, s[20:23], s41 offen
    s_add_u32 s41, s84, 950272
    buffer_load_dwordx4 v[236:239], v7, s[20:23], s41 offen
    v_perm_b32 v16, v33, v32, s57
    v_perm_b32 v17, v35, v34, s57
    v_perm_b32 v18, v37, v36, s57
    v_perm_b32 v19, v39, v38, s57
    v_accvgpr_write_b32 a100, v16
    v_accvgpr_write_b32 a101, v17
    v_accvgpr_write_b32 a102, v18
    v_accvgpr_write_b32 a103, v19
    v_perm_b32 v20, v33, v32, s58
    v_perm_b32 v21, v35, v34, s58
    v_perm_b32 v22, v37, v36, s58
    v_perm_b32 v23, v39, v38, s58
    ds_write_b128 v2, v[20:23] offset:13312
    v_perm_b32 v24, v41, v40, s57
    v_perm_b32 v25, v43, v42, s57
    v_perm_b32 v26, v45, v44, s57
    v_perm_b32 v27, v47, v46, s57
    v_accvgpr_write_b32 a148, v24
    v_accvgpr_write_b32 a149, v25
    v_accvgpr_write_b32 a150, v26
    v_accvgpr_write_b32 a151, v27
    v_perm_b32 v28, v41, v40, s58
    v_perm_b32 v29, v43, v42, s58
    v_perm_b32 v30, v45, v44, s58
    v_perm_b32 v31, v47, v46, s58
    ds_write_b128 v2, v[28:31] offset:17408
    s_waitcnt lgkmcnt(0)
    s_barrier
    ds_read_b32 v32, v12 offset:0
    ds_read_b32 v33, v12 offset:128
    ds_read_b32 v34, v12 offset:1024
    ds_read_b32 v35, v12 offset:1152
    ds_read_b32 v36, v12 offset:256
    ds_read_b32 v37, v12 offset:384
    ds_read_b32 v38, v12 offset:1280
    ds_read_b32 v39, v12 offset:1408
    ds_read_b32 v40, v15 offset:0
    ds_read_b32 v41, v15 offset:128
    ds_read_b32 v42, v15 offset:1024
    ds_read_b32 v43, v15 offset:1152
    ds_read_b32 v44, v15 offset:256
    ds_read_b32 v45, v15 offset:384
    ds_read_b32 v46, v15 offset:1280
    ds_read_b32 v47, v15 offset:1408
    s_waitcnt vmcnt(16)
    s_waitcnt lgkmcnt(0)
    s_barrier
    ds_write_b128 v11, v[64:67] offset:0
    ds_write_b128 v11, v[68:71] offset:1024
    ds_write_b128 v11, v[72:75] offset:2048
    ds_write_b128 v11, v[76:79] offset:3072
    s_add_u32 s41, s86, 4194304
    buffer_load_dwordx4 v[64:67], v10, s[12:15], s41 offen
    s_add_u32 s41, s86, 4259840
    buffer_load_dwordx4 v[68:71], v10, s[12:15], s41 offen
    s_add_u32 s41, s86, 4325376
    buffer_load_dwordx4 v[72:75], v10, s[12:15], s41 offen
    s_add_u32 s41, s86, 4390912
    buffer_load_dwordx4 v[76:79], v10, s[12:15], s41 offen
    v_perm_b32 v16, v33, v32, s57
    v_perm_b32 v17, v35, v34, s57
    v_perm_b32 v18, v37, v36, s57
    v_perm_b32 v19, v39, v38, s57
    v_accvgpr_write_b32 a120, v16
    v_accvgpr_write_b32 a121, v17
    v_accvgpr_write_b32 a122, v18
    v_accvgpr_write_b32 a123, v19
    v_perm_b32 v20, v33, v32, s58
    v_perm_b32 v21, v35, v34, s58
    v_perm_b32 v22, v37, v36, s58
    v_perm_b32 v23, v39, v38, s58
    ds_write_b128 v2, v[20:23] offset:14336
    v_perm_b32 v24, v41, v40, s57
    v_perm_b32 v25, v43, v42, s57
    v_perm_b32 v26, v45, v44, s57
    v_perm_b32 v27, v47, v46, s57
    v_accvgpr_write_b32 a168, v24
    v_accvgpr_write_b32 a169, v25
    v_accvgpr_write_b32 a170, v26
    v_accvgpr_write_b32 a171, v27
    v_perm_b32 v28, v41, v40, s58
    v_perm_b32 v29, v43, v42, s58
    v_perm_b32 v30, v45, v44, s58
    v_perm_b32 v31, v47, v46, s58
    ds_write_b128 v2, v[28:31] offset:18432
    s_waitcnt lgkmcnt(0)
    s_barrier
    ds_read_b32 v32, v12 offset:0
    ds_read_b32 v33, v12 offset:128
    ds_read_b32 v34, v12 offset:1024
    ds_read_b32 v35, v12 offset:1152
    ds_read_b32 v36, v12 offset:256
    ds_read_b32 v37, v12 offset:384
    ds_read_b32 v38, v12 offset:1280
    ds_read_b32 v39, v12 offset:1408
    ds_read_b32 v40, v15 offset:0
    ds_read_b32 v41, v15 offset:128
    ds_read_b32 v42, v15 offset:1024
    ds_read_b32 v43, v15 offset:1152
    ds_read_b32 v44, v15 offset:256
    ds_read_b32 v45, v15 offset:384
    ds_read_b32 v46, v15 offset:1280
    ds_read_b32 v47, v15 offset:1408
    s_waitcnt vmcnt(16)
    s_waitcnt lgkmcnt(0)
    s_barrier
    ds_write_b128 v11, v[48:51] offset:0
    ds_write_b128 v11, v[52:55] offset:1024
    ds_write_b128 v11, v[56:59] offset:2048
    ds_write_b128 v11, v[60:63] offset:3072
    s_add_u32 s41, s86, 4194304
    buffer_load_dwordx4 v[48:51], v10, s[16:19], s41 offen
    s_add_u32 s41, s86, 4259840
    buffer_load_dwordx4 v[52:55], v10, s[16:19], s41 offen
    s_add_u32 s41, s86, 4325376
    buffer_load_dwordx4 v[56:59], v10, s[16:19], s41 offen
    s_add_u32 s41, s86, 4390912
    buffer_load_dwordx4 v[60:63], v10, s[16:19], s41 offen
    v_perm_b32 v16, v33, v32, s57
    v_perm_b32 v17, v35, v34, s57
    v_perm_b32 v18, v37, v36, s57
    v_perm_b32 v19, v39, v38, s57
    v_accvgpr_write_b32 a124, v16
    v_accvgpr_write_b32 a125, v17
    v_accvgpr_write_b32 a126, v18
    v_accvgpr_write_b32 a127, v19
    v_perm_b32 v20, v33, v32, s58
    v_perm_b32 v21, v35, v34, s58
    v_perm_b32 v22, v37, v36, s58
    v_perm_b32 v23, v39, v38, s58
    ds_write_b128 v2, v[20:23] offset:15360
    v_perm_b32 v24, v41, v40, s57
    v_perm_b32 v25, v43, v42, s57
    v_perm_b32 v26, v45, v44, s57
    v_perm_b32 v27, v47, v46, s57
    v_accvgpr_write_b32 a172, v24
    v_accvgpr_write_b32 a173, v25
    v_accvgpr_write_b32 a174, v26
    v_accvgpr_write_b32 a175, v27
    v_perm_b32 v28, v41, v40, s58
    v_perm_b32 v29, v43, v42, s58
    v_perm_b32 v30, v45, v44, s58
    v_perm_b32 v31, v47, v46, s58
    ds_write_b128 v2, v[28:31] offset:19456
    s_waitcnt lgkmcnt(0)
    s_barrier
    ds_read_b32 v32, v12 offset:0
    ds_read_b32 v33, v12 offset:128
    ds_read_b32 v34, v12 offset:1024
    ds_read_b32 v35, v12 offset:1152
    ds_read_b32 v36, v12 offset:256
    ds_read_b32 v37, v12 offset:384
    ds_read_b32 v38, v12 offset:1280
    ds_read_b32 v39, v12 offset:1408
    ds_read_b32 v40, v15 offset:0
    ds_read_b32 v41, v15 offset:128
    ds_read_b32 v42, v15 offset:1024
    ds_read_b32 v43, v15 offset:1152
    ds_read_b32 v44, v15 offset:256
    ds_read_b32 v45, v15 offset:384
    ds_read_b32 v46, v15 offset:1280
    ds_read_b32 v47, v15 offset:1408
    s_waitcnt vmcnt(16)
    s_waitcnt lgkmcnt(0)
    s_barrier
    ds_write_b128 v11, v[208:211] offset:0
    ds_write_b128 v11, v[212:215] offset:1024
    ds_write_b128 v11, v[216:219] offset:2048
    ds_write_b128 v11, v[220:223] offset:3072
    v_perm_b32 v16, v33, v32, s57
    v_perm_b32 v17, v35, v34, s57
    v_perm_b32 v18, v37, v36, s57
    v_perm_b32 v19, v39, v38, s57
    v_accvgpr_write_b32 a200, v16
    v_accvgpr_write_b32 a201, v17
    v_accvgpr_write_b32 a202, v18
    v_accvgpr_write_b32 a203, v19
    v_perm_b32 v20, v33, v32, s58
    v_perm_b32 v21, v35, v34, s58
    v_perm_b32 v22, v37, v36, s58
    v_perm_b32 v23, v39, v38, s58
    v_accvgpr_write_b32 a208, v20
    v_accvgpr_write_b32 a209, v21
    v_accvgpr_write_b32 a210, v22
    v_accvgpr_write_b32 a211, v23
    v_perm_b32 v24, v41, v40, s57
    v_perm_b32 v25, v43, v42, s57
    v_perm_b32 v26, v45, v44, s57
    v_perm_b32 v27, v47, v46, s57
    v_accvgpr_write_b32 a232, v24
    v_accvgpr_write_b32 a233, v25
    v_accvgpr_write_b32 a234, v26
    v_accvgpr_write_b32 a235, v27
    v_perm_b32 v28, v41, v40, s58
    v_perm_b32 v29, v43, v42, s58
    v_perm_b32 v30, v45, v44, s58
    v_perm_b32 v31, v47, v46, s58
    v_accvgpr_write_b32 a240, v28
    v_accvgpr_write_b32 a241, v29
    v_accvgpr_write_b32 a242, v30
    v_accvgpr_write_b32 a243, v31
    s_waitcnt lgkmcnt(0)
    s_barrier
    ds_read_b32 v32, v12 offset:0
    ds_read_b32 v33, v12 offset:128
    ds_read_b32 v34, v12 offset:1024
    ds_read_b32 v35, v12 offset:1152
    ds_read_b32 v36, v12 offset:256
    ds_read_b32 v37, v12 offset:384
    ds_read_b32 v38, v12 offset:1280
    ds_read_b32 v39, v12 offset:1408
    ds_read_b32 v40, v15 offset:0
    ds_read_b32 v41, v15 offset:128
    ds_read_b32 v42, v15 offset:1024
    ds_read_b32 v43, v15 offset:1152
    ds_read_b32 v44, v15 offset:256
    ds_read_b32 v45, v15 offset:384
    ds_read_b32 v46, v15 offset:1280
    ds_read_b32 v47, v15 offset:1408
    s_waitcnt vmcnt(12)
    s_waitcnt lgkmcnt(0)
    s_barrier
    ds_write_b128 v11, v[240:243] offset:0
    ds_write_b128 v11, v[244:247] offset:1024
    ds_write_b128 v11, v[248:251] offset:2048
    ds_write_b128 v11, v[252:255] offset:3072
    s_add_u32 s41, s85, 0
    buffer_load_dwordx4 v[240:243], v7, s[20:23], s41 offen
    s_add_u32 s41, s85, 131072
    buffer_load_dwordx4 v[244:247], v7, s[20:23], s41 offen
    s_add_u32 s41, s85, 262144
    buffer_load_dwordx4 v[248:251], v7, s[20:23], s41 offen
    s_add_u32 s41, s85, 393216
    buffer_load_dwordx4 v[252:255], v7, s[20:23], s41 offen
    v_perm_b32 v16, v33, v32, s57
    v_perm_b32 v17, v35, v34, s57
    v_perm_b32 v18, v37, v36, s57
    v_perm_b32 v19, v39, v38, s57
    v_accvgpr_write_b32 a204, v16
    v_accvgpr_write_b32 a205, v17
    v_accvgpr_write_b32 a206, v18
    v_accvgpr_write_b32 a207, v19
    v_perm_b32 v20, v33, v32, s58
    v_perm_b32 v21, v35, v34, s58
    v_perm_b32 v22, v37, v36, s58
    v_perm_b32 v23, v39, v38, s58
    v_accvgpr_write_b32 a212, v20
    v_accvgpr_write_b32 a213, v21
    v_accvgpr_write_b32 a214, v22
    v_accvgpr_write_b32 a215, v23
    v_perm_b32 v24, v41, v40, s57
    v_perm_b32 v25, v43, v42, s57
    v_perm_b32 v26, v45, v44, s57
    v_perm_b32 v27, v47, v46, s57
    v_accvgpr_write_b32 a236, v24
    v_accvgpr_write_b32 a237, v25
    v_accvgpr_write_b32 a238, v26
    v_accvgpr_write_b32 a239, v27
    v_perm_b32 v28, v41, v40, s58
    v_perm_b32 v29, v43, v42, s58
    v_perm_b32 v30, v45, v44, s58
    v_perm_b32 v31, v47, v46, s58
    v_accvgpr_write_b32 a244, v28
    v_accvgpr_write_b32 a245, v29
    v_accvgpr_write_b32 a246, v30
    v_accvgpr_write_b32 a247, v31
    s_waitcnt lgkmcnt(0)
    s_barrier
    ds_read_b32 v32, v12 offset:0
    ds_read_b32 v33, v12 offset:128
    ds_read_b32 v34, v12 offset:1024
    ds_read_b32 v35, v12 offset:1152
    ds_read_b32 v36, v12 offset:256
    ds_read_b32 v37, v12 offset:384
    ds_read_b32 v38, v12 offset:1280
    ds_read_b32 v39, v12 offset:1408
    ds_read_b32 v40, v15 offset:0
    ds_read_b32 v41, v15 offset:128
    ds_read_b32 v42, v15 offset:1024
    ds_read_b32 v43, v15 offset:1152
    ds_read_b32 v44, v15 offset:256
    ds_read_b32 v45, v15 offset:384
    ds_read_b32 v46, v15 offset:1280
    ds_read_b32 v47, v15 offset:1408
    s_waitcnt vmcnt(12)
    s_waitcnt lgkmcnt(0)
    s_barrier
    ds_write_b128 v11, v[224:227] offset:0
    ds_write_b128 v11, v[228:231] offset:1024
    ds_write_b128 v11, v[232:235] offset:2048
    ds_write_b128 v11, v[236:239] offset:3072
    v_perm_b32 v16, v33, v32, s57
    v_perm_b32 v17, v35, v34, s57
    v_perm_b32 v18, v37, v36, s57
    v_perm_b32 v19, v39, v38, s57
    v_accvgpr_write_b32 a216, v16
    v_accvgpr_write_b32 a217, v17
    v_accvgpr_write_b32 a218, v18
    v_accvgpr_write_b32 a219, v19
    v_perm_b32 v20, v33, v32, s58
    v_perm_b32 v21, v35, v34, s58
    v_perm_b32 v22, v37, v36, s58
    v_perm_b32 v23, v39, v38, s58
    v_accvgpr_write_b32 a224, v20
    v_accvgpr_write_b32 a225, v21
    v_accvgpr_write_b32 a226, v22
    v_accvgpr_write_b32 a227, v23
    v_perm_b32 v24, v41, v40, s57
    v_perm_b32 v25, v43, v42, s57
    v_perm_b32 v26, v45, v44, s57
    v_perm_b32 v27, v47, v46, s57
    v_accvgpr_write_b32 a248, v24
    v_accvgpr_write_b32 a249, v25
    v_accvgpr_write_b32 a250, v26
    v_accvgpr_write_b32 a251, v27
    v_perm_b32 v28, v41, v40, s58
    v_perm_b32 v29, v43, v42, s58
    v_perm_b32 v30, v45, v44, s58
    v_perm_b32 v31, v47, v46, s58
    ds_write_b128 v2, v[28:31] offset:26624
    s_waitcnt lgkmcnt(0)
    s_barrier
    ds_read_b32 v32, v12 offset:0
    ds_read_b32 v33, v12 offset:128
    ds_read_b32 v34, v12 offset:1024
    ds_read_b32 v35, v12 offset:1152
    ds_read_b32 v36, v12 offset:256
    ds_read_b32 v37, v12 offset:384
    ds_read_b32 v38, v12 offset:1280
    ds_read_b32 v39, v12 offset:1408
    ds_read_b32 v40, v15 offset:0
    ds_read_b32 v41, v15 offset:128
    ds_read_b32 v42, v15 offset:1024
    ds_read_b32 v43, v15 offset:1152
    ds_read_b32 v44, v15 offset:256
    ds_read_b32 v45, v15 offset:384
    ds_read_b32 v46, v15 offset:1280
    ds_read_b32 v47, v15 offset:1408
    s_waitcnt vmcnt(8)
    s_waitcnt lgkmcnt(0)
    s_barrier
    ds_write_b128 v11, v[64:67] offset:0
    ds_write_b128 v11, v[68:71] offset:1024
    ds_write_b128 v11, v[72:75] offset:2048
    ds_write_b128 v11, v[76:79] offset:3072
    s_add_u32 s41, s85, 524288
    buffer_load_dwordx4 v[64:67], v7, s[20:23], s41 offen
    s_add_u32 s41, s85, 655360
    buffer_load_dwordx4 v[68:71], v7, s[20:23], s41 offen
    s_add_u32 s41, s85, 786432
    buffer_load_dwordx4 v[72:75], v7, s[20:23], s41 offen
    s_add_u32 s41, s85, 917504
    buffer_load_dwordx4 v[76:79], v7, s[20:23], s41 offen
    v_perm_b32 v16, v33, v32, s57
    v_perm_b32 v17, v35, v34, s57
    v_perm_b32 v18, v37, v36, s57
    v_perm_b32 v19, v39, v38, s57
    v_accvgpr_write_b32 a220, v16
    v_accvgpr_write_b32 a221, v17
    v_accvgpr_write_b32 a222, v18
    v_accvgpr_write_b32 a223, v19
    v_perm_b32 v20, v33, v32, s58
    v_perm_b32 v21, v35, v34, s58
    v_perm_b32 v22, v37, v36, s58
    v_perm_b32 v23, v39, v38, s58
    v_accvgpr_write_b32 a228, v20
    v_accvgpr_write_b32 a229, v21
    v_accvgpr_write_b32 a230, v22
    v_accvgpr_write_b32 a231, v23
    v_perm_b32 v24, v41, v40, s57
    v_perm_b32 v25, v43, v42, s57
    v_perm_b32 v26, v45, v44, s57
    v_perm_b32 v27, v47, v46, s57
    v_accvgpr_write_b32 a252, v24
    v_accvgpr_write_b32 a253, v25
    v_accvgpr_write_b32 a254, v26
    v_accvgpr_write_b32 a255, v27
    v_perm_b32 v28, v41, v40, s58
    v_perm_b32 v29, v43, v42, s58
    v_perm_b32 v30, v45, v44, s58
    v_perm_b32 v31, v47, v46, s58
    ds_write_b128 v2, v[28:31] offset:27648
    s_waitcnt lgkmcnt(0)
    s_barrier
    ds_read_b32 v32, v3 offset:0
    ds_read_b32 v33, v3 offset:128
    ds_read_b32 v34, v3 offset:1024
    ds_read_b32 v35, v3 offset:1152
    ds_read_b32 v36, v3 offset:256
    ds_read_b32 v37, v3 offset:384
    ds_read_b32 v38, v3 offset:1280
    ds_read_b32 v39, v3 offset:1408
    ds_read_b32 v40, v1 offset:0
    ds_read_b32 v41, v1 offset:128
    ds_read_b32 v42, v1 offset:1024
    ds_read_b32 v43, v1 offset:1152
    ds_read_b32 v44, v1 offset:256
    ds_read_b32 v45, v1 offset:384
    ds_read_b32 v46, v1 offset:1280
    ds_read_b32 v47, v1 offset:1408
    s_waitcnt vmcnt(8)
    s_waitcnt lgkmcnt(0)
    s_barrier
    ds_write_b128 v11, v[48:51] offset:0
    ds_write_b128 v11, v[52:55] offset:1024
    ds_write_b128 v11, v[56:59] offset:2048
    ds_write_b128 v11, v[60:63] offset:3072
    s_add_u32 s41, s85, 32768
    buffer_load_dwordx4 v[48:51], v7, s[20:23], s41 offen
    s_add_u32 s41, s85, 163840
    buffer_load_dwordx4 v[52:55], v7, s[20:23], s41 offen
    s_add_u32 s41, s85, 294912
    buffer_load_dwordx4 v[56:59], v7, s[20:23], s41 offen
    s_add_u32 s41, s85, 425984
    buffer_load_dwordx4 v[60:63], v7, s[20:23], s41 offen
    v_perm_b32 v16, v33, v32, s57
    v_perm_b32 v17, v35, v34, s57
    v_perm_b32 v18, v37, v36, s57
    v_perm_b32 v19, v39, v38, s57
    v_accvgpr_write_b32 a176, v16
    v_accvgpr_write_b32 a177, v17
    v_accvgpr_write_b32 a178, v18
    v_accvgpr_write_b32 a179, v19
    v_perm_b32 v20, v33, v32, s58
    v_perm_b32 v21, v35, v34, s58
    v_perm_b32 v22, v37, v36, s58
    v_perm_b32 v23, v39, v38, s58
    v_accvgpr_write_b32 a184, v20
    v_accvgpr_write_b32 a185, v21
    v_accvgpr_write_b32 a186, v22
    v_accvgpr_write_b32 a187, v23
    v_perm_b32 v24, v41, v40, s57
    v_perm_b32 v25, v43, v42, s57
    v_perm_b32 v26, v45, v44, s57
    v_perm_b32 v27, v47, v46, s57
    v_accvgpr_write_b32 a180, v24
    v_accvgpr_write_b32 a181, v25
    v_accvgpr_write_b32 a182, v26
    v_accvgpr_write_b32 a183, v27
    v_perm_b32 v28, v41, v40, s58
    v_perm_b32 v29, v43, v42, s58
    v_perm_b32 v30, v45, v44, s58
    v_perm_b32 v31, v47, v46, s58
    v_accvgpr_write_b32 a188, v28
    v_accvgpr_write_b32 a189, v29
    v_accvgpr_write_b32 a190, v30
    v_accvgpr_write_b32 a191, v31
    s_waitcnt lgkmcnt(0)
    s_barrier
    ds_read_b32 v32, v3 offset:0
    ds_read_b32 v33, v3 offset:128
    ds_read_b32 v34, v3 offset:1024
    ds_read_b32 v35, v3 offset:1152
    ds_read_b32 v36, v3 offset:256
    ds_read_b32 v37, v3 offset:384
    ds_read_b32 v38, v3 offset:1280
    ds_read_b32 v39, v3 offset:1408
    ds_read_b32 v40, v1 offset:0
    ds_read_b32 v41, v1 offset:128
    ds_read_b32 v42, v1 offset:1024
    ds_read_b32 v43, v1 offset:1152
    ds_read_b32 v44, v1 offset:256
    ds_read_b32 v45, v1 offset:384
    ds_read_b32 v46, v1 offset:1280
    ds_read_b32 v47, v1 offset:1408
    s_waitcnt vmcnt(8)
    s_waitcnt lgkmcnt(0)
    s_barrier
    ds_write_b128 v11, v[240:243] offset:0
    ds_write_b128 v11, v[244:247] offset:1024
    ds_write_b128 v11, v[248:251] offset:2048
    ds_write_b128 v11, v[252:255] offset:3072
    v_perm_b32 v16, v33, v32, s57
    v_perm_b32 v17, v35, v34, s57
    v_perm_b32 v18, v37, v36, s57
    v_perm_b32 v19, v39, v38, s57
    v_accvgpr_write_b32 a192, v16
    v_accvgpr_write_b32 a193, v17
    v_accvgpr_write_b32 a194, v18
    v_accvgpr_write_b32 a195, v19
    v_perm_b32 v20, v33, v32, s58
    v_perm_b32 v21, v35, v34, s58
    v_perm_b32 v22, v37, v36, s58
    v_perm_b32 v23, v39, v38, s58
    ds_write_b128 v2, v[20:23] offset:20480
    v_perm_b32 v24, v41, v40, s57
    v_perm_b32 v25, v43, v42, s57
    v_perm_b32 v26, v45, v44, s57
    v_perm_b32 v27, v47, v46, s57
    v_accvgpr_write_b32 a196, v24
    v_accvgpr_write_b32 a197, v25
    v_accvgpr_write_b32 a198, v26
    v_accvgpr_write_b32 a199, v27
    v_perm_b32 v28, v41, v40, s58
    v_perm_b32 v29, v43, v42, s58
    v_perm_b32 v30, v45, v44, s58
    v_perm_b32 v31, v47, v46, s58
    ds_write_b128 v2, v[28:31] offset:21504
    s_waitcnt lgkmcnt(0)
    s_barrier
    ds_read_b32 v32, v12 offset:0
    ds_read_b32 v33, v12 offset:128
    ds_read_b32 v34, v12 offset:1024
    ds_read_b32 v35, v12 offset:1152
    ds_read_b32 v36, v12 offset:256
    ds_read_b32 v37, v12 offset:384
    ds_read_b32 v38, v12 offset:1280
    ds_read_b32 v39, v12 offset:1408
    ds_read_b32 v40, v15 offset:0
    ds_read_b32 v41, v15 offset:128
    ds_read_b32 v42, v15 offset:1024
    ds_read_b32 v43, v15 offset:1152
    ds_read_b32 v44, v15 offset:256
    ds_read_b32 v45, v15 offset:384
    ds_read_b32 v46, v15 offset:1280
    ds_read_b32 v47, v15 offset:1408
    s_waitcnt vmcnt(4)
    s_waitcnt lgkmcnt(0)
    s_barrier
    ds_write_b128 v11, v[64:67] offset:0
    ds_write_b128 v11, v[68:71] offset:1024
    ds_write_b128 v11, v[72:75] offset:2048
    ds_write_b128 v11, v[76:79] offset:3072
    s_add_u32 s41, s85, 557056
    buffer_load_dwordx4 v[64:67], v7, s[20:23], s41 offen
    s_add_u32 s41, s85, 688128
    buffer_load_dwordx4 v[68:71], v7, s[20:23], s41 offen
    s_add_u32 s41, s85, 819200
    buffer_load_dwordx4 v[72:75], v7, s[20:23], s41 offen
    s_add_u32 s41, s85, 950272
    buffer_load_dwordx4 v[76:79], v7, s[20:23], s41 offen
    v_perm_b32 v200, v33, v32, s57
    v_perm_b32 v201, v35, v34, s57
    v_perm_b32 v202, v37, v36, s57
    v_perm_b32 v203, v39, v38, s57
    v_perm_b32 v208, v33, v32, s58
    v_perm_b32 v209, v35, v34, s58
    v_perm_b32 v210, v37, v36, s58
    v_perm_b32 v211, v39, v38, s58
    v_perm_b32 v224, v41, v40, s57
    v_perm_b32 v225, v43, v42, s57
    v_perm_b32 v226, v45, v44, s57
    v_perm_b32 v227, v47, v46, s57
    v_perm_b32 v28, v41, v40, s58
    v_perm_b32 v29, v43, v42, s58
    v_perm_b32 v30, v45, v44, s58
    v_perm_b32 v31, v47, v46, s58
    ds_write_b128 v2, v[28:31] offset:22528
    s_waitcnt lgkmcnt(0)
    s_barrier
    ds_read_b32 v32, v12 offset:0
    ds_read_b32 v33, v12 offset:128
    ds_read_b32 v34, v12 offset:1024
    ds_read_b32 v35, v12 offset:1152
    ds_read_b32 v36, v12 offset:256
    ds_read_b32 v37, v12 offset:384
    ds_read_b32 v38, v12 offset:1280
    ds_read_b32 v39, v12 offset:1408
    ds_read_b32 v40, v15 offset:0
    ds_read_b32 v41, v15 offset:128
    ds_read_b32 v42, v15 offset:1024
    ds_read_b32 v43, v15 offset:1152
    ds_read_b32 v44, v15 offset:256
    ds_read_b32 v45, v15 offset:384
    ds_read_b32 v46, v15 offset:1280
    ds_read_b32 v47, v15 offset:1408
    s_waitcnt vmcnt(4)
    s_waitcnt lgkmcnt(0)
    s_barrier
    ds_write_b128 v11, v[48:51] offset:0
    ds_write_b128 v11, v[52:55] offset:1024
    ds_write_b128 v11, v[56:59] offset:2048
    ds_write_b128 v11, v[60:63] offset:3072
    s_add_u32 s41, s86, 4194304
    buffer_load_dwordx4 v[48:51], v10, s[20:23], s41 offen
    s_add_u32 s41, s86, 4259840
    buffer_load_dwordx4 v[52:55], v10, s[20:23], s41 offen
    s_add_u32 s41, s86, 4325376
    buffer_load_dwordx4 v[56:59], v10, s[20:23], s41 offen
    s_add_u32 s41, s86, 4390912
    buffer_load_dwordx4 v[60:63], v10, s[20:23], s41 offen
    v_perm_b32 v204, v33, v32, s57
    v_perm_b32 v205, v35, v34, s57
    v_perm_b32 v206, v37, v36, s57
    v_perm_b32 v207, v39, v38, s57
    v_perm_b32 v212, v33, v32, s58
    v_perm_b32 v213, v35, v34, s58
    v_perm_b32 v214, v37, v36, s58
    v_perm_b32 v215, v39, v38, s58
    v_perm_b32 v228, v41, v40, s57
    v_perm_b32 v229, v43, v42, s57
    v_perm_b32 v230, v45, v44, s57
    v_perm_b32 v231, v47, v46, s57
    v_perm_b32 v28, v41, v40, s58
    v_perm_b32 v29, v43, v42, s58
    v_perm_b32 v30, v45, v44, s58
    v_perm_b32 v31, v47, v46, s58
    ds_write_b128 v2, v[28:31] offset:23552
    s_waitcnt lgkmcnt(0)
    s_barrier
    ds_read_b32 v32, v12 offset:0
    ds_read_b32 v33, v12 offset:128
    ds_read_b32 v34, v12 offset:1024
    ds_read_b32 v35, v12 offset:1152
    ds_read_b32 v36, v12 offset:256
    ds_read_b32 v37, v12 offset:384
    ds_read_b32 v38, v12 offset:1280
    ds_read_b32 v39, v12 offset:1408
    ds_read_b32 v40, v15 offset:0
    ds_read_b32 v41, v15 offset:128
    ds_read_b32 v42, v15 offset:1024
    ds_read_b32 v43, v15 offset:1152
    ds_read_b32 v44, v15 offset:256
    ds_read_b32 v45, v15 offset:384
    ds_read_b32 v46, v15 offset:1280
    ds_read_b32 v47, v15 offset:1408
    s_waitcnt vmcnt(4)
    s_waitcnt lgkmcnt(0)
    s_barrier
    ds_write_b128 v11, v[64:67] offset:0
    ds_write_b128 v11, v[68:71] offset:1024
    ds_write_b128 v11, v[72:75] offset:2048
    ds_write_b128 v11, v[76:79] offset:3072
    v_perm_b32 v216, v33, v32, s57
    v_perm_b32 v217, v35, v34, s57
    v_perm_b32 v218, v37, v36, s57
    v_perm_b32 v219, v39, v38, s57
    v_perm_b32 v20, v33, v32, s58
    v_perm_b32 v21, v35, v34, s58
    v_perm_b32 v22, v37, v36, s58
    v_perm_b32 v23, v39, v38, s58
    ds_write_b128 v2, v[20:23] offset:28672
    v_perm_b32 v232, v41, v40, s57
    v_perm_b32 v233, v43, v42, s57
    v_perm_b32 v234, v45, v44, s57
    v_perm_b32 v235, v47, v46, s57
    v_perm_b32 v240, v41, v40, s58
    v_perm_b32 v241, v43, v42, s58
    v_perm_b32 v242, v45, v44, s58
    v_perm_b32 v243, v47, v46, s58
    s_waitcnt lgkmcnt(0)
    s_barrier
    ds_read_b32 v32, v12 offset:0
    ds_read_b32 v33, v12 offset:128
    ds_read_b32 v34, v12 offset:1024
    ds_read_b32 v35, v12 offset:1152
    ds_read_b32 v36, v12 offset:256
    ds_read_b32 v37, v12 offset:384
    ds_read_b32 v38, v12 offset:1280
    ds_read_b32 v39, v12 offset:1408
    ds_read_b32 v40, v15 offset:0
    ds_read_b32 v41, v15 offset:128
    ds_read_b32 v42, v15 offset:1024
    ds_read_b32 v43, v15 offset:1152
    ds_read_b32 v44, v15 offset:256
    ds_read_b32 v45, v15 offset:384
    ds_read_b32 v46, v15 offset:1280
    ds_read_b32 v47, v15 offset:1408
    s_waitcnt vmcnt(0)
    s_waitcnt lgkmcnt(0)
    s_barrier
    ds_write_b128 v11, v[48:51] offset:0
    ds_write_b128 v11, v[52:55] offset:1024
    ds_write_b128 v11, v[56:59] offset:2048
    ds_write_b128 v11, v[60:63] offset:3072
    v_perm_b32 v220, v33, v32, s57
    v_perm_b32 v221, v35, v34, s57
    v_perm_b32 v222, v37, v36, s57
    v_perm_b32 v223, v39, v38, s57
    v_perm_b32 v20, v33, v32, s58
    v_perm_b32 v21, v35, v34, s58
    v_perm_b32 v22, v37, v36, s58
    v_perm_b32 v23, v39, v38, s58
    ds_write_b128 v2, v[20:23] offset:29696
    v_perm_b32 v236, v41, v40, s57
    v_perm_b32 v237, v43, v42, s57
    v_perm_b32 v238, v45, v44, s57
    v_perm_b32 v239, v47, v46, s57
    v_perm_b32 v244, v41, v40, s58
    v_perm_b32 v245, v43, v42, s58
    v_perm_b32 v246, v45, v44, s58
    v_perm_b32 v247, v47, v46, s58
    s_waitcnt lgkmcnt(0)
    s_barrier
    ds_read_b32 v32, v3 offset:0
    ds_read_b32 v33, v3 offset:128
    ds_read_b32 v34, v3 offset:1024
    ds_read_b32 v35, v3 offset:1152
    ds_read_b32 v36, v3 offset:256
    ds_read_b32 v37, v3 offset:384
    ds_read_b32 v38, v3 offset:1280
    ds_read_b32 v39, v3 offset:1408
    ds_read_b32 v40, v1 offset:0
    ds_read_b32 v41, v1 offset:128
    ds_read_b32 v42, v1 offset:1024
    ds_read_b32 v43, v1 offset:1152
    ds_read_b32 v44, v1 offset:256
    ds_read_b32 v45, v1 offset:384
    ds_read_b32 v46, v1 offset:1280
    ds_read_b32 v47, v1 offset:1408
    s_waitcnt lgkmcnt(0)
    v_perm_b32 v248, v33, v32, s57
    v_perm_b32 v249, v35, v34, s57
    v_perm_b32 v250, v37, v36, s57
    v_perm_b32 v251, v39, v38, s57
    v_perm_b32 v20, v33, v32, s58
    v_perm_b32 v21, v35, v34, s58
    v_perm_b32 v22, v37, v36, s58
    v_perm_b32 v23, v39, v38, s58
    ds_write_b128 v2, v[20:23] offset:24576
    v_perm_b32 v252, v41, v40, s57
    v_perm_b32 v253, v43, v42, s57
    v_perm_b32 v254, v45, v44, s57
    v_perm_b32 v255, v47, v46, s57
    v_perm_b32 v28, v41, v40, s58
    v_perm_b32 v29, v43, v42, s58
    v_perm_b32 v30, v45, v44, s58
    v_perm_b32 v31, v47, v46, s58
    ds_write_b128 v2, v[28:31] offset:25600
    s_waitcnt vmcnt(0) lgkmcnt(0)
    v_lshrrev_b32 v62, 4, v0
    v_and_b32 v60, 15, v62
    v_lshrrev_b32 v61, 4, v62
    v_and_b32 v63, 2, v62
    v_mov_b32 v1, 0x00444444
    v_mov_b32 v64, 0x0049EEEE
    v_cmp_ne_u32 vcc, 0, v63
    s_nop 1
    v_cndmask_b32 v1, v1, v64, vcc
    s_mov_b64 s[6:7], vcc
    s_not_b64 s[4:5], vcc
    s_mov_b32 s78, 0x3f803f80
    s_mov_b32 s79, 0x3f803f80
    s_lshl_b32 s68, s37, 11
    s_xor_b32 s69, s68, 2048
    s_xor_b32 s70, s68, 4096
    s_xor_b32 s71, s68, 6144
    s_lshl_b32 s55, s37, 8
    s_add_u32 s55, s55, 8192
    s_lshl_b32 s48, s37, 10
    s_add_u32 s48, s48, 9216
    s_lshl_b32 s49, s37, 2
    s_add_u32 s49, s49, 13312
    v_lshlrev_b32 v63, 7, v61
    v_lshl_add_u32 v63, v60, 2, v63
    v_add_u32 v3, s48, v63
    v_lshrrev_b32 v63, 2, v60
    v_and_b32 v64, 1, v60
    v_lshl_add_u32 v65, v63, 1, v64
    v_lshlrev_b32 v63, 6, v65
    v_lshl_add_u32 v63, v61, 4, v63
    v_add_u32 v4, s48, v63
    v_lshrrev_b32 v63, 2, v60
    v_lshlrev_b32 v63, 7, v63
    v_lshl_add_u32 v63, v61, 4, v63
    v_add_u32 v63, 512, v63
    v_add_u32 v5, s48, v63
    v_lshl_add_u32 v63, v61, 3, v65
    v_lshlrev_b32 v63, 4, v63
    v_add_u32 v11, 14336, v63
    v_lshrrev_b32 v63, 2, v60
    v_lshlrev_b32 v63, 3, v63
    v_lshl_add_u32 v63, v61, 1, v63
    v_lshlrev_b32 v63, 4, v63
    v_and_b32 v64, 3, v60
    v_lshl_add_u32 v63, v64, 2, v63
    s_lshl_b32 s39, s37, 9
    s_add_u32 s39, s39, 14336
    v_add_u32 v6, s39, v63
    v_lshrrev_b32 v63, 2, v60
    v_lshlrev_b32 v63, 1, v63
    v_lshl_add_u32 v63, v61, 3, v63
    v_and_b32 v64, 1, v60
    v_add_u32 v63, v63, v64
    v_lshlrev_b32 v63, 3, v63
    v_and_b32 v64, 2, v60
    v_lshl_add_u32 v63, v64, 1, v63
    s_mul_i32 s39, s37, 1792
    s_sub_u32 s39, 8192, s39
    v_add_u32 v7, s39, v63
    s_cmp_eq_u32 s37, 2
    s_cselect_b32 s40, 1, 3
    s_cselect_b32 s41, 1, 7
    s_lshl_b32 s39, s72, 7
    s_lshl_b32 s80, s36, 5
    s_add_u32 s80, s80, 8192
    s_cmp_eq_u32 s37, 2
    s_cselect_b32 s74, s80, s39
    v_lshrrev_b32 v63, s40, v60
    v_lshl_add_u32 v63, v63, 2, v61
    v_mul_u32_u24 v63, 9344, v63
    v_and_b32 v64, s41, v60
    v_lshl_add_u32 v64, v64, 4, v63
    v_add_u32 v8, s74, v64
    v_lshrrev_b32 v64, 2, v60
    v_cmp_eq_u32 s[100:101], 0, v64
    v_cmp_eq_u32 s[2:3], 1, v64
    v_and_b32 v63, s41, v60
    v_lshlrev_b32 v63, 4, v63
    v_and_b32 v64, 1, v61
    v_lshl_add_u32 v63, v64, 3, v63
    v_add_u32 v66, s74, v63
    v_bfe_u32 v63, v66, 8, 2
    v_bfe_u32 v64, v66, 3, 1
    v_lshl_add_u32 v65, v63, 1, v64
    v_lshrrev_b32 v67, 11, v66
    v_lshlrev_b32 v67, 4, v67
    v_bfe_u32 v63, v66, 4, 4
    v_add_u32 v67, v67, v63
    v_bfe_u32 v69, v66, 10, 1
    v_bfe_u32 v63, v66, 8, 2
    v_bfe_u32 v64, v66, 5, 1
    v_lshl_add_u32 v70, v63, 1, v64
    v_add_u32 v70, 64, v70
    v_bfe_u32 v63, v66, 6, 2
    v_bfe_u32 v64, v66, 3, 1
    v_lshl_add_u32 v71, v63, 1, v64
    v_bfe_u32 v72, v66, 4, 1
    v_cmp_le_u32 vcc, 0x2000, v66
    s_nop 1
    v_cndmask_b32 v67, v67, v70, vcc
    v_cndmask_b32 v65, v65, v71, vcc
    v_cndmask_b32 v69, v69, v72, vcc
    v_mul_u32_u24 v68, 1152, v65
    v_lshl_add_u32 v68, v67, 4, v68
    v_lshl_add_u32 v68, v69, 3, v68
    v_lshrrev_b32 v63, 10, v66
    v_bfe_u32 v64, v66, 5, 3
    v_lshl_add_u32 v63, v63, 3, v64
    v_bfe_u32 v64, v66, 4, 1
    v_cndmask_b32 v67, v63, v67, vcc
    v_cndmask_b32 v69, v64, v69, vcc
    v_lshrrev_b32 v63, 1, v65
    v_lshlrev_b32 v63, 2, v63
    v_and_b32 v64, 1, v67
    v_lshl_add_u32 v63, v64, 1, v63
    v_and_b32 v64, 1, v65
    v_add_u32 v63, v63, v64
    v_lshlrev_b32 v63, 4, v63
    v_lshrrev_b32 v64, 1, v67
    v_lshl_add_u32 v63, v64, 8, v63
    v_lshl_add_u32 v9, v69, 3, v63
    v_cmp_ge_u32 s[80:81], s41, v60
    v_cmp_gt_u32 s[82:83], 2, v61
    s_nop 0
    s_and_b64 vcc, s[80:81], s[82:83]
    s_cmp_lt_u32 s37, 3
    s_cselect_b64 vcc, vcc, 0
    s_cselect_b64 s[80:81], -1, 0
    v_mov_b32 v63, 1073741824
    v_cndmask_b32 v9, v63, v9, vcc
    v_cndmask_b32 v68, v63, v68, vcc
    v_cndmask_b32 v8, v63, v8, s[80:81]
    v_and_b32 v63, 1, v60
    v_cmp_eq_u32 s[76:77], 0, v63
    s_mov_b32 s56, 0x3e0293ee
    s_mov_b32 s64, 60817408
    s_cmp_eq_u32 s37, 2
    s_cselect_b32 s65, s64, 60892160
    s_cselect_b32 s66, s64, 60966912
    s_cselect_b32 s67, s64, 61041664
    s_mul_i32 s47, s36, 9344
    s_add_u32 s47, s47, 60817408
    s_add_u32 s47, s47, s68
    s_lshl_b32 s50, s36, 14
    s_add_u32 s73, s50, 1048576
    s_lshl_b32 s39, s37, 12
    s_add_u32 s73, s73, s39
    s_add_u32 s50, s50, s68
    s_add_u32 s50, s50, 0
    s_add_u32 s51, s50, 8192
    s_lshl_b32 s52, s43, 10
    s_add_u32 s52, s52, 50331648
    s_barrier
    s_mov_b32 s59, 0
L_bar_loop:
    buffer_load_dwordx4 v[20:23], off, s[32:35], 0 sc1
    s_waitcnt vmcnt(0)
    v_readfirstlane_b32 s39, v21
    v_readfirstlane_b32 s40, v22
    v_readfirstlane_b32 s41, v20
    s_add_u32 s59, s59, 1
    s_cmp_gt_u32 s59, 300000
    s_cbranch_scc1 L_end
    s_cmp_lt_u32 s39, 32
    s_cbranch_scc1 L_bar_loop
    s_cmp_lt_u32 s40, 96
    s_cbranch_scc1 L_bar_loop
    s_mov_b32 s75, 0
    s_mov_b32 s39, 2
L_rdy_i:
    v_lshrrev_b32 v52, 2, v0
    v_and_b32 v52, 60, v52
    buffer_load_dword v53, v52, s[32:35], 0 offen offset:160 sc1
    s_add_u32 s59, s59, 1
    s_waitcnt vmcnt(0)
    v_cmp_gt_u32 vcc, 128, v53
    s_or_b32 s40, vcc_lo, 0x10000
    s_ff1_i32_b32 s40, s40
    s_lshl_b32 s75, s40, 2
    s_cmp_eq_u32 s40, 16
    s_cselect_b32 s75, 100, s75
    s_cmp_gt_u32 s59, 300000
    s_cbranch_scc1 L_rdy_done_i
    s_cmp_ge_u32 s39, s75
    s_cbranch_scc1 L_rdy_i
    s_branch L_rdy_done_i
L_rdy_done_i:
    v_lshlrev_b32 v20, 2, v0
    s_sub_u32 s39, s73, 1048576
    s_sub_u32 s40, s73, 524288
    buffer_load_dword v21, v20, s[8:11], s39 offen
    buffer_load_dword v22, v20, s[8:11], s40 offen
    s_nop 0
    s_mov_b32 s38, 0
    s_mov_b32 s59, 0
    s_waitcnt lgkmcnt(0)
    s_mov_b32 s44, 1073741824
    s_mov_b32 s45, 61865984
    s_cmp_eq_u32 s37, 3
    s_cbranch_scc1 L_step_n
    s_cmp_eq_u32 s37, 2
    s_cbranch_scc1 L_step_q
    s_cmp_lt_u32 s41, 32
    s_cbranch_scc1 L_slow_r
    ds_read_b128 v[36:39], v2 offset:0
    ds_read_b128 v[40:43], v2 offset:1024
    ds_read_b128 v[44:47], v2 offset:2048
    ds_read_b128 v[48:51], v2 offset:3072
    ds_read_b128 v[24:27], v2 offset:4096
    ds_read_b128 v[28:31], v2 offset:5120
    s_add_u32 s54, s45, s68
    v_lshrrev_b32 v10, 2, v0
    v_add_u32 v10, s55, v10
    v_add_u32 v32, s68, v0
    v_add_u32 v76, s69, v0
    v_add_u32 v77, s70, v0
    v_add_u32 v78, s71, v0
    s_waitcnt lgkmcnt(0)
L_loop_r:
    buffer_load_dwordx4 v[16:19], v0, s[8:11], s54 offen sc1
    buffer_load_dwordx4 v[20:23], v0, s[8:11], s54 offen offset:1024 sc1
    buffer_load_dword v79, v10, s[8:11], s45 offen sc1
    s_mov_b32 s46, s44
    s_mov_b32 s44, s45
    s_and_b32 s53, s38, 1
    v_mov_b64 v[52:53], 0
    v_mov_b64 v[54:55], 0
    v_mov_b64 v[56:57], 0
    v_mov_b64 v[58:59], 0
    v_mov_b64 v[60:61], 0
    v_mov_b64 v[62:63], 0
    v_mov_b64 v[64:65], 0
    v_mov_b64 v[66:67], 0
    v_mov_b64 v[68:69], 0
    v_mov_b64 v[70:71], 0
    v_mov_b64 v[72:73], 0
    v_mov_b64 v[74:75], 0
L_pm_chk_r:
    s_waitcnt vmcnt(0)
    ds_write_b128 v32, v[16:19]
    v_max3_u32 v33, v16, v17, v18
    v_max3_u32 v34, v19, v20, v21
    ds_write_b128 v32, v[20:23] offset:1024
    v_max3_u32 v33, v33, v22, v23
    v_max3_u32 v33, v33, v34, v79
    ds_write_b32 v10, v79
    v_cmp_eq_u32 vcc, -1, v33
    s_cbranch_vccnz L_pm_r
L_pm_done_r:
    s_mov_b64 exec, -1
    v_smfmac_f32_16x16x64_bf16 v[52:55], v[16:19], v[36:43], v1
    ds_read_b128 v[36:39], v2 offset:6144
    ds_read_b128 v[40:43], v2 offset:7168
    v_smfmac_f32_16x16x64_bf16 v[56:59], v[16:19], v[44:51], v1
    ds_read_b128 v[44:47], v2 offset:8192
    ds_read_b128 v[48:51], v2 offset:9216
    v_smfmac_f32_16x16x64_bf16 v[60:63], v[16:19], v[24:31], v1
    v_smfmac_f32_16x16x64_bf16 v[64:67], v[16:19], a[0:7], v1
    s_waitcnt lgkmcnt(4)
    s_barrier
    ds_read_b128 v[24:27], v76 offset:0
    ds_read_b128 v[28:31], v76 offset:1024
    ds_read_b128 v[32:35], v77 offset:0
    v_smfmac_f32_16x16x64_bf16 v[52:55], v[20:23], a[8:15], v1
    v_smfmac_f32_16x16x64_bf16 v[56:59], v[20:23], a[16:23], v1
    v_smfmac_f32_16x16x64_bf16 v[60:63], v[20:23], a[24:31], v1
    v_smfmac_f32_16x16x64_bf16 v[68:71], v[16:19], a[200:207], v1
    v_smfmac_f32_16x16x64_bf16 v[72:75], v[16:19], a[208:215], v1
    v_smfmac_f32_16x16x64_bf16 v[68:71], v[20:23], a[216:223], v1
    v_smfmac_f32_16x16x64_bf16 v[72:75], v[20:23], a[224:231], v1
    s_waitcnt lgkmcnt(5)
    v_smfmac_f32_16x16x64_bf16 v[64:67], v[20:23], v[36:43], v1
    ds_read_b128 v[36:39], v2 offset:10240
    ds_read_b128 v[40:43], v2 offset:11264
    s_waitcnt lgkmcnt(4)
    v_smfmac_f32_16x16x64_bf16 v[52:55], v[24:27], a[32:39], v1
    buffer_load_dwordx4 v[16:19], v0, s[8:11], s50 offen
    v_smfmac_f32_16x16x64_bf16 v[56:59], v[24:27], a[40:47], v1
    s_add_u32 s40, s38, 1
    v_smfmac_f32_16x16x64_bf16 v[60:63], v[24:27], a[48:55], v1
    buffer_load_dwordx4 v[20:23], v0, s[8:11], s50 offen offset:1024
    v_smfmac_f32_16x16x64_bf16 v[64:67], v[24:27], v[44:51], v1
    ds_read_b128 v[44:47], v2 offset:12288
    ds_read_b128 v[48:51], v2 offset:13312
    ds_read_b128 v[24:27], v77 offset:1024
    s_waitcnt lgkmcnt(6)
    v_smfmac_f32_16x16x64_bf16 v[52:55], v[28:31], a[56:63], v1
    s_and_b32 s40, s40, 3
    v_smfmac_f32_16x16x64_bf16 v[56:59], v[28:31], a[64:71], v1
    s_mul_i32 s45, s40, 9216
    v_smfmac_f32_16x16x64_bf16 v[60:63], v[28:31], a[72:79], v1
    v_mov_b64 v[12:13], -1
    s_waitcnt lgkmcnt(3)
    v_smfmac_f32_16x16x64_bf16 v[64:67], v[28:31], v[36:43], v1
    ds_read_b128 v[36:39], v2 offset:14336
    ds_read_b128 v[40:43], v2 offset:15360
    ds_read_b128 v[28:31], v78 offset:0
    v_smfmac_f32_16x16x64_bf16 v[52:55], v[32:35], a[80:87], v1
    buffer_store_dwordx2 v[12:13], v9, s[8:11], s46 offen
    v_smfmac_f32_16x16x64_bf16 v[56:59], v[32:35], a[88:95], v1
    s_add_u32 s45, s45, 61865984
    v_smfmac_f32_16x16x64_bf16 v[60:63], v[32:35], a[96:103], v1
    s_add_u32 s50, s50, 524288
    s_waitcnt lgkmcnt(4)
    v_smfmac_f32_16x16x64_bf16 v[64:67], v[32:35], v[44:51], v1
    ds_read_b128 v[44:47], v2 offset:16384
    ds_read_b128 v[48:51], v2 offset:17408
    ds_read_b128 v[32:35], v78 offset:1024
    s_waitcnt lgkmcnt(6)
    v_smfmac_f32_16x16x64_bf16 v[52:55], v[24:27], a[104:111], v1
    v_smfmac_f32_16x16x64_bf16 v[56:59], v[24:27], a[112:119], v1
    v_smfmac_f32_16x16x64_bf16 v[60:63], v[24:27], a[120:127], v1
    s_waitcnt lgkmcnt(4)
    v_smfmac_f32_16x16x64_bf16 v[64:67], v[24:27], v[36:43], v1
    ds_read_b128 v[36:39], v2 offset:18432
    ds_read_b128 v[40:43], v2 offset:19456
    ds_read_b128 v[24:27], v0 offset:8192
    s_waitcnt lgkmcnt(6)
    v_smfmac_f32_16x16x64_bf16 v[52:55], v[28:31], a[128:135], v1
    v_smfmac_f32_16x16x64_bf16 v[56:59], v[28:31], a[136:143], v1
    s_waitcnt lgkmcnt(4)
    v_smfmac_f32_16x16x64_bf16 v[64:67], v[28:31], v[44:51], v1
    ds_read_b128 v[44:47], v2 offset:20480
    ds_read_b128 v[48:51], v2 offset:21504
    s_waitcnt lgkmcnt(5)
    v_smfmac_f32_16x16x64_bf16 v[52:55], v[32:35], a[152:159], v1
    v_smfmac_f32_16x16x64_bf16 v[56:59], v[32:35], a[160:167], v1
    s_waitcnt lgkmcnt(3)
    v_smfmac_f32_16x16x64_bf16 v[64:67], v[32:35], v[36:43], v1
    s_waitcnt lgkmcnt(2)
    v_smfmac_f32_16x16x64_bf16 v[52:55], v[24:27], a[176:183], v1
    v_mov_b64 v[36:37], 0
    v_smfmac_f32_16x16x64_bf16 v[56:59], v[24:27], a[184:191], v1
    v_mov_b64 v[38:39], 0
    v_smfmac_f32_16x16x64_bf16 v[60:63], v[28:31], a[144:151], v1
    v_mov_b64 v[40:41], 0
    v_smfmac_f32_16x16x64_bf16 v[60:63], v[32:35], a[168:175], v1
    v_mov_b64 v[42:43], 0
    v_smfmac_f32_16x16x64_bf16 v[60:63], v[24:27], a[192:199], v1
    v_add_f32 v52, v52, v54
    s_waitcnt lgkmcnt(0)
    v_smfmac_f32_16x16x64_bf16 v[64:67], v[24:27], v[44:51], v1
    ds_read_b128 v[44:47], v2 offset:22528
    ds_read_b128 v[48:51], v2 offset:23552
    v_add_f32 v53, v53, v55
    v_add_f32 v56, v56, v58
    v_add_f32 v57, v57, v59
    v_cvt_pk_bf16_f32 v54, v52, v56
    v_cvt_pk_bf16_f32 v55, v53, v57
    ds_write2_b32 v3, v54, v55 offset0:0 offset1:16
    v_add_f32 v60, v60, v62
    v_add_f32 v61, v61, v63
    v_add_f32 v64, v64, v66
    v_add_f32 v65, v65, v67
    v_cvt_pk_bf16_f32 v12, v60, v64
    v_cvt_pk_bf16_f32 v13, v61, v65
    ds_write2_b32 v3, v12, v13 offset0:128 offset1:144
    s_mov_b64 exec, s[4:5]
    ds_read_b128 v[36:39], v4
    s_mov_b64 exec, s[6:7]
    ds_read_b128 v[40:43], v4
    s_mov_b64 exec, -1
    ds_read_b128 v[60:63], v5
    ds_read_b128 v[64:67], v5 offset:64
    v_smfmac_f32_16x16x64_bf16 v[68:71], v[32:35], v[232:239], v1
    v_add_u32 v76, s48, v0
    v_smfmac_f32_16x16x64_bf16 v[72:75], v[32:35], v[240:247], v1
    v_add_u32 v10, s69, v0
    ds_read_b128 v[32:35], v10 offset:0
    v_add_u32 v77, s49, v0
    s_waitcnt vmcnt(1)
    s_waitcnt lgkmcnt(4)
    v_mfma_f32_16x16x32_bf16 v[52:55], v[16:19], v[36:39], 0
    s_waitcnt lgkmcnt(2)
    v_mfma_f32_16x16x32_bf16 v[56:59], v[60:63], v[36:39], 0
    s_waitcnt lgkmcnt(1)
    v_mfma_f32_16x16x32_bf16 v[56:59], v[64:67], v[40:43], v[56:59]
    v_mfma_f32_16x16x32_bf16 v[52:55], v[20:23], v[40:43], v[52:55]
    buffer_load_dwordx4 v[16:19], v0, s[8:11], s51 offen
    v_smfmac_f32_16x16x64_bf16 v[68:71], v[28:31], v[224:231], v1
    ds_write_b32 v77, v56
    buffer_load_dwordx4 v[20:23], v0, s[8:11], s51 offen offset:1024
    v_smfmac_f32_16x16x64_bf16 v[68:71], v[24:27], v[248:255], v1
    ds_write_b128 v76, v[52:55]
    v_smfmac_f32_16x16x64_bf16 v[72:75], v[28:31], v[44:51], v1
    ds_read_b128 v[44:47], v2 offset:24576
    ds_read_b128 v[48:51], v2 offset:25600
    ds_read_b128 v[28:31], v10 offset:1024
    buffer_store_dwordx4 v[12:15], v0, s[8:11], s52 offen sc1
    s_waitcnt lgkmcnt(3)
    s_barrier
    ds_read_b128 v[52:55], v0 offset:9216
    ds_read_b128 v[56:59], v0 offset:10240
    ds_read_b128 v[60:63], v0 offset:11264
    ds_read_b128 v[64:67], v0 offset:12288
    ds_read_b128 v[36:39], v0 offset:13312
    v_smfmac_f32_16x16x64_bf16 v[68:71], v[32:35], a[232:239], v1
    v_mov_b64 v[40:41], 0
    v_lshlrev_b32 v13, 2, v0
    buffer_load_dword v12, v13, s[8:11], s73 offen
    s_add_u32 s73, s73, 524288
    v_smfmac_f32_16x16x64_bf16 v[72:75], v[32:35], a[240:247], v1
    v_add_u32 v10, s70, v0
    ds_read_b128 v[32:35], v10 offset:0
    v_mov_b64 v[42:43], 0
    s_waitcnt lgkmcnt(7)
    v_smfmac_f32_16x16x64_bf16 v[72:75], v[24:27], v[44:51], v1
    ds_read_b128 v[44:47], v2 offset:26624
    ds_read_b128 v[48:51], v2 offset:27648
    ds_read_b128 v[24:27], v10 offset:1024
    v_mov_b64 v[76:77], 0
    s_waitcnt lgkmcnt(9)
    v_smfmac_f32_16x16x64_bf16 v[68:71], v[28:31], a[248:255], v1
    v_mov_b64 v[78:79], 0
    s_add_u32 s51, s51, 524288
    s_add_u32 s52, s52, 131072
    s_waitcnt lgkmcnt(4)
    v_pk_add_f32 v[52:53], v[52:53], v[56:57]
    v_pk_add_f32 v[60:61], v[60:61], v[64:65]
    v_pk_add_f32 v[54:55], v[54:55], v[58:59]
    v_pk_add_f32 v[62:63], v[62:63], v[66:67]
    v_pk_add_f32 v[36:37], v[36:37], v[38:39]
    v_pk_add_f32 v[52:53], v[52:53], v[60:61]
    v_pk_add_f32 v[54:55], v[54:55], v[62:63]
    v_add_f32 v36, v36, v37
    v_max3_f32 v56, v52, v53, v54
    v_max3_f32 v56, v56, v55, v36
    s_waitcnt lgkmcnt(3)
    v_smfmac_f32_16x16x64_bf16 v[68:71], v[32:35], v[200:207], v1
    v_mov_b64 v[64:65], s[78:79]
    v_max_f32_dpp v56, v56, v56 quad_perm:[2,3,0,1] row_mask:0xf bank_mask:0xf
    v_mov_b32 v57, v56
    v_smfmac_f32_16x16x64_bf16 v[72:75], v[32:35], v[208:215], v1
    v_mov_b64 v[66:67], s[78:79]
    v_permlane16_swap_b32 v57, v56
    v_max_f32 v56, v56, v57
    v_mov_b32 v57, v56
    s_waitcnt lgkmcnt(1)
    v_smfmac_f32_16x16x64_bf16 v[72:75], v[28:31], v[44:51], v1
    ds_read_b128 v[44:47], v2 offset:28672
    ds_read_b128 v[48:51], v2 offset:29696
    v_mov_b32 v63, 0
    v_permlane32_swap_b32 v57, v56
    v_max_f32 v56, v56, v57
    s_waitcnt lgkmcnt(2)
    v_smfmac_f32_16x16x64_bf16 v[68:71], v[24:27], v[216:223], v1
    v_mul_f32 v56, s56, v56
    v_fma_f32 v52, v52, s56, -v56
    v_fma_f32 v53, v53, s56, -v56
    v_fma_f32 v54, v54, s56, -v56
    v_fma_f32 v55, v55, s56, -v56
    v_fma_f32 v36, v36, s56, -v56
    s_waitcnt lgkmcnt(0)
    v_smfmac_f32_16x16x64_bf16 v[72:75], v[24:27], v[44:51], v1
    ds_read_b128 v[44:47], v2 offset:30720
    ds_read_b128 v[48:51], v2 offset:31744
    v_exp_f32 v52, v52
    v_exp_f32 v53, v53
    v_exp_f32 v54, v54
    v_exp_f32 v55, v55
    v_exp_f32 v36, v36
    v_cvt_pk_bf16_f32 v60, v52, v53
    v_cvt_pk_bf16_f32 v61, v54, v55
    v_cvt_pk_bf16_f32 v62, v36, v63
    s_waitcnt vmcnt(2)
    v_smfmac_f32_16x16x32_bf16 v[40:43], v[60:61], v[16:19], v1
    v_add_f32 v68, v68, v70
    v_add_f32 v69, v69, v71
    v_smfmac_f32_16x16x32_bf16 v[76:79], v[60:61], v[20:23], v1
    v_add_f32 v72, v72, v74
    v_add_f32 v73, v73, v75
    v_mfma_f32_16x16x32_bf16 v[32:35], v[60:63], v[64:67], 0
    v_cvt_pk_bf16_f32 v68, v68, v69
    v_cvt_pk_bf16_f32 v69, v72, v73
    v_cvt_pk_bf16_f32 v70, v72, v73
    v_mov_b32 v71, 0
    v_mov_b32 v72, 0
    ds_read_b128 v[24:27], v2 offset:32768
    ds_read_b128 v[28:31], v2 offset:33792
    v_smfmac_f32_16x16x32_bf16 v[40:43], v[62:63], v[68:71], v1 abid:2
    ds_read_b128 v[16:19], v2 offset:34816
    ds_read_b128 v[20:23], v2 offset:35840
    v_add_f32 v32, v32, v34
    v_smfmac_f32_16x16x32_bf16 v[76:79], v[62:63], v[70:73], v1 abid:2
    v_add_f32 v33, v33, v35
    v_rcp_f32 v32, v32
    v_rcp_f32 v33, v33
    v_mov_b64 v[14:15], v[68:69]
    s_cmp_eq_u32 s38, 63
    s_cbranch_scc1 L_exit_r
    v_mov_b64 v[36:37], 0
    v_mov_b64 v[38:39], 0
    v_add_f32 v40, v40, v42
    v_add_f32 v41, v41, v43
    v_add_f32 v76, v76, v78
    v_add_f32 v77, v77, v79
    v_pk_mul_f32 v[40:41], v[40:41], v[32:33]
    v_pk_mul_f32 v[76:77], v[76:77], v[32:33]
    v_cvt_pk_bf16_f32 v34, v40, v76
    v_cvt_pk_bf16_f32 v35, v41, v77
    ds_write2_b32 v6, v34, v35 offset0:0 offset1:4
    v_and_b32 v10, 32, v0
    v_lshl_add_u32 v10, v10, 5, v11
    v_mov_b64 v[40:41], 0
    v_mov_b64 v[42:43], 0
    v_mov_b64 v[76:77], 0
    v_mov_b64 v[78:79], 0
    s_waitcnt lgkmcnt(0)
    s_barrier
    ds_read_b128 v[52:55], v11 offset:0
    ds_read_b128 v[56:59], v11 offset:512
    ds_read_b128 v[60:63], v11 offset:1024
    ds_read_b128 v[64:67], v11 offset:1536
    ds_read_b128 v[68:71], v10 offset:0
    ds_read_b128 v[72:75], v10 offset:512
    v_mov_b64 v[32:33], 0
    v_mov_b64 v[34:35], 0
    s_waitcnt lgkmcnt(5)
    v_smfmac_f32_16x16x64_bf16 v[40:43], v[52:55], v[88:95], v1
    v_smfmac_f32_16x16x64_bf16 v[76:79], v[52:55], v[96:103], v1
    s_waitcnt lgkmcnt(4)
    v_smfmac_f32_16x16x64_bf16 v[40:43], v[56:59], v[24:31], v1
    v_smfmac_f32_16x16x64_bf16 v[76:79], v[56:59], v[120:127], v1
    v_mov_b64 v[24:25], 0
    s_waitcnt lgkmcnt(3)
    v_smfmac_f32_16x16x64_bf16 v[40:43], v[60:63], v[144:151], v1
    v_mov_b64 v[26:27], 0
    s_waitcnt lgkmcnt(2)
    v_smfmac_f32_16x16x64_bf16 v[40:43], v[64:67], v[16:23], v1
    v_smfmac_f32_16x16x64_bf16 v[76:79], v[60:63], v[152:159], v1
    v_smfmac_f32_16x16x64_bf16 v[76:79], v[64:67], v[176:183], v1
    s_waitcnt lgkmcnt(1)
    v_smfmac_f32_16x16x64_bf16 v[36:39], v[68:71], v[80:87], v1
    v_cvt_pk_bf16_f32 v40, v40, v42
    s_waitcnt lgkmcnt(0)
    v_smfmac_f32_16x16x64_bf16 v[36:39], v[72:75], v[44:51], v1
    v_cvt_pk_bf16_f32 v42, v41, v43
    v_smfmac_f32_16x16x64_bf16 v[32:35], v[52:55], v[104:111], v1
    v_and_or_b32 v40, v40, -2, s53
    v_and_or_b32 v42, v42, -2, s53
    v_smfmac_f32_16x16x64_bf16 v[32:35], v[56:59], v[128:135], v1
    v_cvt_pk_bf16_f32 v41, v76, v78
    v_smfmac_f32_16x16x64_bf16 v[32:35], v[60:63], v[160:167], v1
    v_cvt_pk_bf16_f32 v43, v77, v79
    buffer_store_dwordx4 v[40:43], v0, s[8:11], s47 offen offset:0
    v_add_f32 v36, v36, v38
    v_smfmac_f32_16x16x64_bf16 v[32:35], v[64:67], v[184:191], v1
    v_add_f32 v37, v37, v39
    v_cndmask_b32 v38, v36, v37, s[76:77]
    v_smfmac_f32_16x16x64_bf16 v[24:27], v[52:55], v[112:119], v1
    s_nop 0
    v_mov_b32_dpp v39, v38 quad_perm:[1,0,3,2] row_mask:0xf bank_mask:0xf
    v_cndmask_b32 v36, v39, v36, s[76:77]
    v_smfmac_f32_16x16x64_bf16 v[24:27], v[56:59], v[136:143], v1
    v_cndmask_b32 v37, v37, v39, s[76:77]
    v_smfmac_f32_16x16x64_bf16 v[24:27], v[60:63], v[168:175], v1
    v_cvt_pk_bf16_f32 v36, v36, v37
    v_and_or_b32 v36, v36, -2, s53
    v_smfmac_f32_16x16x64_bf16 v[24:27], v[64:67], v[192:199], v1
    buffer_store_dword v36, v7, s[8:11], s47 offen
    v_cvt_pk_bf16_f32 v32, v32, v34
    v_cvt_pk_bf16_f32 v34, v33, v35
    v_and_or_b32 v32, v32, -2, s53
    v_and_or_b32 v34, v34, -2, s53
    s_nop 2
    v_cvt_pk_bf16_f32 v33, v24, v26
    v_cvt_pk_bf16_f32 v35, v25, v27
    buffer_store_dwordx4 v[32:35], v0, s[8:11], s47 offen offset:1024
    ds_read_b128 v[36:39], v2 offset:0
    ds_read_b128 v[40:43], v2 offset:1024
    ds_read_b128 v[44:47], v2 offset:2048
    ds_read_b128 v[48:51], v2 offset:3072
    ds_read_b128 v[24:27], v2 offset:4096
    ds_read_b128 v[28:31], v2 offset:5120
    s_add_u32 s54, s45, s68
    v_lshrrev_b32 v10, 2, v0
    v_add_u32 v10, s55, v10
    v_add_u32 v32, s68, v0
    v_add_u32 v76, s69, v0
    v_add_u32 v77, s70, v0
    v_add_u32 v78, s71, v0
    s_waitcnt lgkmcnt(0)
    v_mov_b32 v18, 0x3f80
    v_mov_b32 v19, 0x3f800000
    v_cndmask_b32 v18, v19, v18, s[76:77]
    v_cndmask_b32 v16, 0, v18, s[100:101]
    v_cndmask_b32 v17, 0, v18, s[2:3]
    v_mov_b64 v[18:19], v[16:17]
    v_mov_b64 v[72:73], 0
    v_mov_b64 v[74:75], 0
    v_mov_b64 v[20:21], 0
    s_waitcnt vmcnt(2)
    s_cmp_eq_u32 s37, 0
    s_cbranch_scc1 L_ew_r
    s_waitcnt vmcnt(0)
L_ew_r:
    buffer_load_dwordx4 v[52:55], v8, s[8:11], s64 offen sc1
    buffer_load_dwordx4 v[56:59], v8, s[8:11], s65 offen sc1
    buffer_load_dwordx4 v[60:63], v8, s[8:11], s66 offen sc1
    buffer_load_dwordx4 v[64:67], v8, s[8:11], s67 offen sc1
L_pp_wait_r:
    s_waitcnt vmcnt(2)
    v_smfmac_f32_16x16x64_bf16 v[72:75], v[16:19], v[52:59], v1
    v_bitop3_b32 v20, v20, v52, s53 bitop3:0xf6
    v_bitop3_b32 v20, v20, v54, s53 bitop3:0xf6
    v_bitop3_b32 v20, v20, v56, s53 bitop3:0xf6
    v_bitop3_b32 v20, v20, v58, s53 bitop3:0xf6
    s_waitcnt vmcnt(1)
    v_bitop3_b32 v20, v20, v60, s53 bitop3:0xf6
    v_bitop3_b32 v20, v20, v62, s53 bitop3:0xf6
    s_waitcnt vmcnt(0)
    v_smfmac_f32_16x16x64_bf16 v[72:75], v[16:19], v[60:67], v1
    v_bitop3_b32 v20, v20, v64, s53 bitop3:0xf6
    v_bitop3_b32 v20, v20, v66, s53 bitop3:0xf6
    v_and_b32 v20, 1, v20
    v_cmp_ne_u32 vcc, 0, v20
    s_cbranch_vccnz L_pp_retry_r
L_pp_done_r:
    s_nop 2
    v_add_f32_dpp v72, v72, v72 row_ror:8 row_mask:0xf bank_mask:0xf
    v_add_f32_dpp v73, v73, v73 row_ror:8 row_mask:0xf bank_mask:0xf
    v_add_f32_dpp v74, v74, v74 row_ror:8 row_mask:0xf bank_mask:0xf
    v_add_f32_dpp v75, v75, v75 row_ror:8 row_mask:0xf bank_mask:0xf
    v_cvt_pk_bf16_f32 v72, v72, v73
    v_cvt_pk_bf16_f32 v73, v74, v75
    buffer_store_dwordx2 v[72:73], v9, s[8:11], s45 offen
    s_waitcnt vmcnt(0)
    s_barrier
    s_add_u32 s38, s38, 1
    s_cmp_lt_u32 s38, 64
    s_cbranch_scc1 L_loop_r
    s_branch L_exit_r
L_pm_r:
    s_mov_b64 exec, vcc
    buffer_load_dwordx4 v[16:19], v0, s[8:11], s54 offen sc1
    buffer_load_dwordx4 v[20:23], v0, s[8:11], s54 offen offset:1024 sc1
    buffer_load_dword v79, v10, s[8:11], s45 offen sc1
    s_add_u32 s59, s59, 1
    s_cmp_gt_u32 s59, 300000
    s_cbranch_scc1 L_pm_done_r
    s_branch L_pm_chk_r
L_pp_retry_r:
    s_mov_b64 exec, vcc
    buffer_load_dwordx4 v[52:55], v8, s[8:11], s64 offen sc1
    buffer_load_dwordx4 v[56:59], v8, s[8:11], s65 offen sc1
    buffer_load_dwordx4 v[60:63], v8, s[8:11], s66 offen sc1
    buffer_load_dwordx4 v[64:67], v8, s[8:11], s67 offen sc1
    s_mov_b64 exec, -1
    s_add_u32 s59, s59, 1
    s_cmp_gt_u32 s59, 300000
    s_cbranch_scc1 L_pp_done_r
    s_nop 3
    v_mov_b32 v20, 0
    v_mov_b64 v[72:73], 0
    v_mov_b64 v[74:75], 0
    s_branch L_pp_wait_r
L_exit_r:
    s_branch L_fin
L_slow_r:
    ds_read_b128 v[36:39], v2 offset:0
    ds_read_b128 v[40:43], v2 offset:1024
    ds_read_b128 v[44:47], v2 offset:2048
    ds_read_b128 v[48:51], v2 offset:3072
    ds_read_b128 v[24:27], v2 offset:4096
    ds_read_b128 v[28:31], v2 offset:5120
    s_add_u32 s54, s45, s68
    v_lshrrev_b32 v10, 2, v0
    v_add_u32 v10, s55, v10
    v_add_u32 v32, s68, v0
    v_add_u32 v76, s69, v0
    v_add_u32 v77, s70, v0
    v_add_u32 v78, s71, v0
    s_waitcnt lgkmcnt(0)
L_loop_rsc1:
    buffer_load_dwordx4 v[16:19], v0, s[8:11], s54 offen sc1
    buffer_load_dwordx4 v[20:23], v0, s[8:11], s54 offen offset:1024 sc1
    buffer_load_dword v79, v10, s[8:11], s45 offen sc1
    s_mov_b32 s46, s44
    s_mov_b32 s44, s45
    s_and_b32 s53, s38, 1
    v_mov_b64 v[52:53], 0
    v_mov_b64 v[54:55], 0
    v_mov_b64 v[56:57], 0
    v_mov_b64 v[58:59], 0
    v_mov_b64 v[60:61], 0
    v_mov_b64 v[62:63], 0
    v_mov_b64 v[64:65], 0
    v_mov_b64 v[66:67], 0
    v_mov_b64 v[68:69], 0
    v_mov_b64 v[70:71], 0
    v_mov_b64 v[72:73], 0
    v_mov_b64 v[74:75], 0
L_pm_chk_rsc1:
    s_waitcnt vmcnt(0)
    ds_write_b128 v32, v[16:19]
    v_max3_u32 v33, v16, v17, v18
    v_max3_u32 v34, v19, v20, v21
    ds_write_b128 v32, v[20:23] offset:1024
    v_max3_u32 v33, v33, v22, v23
    v_max3_u32 v33, v33, v34, v79
    ds_write_b32 v10, v79
    v_cmp_eq_u32 vcc, -1, v33
    s_cbranch_vccnz L_pm_rsc1
L_pm_done_rsc1:
    s_mov_b64 exec, -1
    v_smfmac_f32_16x16x64_bf16 v[52:55], v[16:19], v[36:43], v1
    ds_read_b128 v[36:39], v2 offset:6144
    ds_read_b128 v[40:43], v2 offset:7168
    v_smfmac_f32_16x16x64_bf16 v[56:59], v[16:19], v[44:51], v1
    ds_read_b128 v[44:47], v2 offset:8192
    ds_read_b128 v[48:51], v2 offset:9216
    v_smfmac_f32_16x16x64_bf16 v[60:63], v[16:19], v[24:31], v1
    v_smfmac_f32_16x16x64_bf16 v[64:67], v[16:19], a[0:7], v1
    s_waitcnt lgkmcnt(4)
    s_barrier
    ds_read_b128 v[24:27], v76 offset:0
    ds_read_b128 v[28:31], v76 offset:1024
    ds_read_b128 v[32:35], v77 offset:0
    v_smfmac_f32_16x16x64_bf16 v[52:55], v[20:23], a[8:15], v1
    v_smfmac_f32_16x16x64_bf16 v[56:59], v[20:23], a[16:23], v1
    v_smfmac_f32_16x16x64_bf16 v[60:63], v[20:23], a[24:31], v1
    v_smfmac_f32_16x16x64_bf16 v[68:71], v[16:19], a[200:207], v1
    v_smfmac_f32_16x16x64_bf16 v[72:75], v[16:19], a[208:215], v1
    v_smfmac_f32_16x16x64_bf16 v[68:71], v[20:23], a[216:223], v1
    v_smfmac_f32_16x16x64_bf16 v[72:75], v[20:23], a[224:231], v1
    s_waitcnt lgkmcnt(5)
    v_smfmac_f32_16x16x64_bf16 v[64:67], v[20:23], v[36:43], v1
    ds_read_b128 v[36:39], v2 offset:10240
    ds_read_b128 v[40:43], v2 offset:11264
    s_waitcnt lgkmcnt(4)
    v_smfmac_f32_16x16x64_bf16 v[52:55], v[24:27], a[32:39], v1
    buffer_load_dwordx4 v[16:19], v0, s[8:11], s50 offen
    v_smfmac_f32_16x16x64_bf16 v[56:59], v[24:27], a[40:47], v1
    s_add_u32 s40, s38, 1
    v_smfmac_f32_16x16x64_bf16 v[60:63], v[24:27], a[48:55], v1
    buffer_load_dwordx4 v[20:23], v0, s[8:11], s50 offen offset:1024
    v_smfmac_f32_16x16x64_bf16 v[64:67], v[24:27], v[44:51], v1
    ds_read_b128 v[44:47], v2 offset:12288
    ds_read_b128 v[48:51], v2 offset:13312
    ds_read_b128 v[24:27], v77 offset:1024
    s_waitcnt lgkmcnt(6)
    v_smfmac_f32_16x16x64_bf16 v[52:55], v[28:31], a[56:63], v1
    s_and_b32 s40, s40, 3
    v_smfmac_f32_16x16x64_bf16 v[56:59], v[28:31], a[64:71], v1
    s_mul_i32 s45, s40, 9216
    v_smfmac_f32_16x16x64_bf16 v[60:63], v[28:31], a[72:79], v1
    v_mov_b64 v[12:13], -1
    s_waitcnt lgkmcnt(3)
    v_smfmac_f32_16x16x64_bf16 v[64:67], v[28:31], v[36:43], v1
    ds_read_b128 v[36:39], v2 offset:14336
    ds_read_b128 v[40:43], v2 offset:15360
    ds_read_b128 v[28:31], v78 offset:0
    v_smfmac_f32_16x16x64_bf16 v[52:55], v[32:35], a[80:87], v1
    buffer_store_dwordx2 v[12:13], v9, s[8:11], s46 offen sc1
    v_smfmac_f32_16x16x64_bf16 v[56:59], v[32:35], a[88:95], v1
    s_add_u32 s45, s45, 61865984
    v_smfmac_f32_16x16x64_bf16 v[60:63], v[32:35], a[96:103], v1
    s_add_u32 s50, s50, 524288
    s_waitcnt lgkmcnt(4)
    v_smfmac_f32_16x16x64_bf16 v[64:67], v[32:35], v[44:51], v1
    ds_read_b128 v[44:47], v2 offset:16384
    ds_read_b128 v[48:51], v2 offset:17408
    ds_read_b128 v[32:35], v78 offset:1024
    s_waitcnt lgkmcnt(6)
    v_smfmac_f32_16x16x64_bf16 v[52:55], v[24:27], a[104:111], v1
    v_smfmac_f32_16x16x64_bf16 v[56:59], v[24:27], a[112:119], v1
    v_smfmac_f32_16x16x64_bf16 v[60:63], v[24:27], a[120:127], v1
    s_waitcnt lgkmcnt(4)
    v_smfmac_f32_16x16x64_bf16 v[64:67], v[24:27], v[36:43], v1
    ds_read_b128 v[36:39], v2 offset:18432
    ds_read_b128 v[40:43], v2 offset:19456
    ds_read_b128 v[24:27], v0 offset:8192
    s_waitcnt lgkmcnt(6)
    v_smfmac_f32_16x16x64_bf16 v[52:55], v[28:31], a[128:135], v1
    v_smfmac_f32_16x16x64_bf16 v[56:59], v[28:31], a[136:143], v1
    s_waitcnt lgkmcnt(4)
    v_smfmac_f32_16x16x64_bf16 v[64:67], v[28:31], v[44:51], v1
    ds_read_b128 v[44:47], v2 offset:20480
    ds_read_b128 v[48:51], v2 offset:21504
    s_waitcnt lgkmcnt(5)
    v_smfmac_f32_16x16x64_bf16 v[52:55], v[32:35], a[152:159], v1
    v_smfmac_f32_16x16x64_bf16 v[56:59], v[32:35], a[160:167], v1
    s_waitcnt lgkmcnt(3)
    v_smfmac_f32_16x16x64_bf16 v[64:67], v[32:35], v[36:43], v1
    s_waitcnt lgkmcnt(2)
    v_smfmac_f32_16x16x64_bf16 v[52:55], v[24:27], a[176:183], v1
    v_mov_b64 v[36:37], 0
    v_smfmac_f32_16x16x64_bf16 v[56:59], v[24:27], a[184:191], v1
    v_mov_b64 v[38:39], 0
    v_smfmac_f32_16x16x64_bf16 v[60:63], v[28:31], a[144:151], v1
    v_mov_b64 v[40:41], 0
    v_smfmac_f32_16x16x64_bf16 v[60:63], v[32:35], a[168:175], v1
    v_mov_b64 v[42:43], 0
    v_smfmac_f32_16x16x64_bf16 v[60:63], v[24:27], a[192:199], v1
    v_add_f32 v52, v52, v54
    s_waitcnt lgkmcnt(0)
    v_smfmac_f32_16x16x64_bf16 v[64:67], v[24:27], v[44:51], v1
    ds_read_b128 v[44:47], v2 offset:22528
    ds_read_b128 v[48:51], v2 offset:23552
    v_add_f32 v53, v53, v55
    v_add_f32 v56, v56, v58
    v_add_f32 v57, v57, v59
    v_cvt_pk_bf16_f32 v54, v52, v56
    v_cvt_pk_bf16_f32 v55, v53, v57
    ds_write2_b32 v3, v54, v55 offset0:0 offset1:16
    v_add_f32 v60, v60, v62
    v_add_f32 v61, v61, v63
    v_add_f32 v64, v64, v66
    v_add_f32 v65, v65, v67
    v_cvt_pk_bf16_f32 v12, v60, v64
    v_cvt_pk_bf16_f32 v13, v61, v65
    ds_write2_b32 v3, v12, v13 offset0:128 offset1:144
    s_mov_b64 exec, s[4:5]
    ds_read_b128 v[36:39], v4
    s_mov_b64 exec, s[6:7]
    ds_read_b128 v[40:43], v4
    s_mov_b64 exec, -1
    ds_read_b128 v[60:63], v5
    ds_read_b128 v[64:67], v5 offset:64
    v_smfmac_f32_16x16x64_bf16 v[68:71], v[32:35], v[232:239], v1
    v_add_u32 v76, s48, v0
    v_smfmac_f32_16x16x64_bf16 v[72:75], v[32:35], v[240:247], v1
    v_add_u32 v10, s69, v0
    ds_read_b128 v[32:35], v10 offset:0
    v_add_u32 v77, s49, v0
    s_waitcnt vmcnt(1)
    s_waitcnt lgkmcnt(4)
    v_mfma_f32_16x16x32_bf16 v[52:55], v[16:19], v[36:39], 0
    s_waitcnt lgkmcnt(2)
    v_mfma_f32_16x16x32_bf16 v[56:59], v[60:63], v[36:39], 0
    s_waitcnt lgkmcnt(1)
    v_mfma_f32_16x16x32_bf16 v[56:59], v[64:67], v[40:43], v[56:59]
    v_mfma_f32_16x16x32_bf16 v[52:55], v[20:23], v[40:43], v[52:55]
    buffer_load_dwordx4 v[16:19], v0, s[8:11], s51 offen
    v_smfmac_f32_16x16x64_bf16 v[68:71], v[28:31], v[224:231], v1
    ds_write_b32 v77, v56
    buffer_load_dwordx4 v[20:23], v0, s[8:11], s51 offen offset:1024
    v_smfmac_f32_16x16x64_bf16 v[68:71], v[24:27], v[248:255], v1
    ds_write_b128 v76, v[52:55]
    v_smfmac_f32_16x16x64_bf16 v[72:75], v[28:31], v[44:51], v1
    ds_read_b128 v[44:47], v2 offset:24576
    ds_read_b128 v[48:51], v2 offset:25600
    ds_read_b128 v[28:31], v10 offset:1024
    buffer_store_dwordx4 v[12:15], v0, s[8:11], s52 offen sc1
    s_waitcnt lgkmcnt(3)
    s_barrier
    ds_read_b128 v[52:55], v0 offset:9216
    ds_read_b128 v[56:59], v0 offset:10240
    ds_read_b128 v[60:63], v0 offset:11264
    ds_read_b128 v[64:67], v0 offset:12288
    ds_read_b128 v[36:39], v0 offset:13312
    v_smfmac_f32_16x16x64_bf16 v[68:71], v[32:35], a[232:239], v1
    v_mov_b64 v[40:41], 0
    v_lshlrev_b32 v13, 2, v0
    buffer_load_dword v12, v13, s[8:11], s73 offen
    s_add_u32 s73, s73, 524288
    v_smfmac_f32_16x16x64_bf16 v[72:75], v[32:35], a[240:247], v1
    v_add_u32 v10, s70, v0
    ds_read_b128 v[32:35], v10 offset:0
    v_mov_b64 v[42:43], 0
    s_waitcnt lgkmcnt(7)
    v_smfmac_f32_16x16x64_bf16 v[72:75], v[24:27], v[44:51], v1
    ds_read_b128 v[44:47], v2 offset:26624
    ds_read_b128 v[48:51], v2 offset:27648
    ds_read_b128 v[24:27], v10 offset:1024
    v_mov_b64 v[76:77], 0
    s_waitcnt lgkmcnt(9)
    v_smfmac_f32_16x16x64_bf16 v[68:71], v[28:31], a[248:255], v1
    v_mov_b64 v[78:79], 0
    s_add_u32 s51, s51, 524288
    s_add_u32 s52, s52, 131072
    s_waitcnt lgkmcnt(4)
    v_pk_add_f32 v[52:53], v[52:53], v[56:57]
    v_pk_add_f32 v[60:61], v[60:61], v[64:65]
    v_pk_add_f32 v[54:55], v[54:55], v[58:59]
    v_pk_add_f32 v[62:63], v[62:63], v[66:67]
    v_pk_add_f32 v[36:37], v[36:37], v[38:39]
    v_pk_add_f32 v[52:53], v[52:53], v[60:61]
    v_pk_add_f32 v[54:55], v[54:55], v[62:63]
    v_add_f32 v36, v36, v37
    v_max3_f32 v56, v52, v53, v54
    v_max3_f32 v56, v56, v55, v36
    s_waitcnt lgkmcnt(3)
    v_smfmac_f32_16x16x64_bf16 v[68:71], v[32:35], v[200:207], v1
    v_mov_b64 v[64:65], s[78:79]
    v_max_f32_dpp v56, v56, v56 quad_perm:[2,3,0,1] row_mask:0xf bank_mask:0xf
    v_mov_b32 v57, v56
    v_smfmac_f32_16x16x64_bf16 v[72:75], v[32:35], v[208:215], v1
    v_mov_b64 v[66:67], s[78:79]
    v_permlane16_swap_b32 v57, v56
    v_max_f32 v56, v56, v57
    v_mov_b32 v57, v56
    s_waitcnt lgkmcnt(1)
    v_smfmac_f32_16x16x64_bf16 v[72:75], v[28:31], v[44:51], v1
    ds_read_b128 v[44:47], v2 offset:28672
    ds_read_b128 v[48:51], v2 offset:29696
    v_mov_b32 v63, 0
    v_permlane32_swap_b32 v57, v56
    v_max_f32 v56, v56, v57
    s_waitcnt lgkmcnt(2)
    v_smfmac_f32_16x16x64_bf16 v[68:71], v[24:27], v[216:223], v1
    v_mul_f32 v56, s56, v56
    v_fma_f32 v52, v52, s56, -v56
    v_fma_f32 v53, v53, s56, -v56
    v_fma_f32 v54, v54, s56, -v56
    v_fma_f32 v55, v55, s56, -v56
    v_fma_f32 v36, v36, s56, -v56
    s_waitcnt lgkmcnt(0)
    v_smfmac_f32_16x16x64_bf16 v[72:75], v[24:27], v[44:51], v1
    ds_read_b128 v[44:47], v2 offset:30720
    ds_read_b128 v[48:51], v2 offset:31744
    v_exp_f32 v52, v52
    v_exp_f32 v53, v53
    v_exp_f32 v54, v54
    v_exp_f32 v55, v55
    v_exp_f32 v36, v36
    v_cvt_pk_bf16_f32 v60, v52, v53
    v_cvt_pk_bf16_f32 v61, v54, v55
    v_cvt_pk_bf16_f32 v62, v36, v63
    s_waitcnt vmcnt(2)
    v_smfmac_f32_16x16x32_bf16 v[40:43], v[60:61], v[16:19], v1
    v_add_f32 v68, v68, v70
    v_add_f32 v69, v69, v71
    v_smfmac_f32_16x16x32_bf16 v[76:79], v[60:61], v[20:23], v1
    v_add_f32 v72, v72, v74
    v_add_f32 v73, v73, v75
    v_mfma_f32_16x16x32_bf16 v[32:35], v[60:63], v[64:67], 0
    v_cvt_pk_bf16_f32 v68, v68, v69
    v_cvt_pk_bf16_f32 v69, v72, v73
    v_cvt_pk_bf16_f32 v70, v72, v73
    v_mov_b32 v71, 0
    v_mov_b32 v72, 0
    ds_read_b128 v[24:27], v2 offset:32768
    ds_read_b128 v[28:31], v2 offset:33792
    v_smfmac_f32_16x16x32_bf16 v[40:43], v[62:63], v[68:71], v1 abid:2
    ds_read_b128 v[16:19], v2 offset:34816
    ds_read_b128 v[20:23], v2 offset:35840
    v_add_f32 v32, v32, v34
    v_smfmac_f32_16x16x32_bf16 v[76:79], v[62:63], v[70:73], v1 abid:2
    v_add_f32 v33, v33, v35
    v_rcp_f32 v32, v32
    v_rcp_f32 v33, v33
    v_mov_b64 v[14:15], v[68:69]
    s_cmp_eq_u32 s38, 63
    s_cbranch_scc1 L_exit_rsc1
    v_mov_b64 v[36:37], 0
    v_mov_b64 v[38:39], 0
    v_add_f32 v40, v40, v42
    v_add_f32 v41, v41, v43
    v_add_f32 v76, v76, v78
    v_add_f32 v77, v77, v79
    v_pk_mul_f32 v[40:41], v[40:41], v[32:33]
    v_pk_mul_f32 v[76:77], v[76:77], v[32:33]
    v_cvt_pk_bf16_f32 v34, v40, v76
    v_cvt_pk_bf16_f32 v35, v41, v77
    ds_write2_b32 v6, v34, v35 offset0:0 offset1:4
    v_and_b32 v10, 32, v0
    v_lshl_add_u32 v10, v10, 5, v11
    v_mov_b64 v[40:41], 0
    v_mov_b64 v[42:43], 0
    v_mov_b64 v[76:77], 0
    v_mov_b64 v[78:79], 0
    s_waitcnt lgkmcnt(0)
    s_barrier
    ds_read_b128 v[52:55], v11 offset:0
    ds_read_b128 v[56:59], v11 offset:512
    ds_read_b128 v[60:63], v11 offset:1024
    ds_read_b128 v[64:67], v11 offset:1536
    ds_read_b128 v[68:71], v10 offset:0
    ds_read_b128 v[72:75], v10 offset:512
    v_mov_b64 v[32:33], 0
    v_mov_b64 v[34:35], 0
    s_waitcnt lgkmcnt(5)
    v_smfmac_f32_16x16x64_bf16 v[40:43], v[52:55], v[88:95], v1
    v_smfmac_f32_16x16x64_bf16 v[76:79], v[52:55], v[96:103], v1
    s_waitcnt lgkmcnt(4)
    v_smfmac_f32_16x16x64_bf16 v[40:43], v[56:59], v[24:31], v1
    v_smfmac_f32_16x16x64_bf16 v[76:79], v[56:59], v[120:127], v1
    v_mov_b64 v[24:25], 0
    s_waitcnt lgkmcnt(3)
    v_smfmac_f32_16x16x64_bf16 v[40:43], v[60:63], v[144:151], v1
    v_mov_b64 v[26:27], 0
    s_waitcnt lgkmcnt(2)
    v_smfmac_f32_16x16x64_bf16 v[40:43], v[64:67], v[16:23], v1
    v_smfmac_f32_16x16x64_bf16 v[76:79], v[60:63], v[152:159], v1
    v_smfmac_f32_16x16x64_bf16 v[76:79], v[64:67], v[176:183], v1
    s_waitcnt lgkmcnt(1)
    v_smfmac_f32_16x16x64_bf16 v[36:39], v[68:71], v[80:87], v1
    v_cvt_pk_bf16_f32 v40, v40, v42
    s_waitcnt lgkmcnt(0)
    v_smfmac_f32_16x16x64_bf16 v[36:39], v[72:75], v[44:51], v1
    v_cvt_pk_bf16_f32 v42, v41, v43
    v_smfmac_f32_16x16x64_bf16 v[32:35], v[52:55], v[104:111], v1
    v_and_or_b32 v40, v40, -2, s53
    v_and_or_b32 v42, v42, -2, s53
    v_smfmac_f32_16x16x64_bf16 v[32:35], v[56:59], v[128:135], v1
    v_cvt_pk_bf16_f32 v41, v76, v78
    v_smfmac_f32_16x16x64_bf16 v[32:35], v[60:63], v[160:167], v1
    v_cvt_pk_bf16_f32 v43, v77, v79
    buffer_store_dwordx4 v[40:43], v0, s[8:11], s47 offen offset:0 sc1
    v_add_f32 v36, v36, v38
    v_smfmac_f32_16x16x64_bf16 v[32:35], v[64:67], v[184:191], v1
    v_add_f32 v37, v37, v39
    v_cndmask_b32 v38, v36, v37, s[76:77]
    v_smfmac_f32_16x16x64_bf16 v[24:27], v[52:55], v[112:119], v1
    s_nop 0
    v_mov_b32_dpp v39, v38 quad_perm:[1,0,3,2] row_mask:0xf bank_mask:0xf
    v_cndmask_b32 v36, v39, v36, s[76:77]
    v_smfmac_f32_16x16x64_bf16 v[24:27], v[56:59], v[136:143], v1
    v_cndmask_b32 v37, v37, v39, s[76:77]
    v_smfmac_f32_16x16x64_bf16 v[24:27], v[60:63], v[168:175], v1
    v_cvt_pk_bf16_f32 v36, v36, v37
    v_and_or_b32 v36, v36, -2, s53
    v_smfmac_f32_16x16x64_bf16 v[24:27], v[64:67], v[192:199], v1
    buffer_store_dword v36, v7, s[8:11], s47 offen sc1
    v_cvt_pk_bf16_f32 v32, v32, v34
    v_cvt_pk_bf16_f32 v34, v33, v35
    v_and_or_b32 v32, v32, -2, s53
    v_and_or_b32 v34, v34, -2, s53
    s_nop 2
    v_cvt_pk_bf16_f32 v33, v24, v26
    v_cvt_pk_bf16_f32 v35, v25, v27
    buffer_store_dwordx4 v[32:35], v0, s[8:11], s47 offen offset:1024 sc1
    ds_read_b128 v[36:39], v2 offset:0
    ds_read_b128 v[40:43], v2 offset:1024
    ds_read_b128 v[44:47], v2 offset:2048
    ds_read_b128 v[48:51], v2 offset:3072
    ds_read_b128 v[24:27], v2 offset:4096
    ds_read_b128 v[28:31], v2 offset:5120
    s_add_u32 s54, s45, s68
    v_lshrrev_b32 v10, 2, v0
    v_add_u32 v10, s55, v10
    v_add_u32 v32, s68, v0
    v_add_u32 v76, s69, v0
    v_add_u32 v77, s70, v0
    v_add_u32 v78, s71, v0
    s_waitcnt lgkmcnt(0)
    v_mov_b32 v18, 0x3f80
    v_mov_b32 v19, 0x3f800000
    v_cndmask_b32 v18, v19, v18, s[76:77]
    v_cndmask_b32 v16, 0, v18, s[100:101]
    v_cndmask_b32 v17, 0, v18, s[2:3]
    v_mov_b64 v[18:19], v[16:17]
    v_mov_b64 v[72:73], 0
    v_mov_b64 v[74:75], 0
    v_mov_b64 v[20:21], 0
    s_waitcnt vmcnt(2)
    s_cmp_eq_u32 s37, 0
    s_cbranch_scc1 L_ew_rsc1
    s_waitcnt vmcnt(0)
L_ew_rsc1:
    buffer_load_dwordx4 v[52:55], v8, s[8:11], s64 offen sc1
    buffer_load_dwordx4 v[56:59], v8, s[8:11], s65 offen sc1
    buffer_load_dwordx4 v[60:63], v8, s[8:11], s66 offen sc1
    buffer_load_dwordx4 v[64:67], v8, s[8:11], s67 offen sc1
L_pp_wait_rsc1:
    s_waitcnt vmcnt(2)
    v_smfmac_f32_16x16x64_bf16 v[72:75], v[16:19], v[52:59], v1
    v_bitop3_b32 v20, v20, v52, s53 bitop3:0xf6
    v_bitop3_b32 v20, v20, v54, s53 bitop3:0xf6
    v_bitop3_b32 v20, v20, v56, s53 bitop3:0xf6
    v_bitop3_b32 v20, v20, v58, s53 bitop3:0xf6
    s_waitcnt vmcnt(1)
    v_bitop3_b32 v20, v20, v60, s53 bitop3:0xf6
    v_bitop3_b32 v20, v20, v62, s53 bitop3:0xf6
    s_waitcnt vmcnt(0)
    v_smfmac_f32_16x16x64_bf16 v[72:75], v[16:19], v[60:67], v1
    v_bitop3_b32 v20, v20, v64, s53 bitop3:0xf6
    v_bitop3_b32 v20, v20, v66, s53 bitop3:0xf6
    v_and_b32 v20, 1, v20
    v_cmp_ne_u32 vcc, 0, v20
    s_cbranch_vccnz L_pp_retry_rsc1
L_pp_done_rsc1:
    s_nop 2
    v_add_f32_dpp v72, v72, v72 row_ror:8 row_mask:0xf bank_mask:0xf
    v_add_f32_dpp v73, v73, v73 row_ror:8 row_mask:0xf bank_mask:0xf
    v_add_f32_dpp v74, v74, v74 row_ror:8 row_mask:0xf bank_mask:0xf
    v_add_f32_dpp v75, v75, v75 row_ror:8 row_mask:0xf bank_mask:0xf
    v_cvt_pk_bf16_f32 v72, v72, v73
    v_cvt_pk_bf16_f32 v73, v74, v75
    buffer_store_dwordx2 v[72:73], v9, s[8:11], s45 offen sc1
    s_waitcnt vmcnt(0)
    s_barrier
    s_add_u32 s38, s38, 1
    s_cmp_lt_u32 s38, 64
    s_cbranch_scc1 L_loop_rsc1
    s_branch L_exit_rsc1
L_pm_rsc1:
    s_mov_b64 exec, vcc
    buffer_load_dwordx4 v[16:19], v0, s[8:11], s54 offen sc1
    buffer_load_dwordx4 v[20:23], v0, s[8:11], s54 offen offset:1024 sc1
    buffer_load_dword v79, v10, s[8:11], s45 offen sc1
    s_add_u32 s59, s59, 1
    s_cmp_gt_u32 s59, 300000
    s_cbranch_scc1 L_pm_done_rsc1
    s_branch L_pm_chk_rsc1
L_pp_retry_rsc1:
    s_mov_b64 exec, vcc
    buffer_load_dwordx4 v[52:55], v8, s[8:11], s64 offen sc1
    buffer_load_dwordx4 v[56:59], v8, s[8:11], s65 offen sc1
    buffer_load_dwordx4 v[60:63], v8, s[8:11], s66 offen sc1
    buffer_load_dwordx4 v[64:67], v8, s[8:11], s67 offen sc1
    s_mov_b64 exec, -1
    s_add_u32 s59, s59, 1
    s_cmp_gt_u32 s59, 300000
    s_cbranch_scc1 L_pp_done_rsc1
    s_nop 3
    v_mov_b32 v20, 0
    v_mov_b64 v[72:73], 0
    v_mov_b64 v[74:75], 0
    s_branch L_pp_wait_rsc1
L_exit_rsc1:
    s_branch L_fin
L_step_q:
    s_cmp_lt_u32 s41, 32
    s_cbranch_scc1 L_slow_q
    ds_read_b128 v[36:39], v2 offset:0
    ds_read_b128 v[40:43], v2 offset:1024
    ds_read_b128 v[44:47], v2 offset:2048
    ds_read_b128 v[48:51], v2 offset:3072
    ds_read_b128 v[24:27], v2 offset:4096
    ds_read_b128 v[28:31], v2 offset:5120
    s_add_u32 s54, s45, s68
    v_lshrrev_b32 v10, 2, v0
    v_add_u32 v10, s55, v10
    v_add_u32 v32, s68, v0
    v_add_u32 v76, s69, v0
    v_add_u32 v77, s70, v0
    v_add_u32 v78, s71, v0
    s_waitcnt lgkmcnt(0)
L_loop_q:
    buffer_load_dwordx4 v[16:19], v0, s[8:11], s54 offen sc1
    buffer_load_dwordx4 v[20:23], v0, s[8:11], s54 offen offset:1024 sc1
    buffer_load_dword v79, v10, s[8:11], s45 offen sc1
    s_mov_b32 s46, s44
    s_mov_b32 s44, s45
    s_and_b32 s53, s38, 1
    v_mov_b64 v[52:53], 0
    v_mov_b64 v[54:55], 0
    v_mov_b64 v[56:57], 0
    v_mov_b64 v[58:59], 0
    v_mov_b64 v[60:61], 0
    v_mov_b64 v[62:63], 0
    v_mov_b64 v[64:65], 0
    v_mov_b64 v[66:67], 0
    v_mov_b64 v[68:69], 0
    v_mov_b64 v[70:71], 0
    v_mov_b64 v[72:73], 0
    v_mov_b64 v[74:75], 0
L_pm_chk_q:
    s_waitcnt vmcnt(0)
    ds_write_b128 v32, v[16:19]
    v_max3_u32 v33, v16, v17, v18
    v_max3_u32 v34, v19, v20, v21
    ds_write_b128 v32, v[20:23] offset:1024
    v_max3_u32 v33, v33, v22, v23
    v_max3_u32 v33, v33, v34, v79
    ds_write_b32 v10, v79
    v_cmp_eq_u32 vcc, -1, v33
    s_cbranch_vccnz L_pm_q
L_pm_done_q:
    s_mov_b64 exec, -1
    v_smfmac_f32_16x16x64_bf16 v[52:55], v[16:19], v[36:43], v1
    ds_read_b128 v[36:39], v2 offset:6144
    ds_read_b128 v[40:43], v2 offset:7168
    v_smfmac_f32_16x16x64_bf16 v[56:59], v[16:19], v[44:51], v1
    ds_read_b128 v[44:47], v2 offset:8192
    ds_read_b128 v[48:51], v2 offset:9216
    v_smfmac_f32_16x16x64_bf16 v[60:63], v[16:19], v[24:31], v1
    v_smfmac_f32_16x16x64_bf16 v[64:67], v[16:19], a[0:7], v1
    s_waitcnt lgkmcnt(4)
    s_barrier
    ds_read_b128 v[24:27], v76 offset:0
    ds_read_b128 v[28:31], v76 offset:1024
    ds_read_b128 v[32:35], v77 offset:0
    v_smfmac_f32_16x16x64_bf16 v[52:55], v[20:23], a[8:15], v1
    v_smfmac_f32_16x16x64_bf16 v[56:59], v[20:23], a[16:23], v1
    v_smfmac_f32_16x16x64_bf16 v[60:63], v[20:23], a[24:31], v1
    v_smfmac_f32_16x16x64_bf16 v[68:71], v[16:19], a[200:207], v1
    v_smfmac_f32_16x16x64_bf16 v[72:75], v[16:19], a[208:215], v1
    v_smfmac_f32_16x16x64_bf16 v[68:71], v[20:23], a[216:223], v1
    v_smfmac_f32_16x16x64_bf16 v[72:75], v[20:23], a[224:231], v1
    s_waitcnt lgkmcnt(5)
    v_smfmac_f32_16x16x64_bf16 v[64:67], v[20:23], v[36:43], v1
    ds_read_b128 v[36:39], v2 offset:10240
    ds_read_b128 v[40:43], v2 offset:11264
    s_waitcnt lgkmcnt(4)
    v_smfmac_f32_16x16x64_bf16 v[52:55], v[24:27], a[32:39], v1
    buffer_load_dwordx4 v[16:19], v0, s[8:11], s50 offen
    v_smfmac_f32_16x16x64_bf16 v[56:59], v[24:27], a[40:47], v1
    s_add_u32 s40, s38, 1
    v_smfmac_f32_16x16x64_bf16 v[60:63], v[24:27], a[48:55], v1
    buffer_load_dwordx4 v[20:23], v0, s[8:11], s50 offen offset:1024
    v_smfmac_f32_16x16x64_bf16 v[64:67], v[24:27], v[44:51], v1
    ds_read_b128 v[44:47], v2 offset:12288
    ds_read_b128 v[48:51], v2 offset:13312
    ds_read_b128 v[24:27], v77 offset:1024
    s_waitcnt lgkmcnt(6)
    v_smfmac_f32_16x16x64_bf16 v[52:55], v[28:31], a[56:63], v1
    s_and_b32 s40, s40, 3
    v_smfmac_f32_16x16x64_bf16 v[56:59], v[28:31], a[64:71], v1
    s_mul_i32 s45, s40, 9216
    v_smfmac_f32_16x16x64_bf16 v[60:63], v[28:31], a[72:79], v1
    v_mov_b64 v[12:13], -1
    s_waitcnt lgkmcnt(3)
    v_smfmac_f32_16x16x64_bf16 v[64:67], v[28:31], v[36:43], v1
    ds_read_b128 v[36:39], v2 offset:14336
    ds_read_b128 v[40:43], v2 offset:15360
    ds_read_b128 v[28:31], v78 offset:0
    v_smfmac_f32_16x16x64_bf16 v[52:55], v[32:35], a[80:87], v1
    buffer_store_dwordx2 v[12:13], v9, s[8:11], s46 offen
    v_smfmac_f32_16x16x64_bf16 v[56:59], v[32:35], a[88:95], v1
    s_add_u32 s45, s45, 61865984
    v_smfmac_f32_16x16x64_bf16 v[60:63], v[32:35], a[96:103], v1
    s_add_u32 s50, s50, 524288
    s_waitcnt lgkmcnt(4)
    v_smfmac_f32_16x16x64_bf16 v[64:67], v[32:35], v[44:51], v1
    ds_read_b128 v[44:47], v2 offset:16384
    ds_read_b128 v[48:51], v2 offset:17408
    ds_read_b128 v[32:35], v78 offset:1024
    s_waitcnt lgkmcnt(6)
    v_smfmac_f32_16x16x64_bf16 v[52:55], v[24:27], a[104:111], v1
    v_smfmac_f32_16x16x64_bf16 v[56:59], v[24:27], a[112:119], v1
    v_smfmac_f32_16x16x64_bf16 v[60:63], v[24:27], a[120:127], v1
    s_waitcnt lgkmcnt(4)
    v_smfmac_f32_16x16x64_bf16 v[64:67], v[24:27], v[36:43], v1
    ds_read_b128 v[36:39], v2 offset:18432
    ds_read_b128 v[40:43], v2 offset:19456
    ds_read_b128 v[24:27], v0 offset:8192
    s_waitcnt lgkmcnt(6)
    v_smfmac_f32_16x16x64_bf16 v[52:55], v[28:31], a[128:135], v1
    v_smfmac_f32_16x16x64_bf16 v[56:59], v[28:31], a[136:143], v1
    s_waitcnt lgkmcnt(4)
    v_smfmac_f32_16x16x64_bf16 v[64:67], v[28:31], v[44:51], v1
    ds_read_b128 v[44:47], v2 offset:20480
    ds_read_b128 v[48:51], v2 offset:21504
    s_waitcnt lgkmcnt(5)
    v_smfmac_f32_16x16x64_bf16 v[52:55], v[32:35], a[152:159], v1
    v_smfmac_f32_16x16x64_bf16 v[56:59], v[32:35], a[160:167], v1
    s_waitcnt lgkmcnt(3)
    v_smfmac_f32_16x16x64_bf16 v[64:67], v[32:35], v[36:43], v1
    s_waitcnt lgkmcnt(2)
    v_smfmac_f32_16x16x64_bf16 v[52:55], v[24:27], a[176:183], v1
    v_mov_b64 v[36:37], 0
    v_smfmac_f32_16x16x64_bf16 v[56:59], v[24:27], a[184:191], v1
    v_mov_b64 v[38:39], 0
    v_smfmac_f32_16x16x64_bf16 v[60:63], v[28:31], a[144:151], v1
    v_mov_b64 v[40:41], 0
    v_smfmac_f32_16x16x64_bf16 v[60:63], v[32:35], a[168:175], v1
    v_mov_b64 v[42:43], 0
    v_smfmac_f32_16x16x64_bf16 v[60:63], v[24:27], a[192:199], v1
    v_add_f32 v52, v52, v54
    s_waitcnt lgkmcnt(0)
    v_smfmac_f32_16x16x64_bf16 v[64:67], v[24:27], v[44:51], v1
    ds_read_b128 v[44:47], v2 offset:22528
    ds_read_b128 v[48:51], v2 offset:23552
    v_add_f32 v53, v53, v55
    v_add_f32 v56, v56, v58
    v_add_f32 v57, v57, v59
    v_cvt_pk_bf16_f32 v54, v52, v56
    v_cvt_pk_bf16_f32 v55, v53, v57
    ds_write2_b32 v3, v54, v55 offset0:0 offset1:16
    v_add_f32 v60, v60, v62
    v_add_f32 v61, v61, v63
    v_add_f32 v64, v64, v66
    v_add_f32 v65, v65, v67
    v_cvt_pk_bf16_f32 v12, v60, v64
    v_cvt_pk_bf16_f32 v13, v61, v65
    ds_write2_b32 v3, v12, v13 offset0:128 offset1:144
    s_mov_b64 exec, s[4:5]
    ds_read_b128 v[36:39], v4
    s_mov_b64 exec, s[6:7]
    ds_read_b128 v[40:43], v4
    s_mov_b64 exec, -1
    ds_read_b128 v[60:63], v5
    ds_read_b128 v[64:67], v5 offset:64
    v_smfmac_f32_16x16x64_bf16 v[68:71], v[32:35], v[232:239], v1
    v_add_u32 v76, s48, v0
    v_smfmac_f32_16x16x64_bf16 v[72:75], v[32:35], v[240:247], v1
    v_add_u32 v10, s69, v0
    ds_read_b128 v[32:35], v10 offset:0
    v_add_u32 v77, s49, v0
    s_waitcnt vmcnt(1)
    s_waitcnt lgkmcnt(4)
    v_mfma_f32_16x16x32_bf16 v[52:55], v[16:19], v[36:39], 0
    s_waitcnt lgkmcnt(2)
    v_mfma_f32_16x16x32_bf16 v[56:59], v[60:63], v[36:39], 0
    s_waitcnt lgkmcnt(1)
    v_mfma_f32_16x16x32_bf16 v[56:59], v[64:67], v[40:43], v[56:59]
    v_mfma_f32_16x16x32_bf16 v[52:55], v[20:23], v[40:43], v[52:55]
    buffer_load_dwordx4 v[16:19], v0, s[8:11], s51 offen
    v_smfmac_f32_16x16x64_bf16 v[68:71], v[28:31], v[224:231], v1
    ds_write_b32 v77, v56
    buffer_load_dwordx4 v[20:23], v0, s[8:11], s51 offen offset:1024
    v_smfmac_f32_16x16x64_bf16 v[68:71], v[24:27], v[248:255], v1
    ds_write_b128 v76, v[52:55]
    v_smfmac_f32_16x16x64_bf16 v[72:75], v[28:31], v[44:51], v1
    ds_read_b128 v[44:47], v2 offset:24576
    ds_read_b128 v[48:51], v2 offset:25600
    ds_read_b128 v[28:31], v10 offset:1024
    buffer_store_dwordx4 v[12:15], v0, s[8:11], s52 offen sc1
    s_waitcnt lgkmcnt(3)
    s_barrier
    ds_read_b128 v[52:55], v0 offset:9216
    ds_read_b128 v[56:59], v0 offset:10240
    ds_read_b128 v[60:63], v0 offset:11264
    ds_read_b128 v[64:67], v0 offset:12288
    ds_read_b128 v[36:39], v0 offset:13312
    v_smfmac_f32_16x16x64_bf16 v[68:71], v[32:35], a[232:239], v1
    v_mov_b64 v[40:41], 0
    v_lshlrev_b32 v13, 2, v0
    buffer_load_dword v12, v13, s[8:11], s73 offen
    s_add_u32 s73, s73, 524288
    v_smfmac_f32_16x16x64_bf16 v[72:75], v[32:35], a[240:247], v1
    v_add_u32 v10, s70, v0
    ds_read_b128 v[32:35], v10 offset:0
    v_mov_b64 v[42:43], 0
    s_waitcnt lgkmcnt(7)
    v_smfmac_f32_16x16x64_bf16 v[72:75], v[24:27], v[44:51], v1
    ds_read_b128 v[44:47], v2 offset:26624
    ds_read_b128 v[48:51], v2 offset:27648
    ds_read_b128 v[24:27], v10 offset:1024
    v_mov_b64 v[76:77], 0
    s_waitcnt lgkmcnt(9)
    v_smfmac_f32_16x16x64_bf16 v[68:71], v[28:31], a[248:255], v1
    v_mov_b64 v[78:79], 0
    s_add_u32 s51, s51, 524288
    s_add_u32 s52, s52, 131072
    s_waitcnt lgkmcnt(4)
    v_pk_add_f32 v[52:53], v[52:53], v[56:57]
    v_pk_add_f32 v[60:61], v[60:61], v[64:65]
    v_pk_add_f32 v[54:55], v[54:55], v[58:59]
    v_pk_add_f32 v[62:63], v[62:63], v[66:67]
    v_pk_add_f32 v[36:37], v[36:37], v[38:39]
    v_pk_add_f32 v[52:53], v[52:53], v[60:61]
    v_pk_add_f32 v[54:55], v[54:55], v[62:63]
    v_add_f32 v36, v36, v37
    v_max3_f32 v56, v52, v53, v54
    v_max3_f32 v56, v56, v55, v36
    s_waitcnt lgkmcnt(3)
    v_smfmac_f32_16x16x64_bf16 v[68:71], v[32:35], v[200:207], v1
    v_mov_b64 v[64:65], s[78:79]
    v_max_f32_dpp v56, v56, v56 quad_perm:[2,3,0,1] row_mask:0xf bank_mask:0xf
    v_mov_b32 v57, v56
    v_smfmac_f32_16x16x64_bf16 v[72:75], v[32:35], v[208:215], v1
    v_mov_b64 v[66:67], s[78:79]
    v_permlane16_swap_b32 v57, v56
    v_max_f32 v56, v56, v57
    v_mov_b32 v57, v56
    s_waitcnt lgkmcnt(1)
    v_smfmac_f32_16x16x64_bf16 v[72:75], v[28:31], v[44:51], v1
    ds_read_b128 v[44:47], v2 offset:28672
    ds_read_b128 v[48:51], v2 offset:29696
    v_mov_b32 v63, 0
    v_permlane32_swap_b32 v57, v56
    v_max_f32 v56, v56, v57
    s_waitcnt lgkmcnt(2)
    v_smfmac_f32_16x16x64_bf16 v[68:71], v[24:27], v[216:223], v1
    v_mul_f32 v56, s56, v56
    v_fma_f32 v52, v52, s56, -v56
    v_fma_f32 v53, v53, s56, -v56
    v_fma_f32 v54, v54, s56, -v56
    v_fma_f32 v55, v55, s56, -v56
    v_fma_f32 v36, v36, s56, -v56
    s_waitcnt lgkmcnt(0)
    v_smfmac_f32_16x16x64_bf16 v[72:75], v[24:27], v[44:51], v1
    ds_read_b128 v[44:47], v2 offset:30720
    ds_read_b128 v[48:51], v2 offset:31744
    v_exp_f32 v52, v52
    v_exp_f32 v53, v53
    v_exp_f32 v54, v54
    v_exp_f32 v55, v55
    v_exp_f32 v36, v36
    v_cvt_pk_bf16_f32 v60, v52, v53
    v_cvt_pk_bf16_f32 v61, v54, v55
    v_cvt_pk_bf16_f32 v62, v36, v63
    s_waitcnt vmcnt(2)
    v_smfmac_f32_16x16x32_bf16 v[40:43], v[60:61], v[16:19], v1
    v_add_f32 v68, v68, v70
    v_add_f32 v69, v69, v71
    v_smfmac_f32_16x16x32_bf16 v[76:79], v[60:61], v[20:23], v1
    v_add_f32 v72, v72, v74
    v_add_f32 v73, v73, v75
    v_mfma_f32_16x16x32_bf16 v[32:35], v[60:63], v[64:67], 0
    v_cvt_pk_bf16_f32 v68, v68, v69
    v_cvt_pk_bf16_f32 v69, v72, v73
    v_cvt_pk_bf16_f32 v70, v72, v73
    v_mov_b32 v71, 0
    v_mov_b32 v72, 0
    ds_read_b128 v[24:27], v2 offset:32768
    ds_read_b128 v[28:31], v2 offset:33792
    v_smfmac_f32_16x16x32_bf16 v[40:43], v[62:63], v[68:71], v1 abid:2
    ds_read_b128 v[16:19], v2 offset:34816
    ds_read_b128 v[20:23], v2 offset:35840
    v_add_f32 v32, v32, v34
    v_smfmac_f32_16x16x32_bf16 v[76:79], v[62:63], v[70:73], v1 abid:2
    v_add_f32 v33, v33, v35
    v_rcp_f32 v32, v32
    v_rcp_f32 v33, v33
    v_mov_b64 v[14:15], v[68:69]
    s_cmp_eq_u32 s38, 63
    s_cbranch_scc1 L_exit_q
    v_mov_b64 v[36:37], 0
    v_mov_b64 v[38:39], 0
    v_add_f32 v40, v40, v42
    v_add_f32 v41, v41, v43
    v_add_f32 v76, v76, v78
    v_add_f32 v77, v77, v79
    v_pk_mul_f32 v[40:41], v[40:41], v[32:33]
    v_pk_mul_f32 v[76:77], v[76:77], v[32:33]
    v_cvt_pk_bf16_f32 v34, v40, v76
    v_cvt_pk_bf16_f32 v35, v41, v77
    ds_write2_b32 v6, v34, v35 offset0:0 offset1:4
    v_and_b32 v10, 32, v0
    v_lshl_add_u32 v10, v10, 5, v11
    v_mov_b64 v[40:41], 0
    v_mov_b64 v[42:43], 0
    v_mov_b64 v[76:77], 0
    v_mov_b64 v[78:79], 0
    s_waitcnt lgkmcnt(0)
    s_barrier
    ds_read_b128 v[52:55], v11 offset:0
    ds_read_b128 v[56:59], v11 offset:512
    ds_read_b128 v[60:63], v11 offset:1024
    ds_read_b128 v[64:67], v11 offset:1536
    ds_read_b128 v[68:71], v10 offset:0
    ds_read_b128 v[72:75], v10 offset:512
    v_mov_b64 v[32:33], 0
    v_mov_b64 v[34:35], 0
    s_waitcnt lgkmcnt(5)
    v_smfmac_f32_16x16x64_bf16 v[40:43], v[52:55], v[88:95], v1
    v_smfmac_f32_16x16x64_bf16 v[76:79], v[52:55], v[96:103], v1
    s_waitcnt lgkmcnt(4)
    v_smfmac_f32_16x16x64_bf16 v[40:43], v[56:59], v[24:31], v1
    v_smfmac_f32_16x16x64_bf16 v[76:79], v[56:59], v[120:127], v1
    v_mov_b64 v[24:25], 0
    s_waitcnt lgkmcnt(3)
    v_smfmac_f32_16x16x64_bf16 v[40:43], v[60:63], v[144:151], v1
    v_mov_b64 v[26:27], 0
    s_waitcnt lgkmcnt(2)
    v_smfmac_f32_16x16x64_bf16 v[40:43], v[64:67], v[16:23], v1
    v_smfmac_f32_16x16x64_bf16 v[76:79], v[60:63], v[152:159], v1
    v_smfmac_f32_16x16x64_bf16 v[76:79], v[64:67], v[176:183], v1
    s_waitcnt lgkmcnt(1)
    v_smfmac_f32_16x16x64_bf16 v[36:39], v[68:71], v[80:87], v1
    v_cvt_pk_bf16_f32 v40, v40, v42
    s_waitcnt lgkmcnt(0)
    v_smfmac_f32_16x16x64_bf16 v[36:39], v[72:75], v[44:51], v1
    v_cvt_pk_bf16_f32 v42, v41, v43
    v_smfmac_f32_16x16x64_bf16 v[32:35], v[52:55], v[104:111], v1
    v_and_or_b32 v40, v40, -2, s53
    v_and_or_b32 v42, v42, -2, s53
    v_smfmac_f32_16x16x64_bf16 v[32:35], v[56:59], v[128:135], v1
    v_cvt_pk_bf16_f32 v41, v76, v78
    v_smfmac_f32_16x16x64_bf16 v[32:35], v[60:63], v[160:167], v1
    v_cvt_pk_bf16_f32 v43, v77, v79
    buffer_store_dwordx4 v[40:43], v0, s[8:11], s47 offen offset:0
    v_add_f32 v36, v36, v38
    v_smfmac_f32_16x16x64_bf16 v[32:35], v[64:67], v[184:191], v1
    v_add_f32 v37, v37, v39
    v_cndmask_b32 v38, v36, v37, s[76:77]
    v_smfmac_f32_16x16x64_bf16 v[24:27], v[52:55], v[112:119], v1
    s_nop 0
    v_mov_b32_dpp v39, v38 quad_perm:[1,0,3,2] row_mask:0xf bank_mask:0xf
    v_cndmask_b32 v36, v39, v36, s[76:77]
    v_smfmac_f32_16x16x64_bf16 v[24:27], v[56:59], v[136:143], v1
    v_cndmask_b32 v37, v37, v39, s[76:77]
    v_smfmac_f32_16x16x64_bf16 v[24:27], v[60:63], v[168:175], v1
    v_cvt_pk_bf16_f32 v36, v36, v37
    v_and_or_b32 v36, v36, -2, s53
    v_smfmac_f32_16x16x64_bf16 v[24:27], v[64:67], v[192:199], v1
    buffer_store_dword v36, v7, s[8:11], s47 offen
    v_cvt_pk_bf16_f32 v32, v32, v34
    v_cvt_pk_bf16_f32 v34, v33, v35
    v_and_or_b32 v32, v32, -2, s53
    v_and_or_b32 v34, v34, -2, s53
    s_nop 2
    v_cvt_pk_bf16_f32 v33, v24, v26
    v_cvt_pk_bf16_f32 v35, v25, v27
    buffer_store_dwordx4 v[32:35], v0, s[8:11], s47 offen offset:1024
    ds_read_b128 v[36:39], v2 offset:0
    ds_read_b128 v[40:43], v2 offset:1024
    ds_read_b128 v[44:47], v2 offset:2048
    ds_read_b128 v[48:51], v2 offset:3072
    ds_read_b128 v[24:27], v2 offset:4096
    ds_read_b128 v[28:31], v2 offset:5120
    s_add_u32 s54, s45, s68
    v_lshrrev_b32 v10, 2, v0
    v_add_u32 v10, s55, v10
    v_add_u32 v32, s68, v0
    v_add_u32 v76, s69, v0
    v_add_u32 v77, s70, v0
    v_add_u32 v78, s71, v0
    s_waitcnt lgkmcnt(0)
    v_mov_b32 v18, 0x3f80
    v_mov_b32 v19, 0x3f800000
    v_cndmask_b32 v18, v19, v18, s[76:77]
    v_cndmask_b32 v16, 0, v18, s[100:101]
    v_cndmask_b32 v17, 0, v18, s[2:3]
    v_mov_b64 v[18:19], v[16:17]
    v_mov_b64 v[72:73], 0
    v_mov_b64 v[74:75], 0
    v_mov_b64 v[20:21], 0
    s_waitcnt vmcnt(2)
    s_cmp_eq_u32 s37, 0
    s_cbranch_scc1 L_ew_q
    s_waitcnt vmcnt(0)
L_ew_q:
    buffer_load_dwordx4 v[52:55], v8, s[8:11], s64 offen sc1
L_pp_wait_q:
    s_waitcnt vmcnt(0)
    v_smfmac_f32_16x16x32_bf16 v[72:75], v[16:17], v[52:55], v1
    v_bitop3_b32 v20, v20, v52, s53 bitop3:0xf6
    v_bitop3_b32 v20, v20, v53, s53 bitop3:0xf6
    v_bitop3_b32 v20, v20, v54, s53 bitop3:0xf6
    v_bitop3_b32 v20, v20, v55, s53 bitop3:0xf6
    v_and_b32 v20, 1, v20
    v_cmp_ne_u32 vcc, 0, v20
    s_cbranch_vccnz L_pp_retry_q
L_pp_done_q:
    s_nop 0
    v_add_f32_dpp v72, v72, v72 row_ror:2 row_mask:0xf bank_mask:0xf
    v_add_f32_dpp v73, v73, v73 row_ror:2 row_mask:0xf bank_mask:0xf
    v_add_f32_dpp v74, v74, v74 row_ror:2 row_mask:0xf bank_mask:0xf
    v_add_f32_dpp v75, v75, v75 row_ror:2 row_mask:0xf bank_mask:0xf
    v_add_f32_dpp v72, v72, v72 row_ror:4 row_mask:0xf bank_mask:0xf
    v_add_f32_dpp v73, v73, v73 row_ror:4 row_mask:0xf bank_mask:0xf
    v_add_f32_dpp v74, v74, v74 row_ror:4 row_mask:0xf bank_mask:0xf
    v_add_f32_dpp v75, v75, v75 row_ror:4 row_mask:0xf bank_mask:0xf
    v_add_f32_dpp v72, v72, v72 row_ror:8 row_mask:0xf bank_mask:0xf
    v_add_f32_dpp v73, v73, v73 row_ror:8 row_mask:0xf bank_mask:0xf
    v_add_f32_dpp v74, v74, v74 row_ror:8 row_mask:0xf bank_mask:0xf
    v_add_f32_dpp v75, v75, v75 row_ror:8 row_mask:0xf bank_mask:0xf
    v_cvt_pk_bf16_f32 v72, v72, v73
    v_cvt_pk_bf16_f32 v73, v74, v75
    buffer_store_dwordx2 v[72:73], v9, s[8:11], s45 offen
    s_waitcnt vmcnt(0)
    s_barrier
    s_add_u32 s38, s38, 1
    s_cmp_lt_u32 s38, 64
    s_cbranch_scc1 L_loop_q
    s_branch L_exit_q
L_pm_q:
    s_mov_b64 exec, vcc
    buffer_load_dwordx4 v[16:19], v0, s[8:11], s54 offen sc1
    buffer_load_dwordx4 v[20:23], v0, s[8:11], s54 offen offset:1024 sc1
    buffer_load_dword v79, v10, s[8:11], s45 offen sc1
    s_add_u32 s59, s59, 1
    s_cmp_gt_u32 s59, 300000
    s_cbranch_scc1 L_pm_done_q
    s_branch L_pm_chk_q
L_pp_retry_q:
    s_mov_b64 exec, vcc
    buffer_load_dwordx4 v[52:55], v8, s[8:11], s64 offen sc1
    s_mov_b64 exec, -1
    s_add_u32 s59, s59, 1
    s_cmp_gt_u32 s59, 300000
    s_cbranch_scc1 L_pp_done_q
    s_nop 3
    v_mov_b32 v20, 0
    v_mov_b64 v[72:73], 0
    v_mov_b64 v[74:75], 0
    s_branch L_pp_wait_q
L_exit_q:
    s_branch L_fin
L_slow_q:
    ds_read_b128 v[36:39], v2 offset:0
    ds_read_b128 v[40:43], v2 offset:1024
    ds_read_b128 v[44:47], v2 offset:2048
    ds_read_b128 v[48:51], v2 offset:3072
    ds_read_b128 v[24:27], v2 offset:4096
    ds_read_b128 v[28:31], v2 offset:5120
    s_add_u32 s54, s45, s68
    v_lshrrev_b32 v10, 2, v0
    v_add_u32 v10, s55, v10
    v_add_u32 v32, s68, v0
    v_add_u32 v76, s69, v0
    v_add_u32 v77, s70, v0
    v_add_u32 v78, s71, v0
    s_waitcnt lgkmcnt(0)
L_loop_qsc1:
    buffer_load_dwordx4 v[16:19], v0, s[8:11], s54 offen sc1
    buffer_load_dwordx4 v[20:23], v0, s[8:11], s54 offen offset:1024 sc1
    buffer_load_dword v79, v10, s[8:11], s45 offen sc1
    s_mov_b32 s46, s44
    s_mov_b32 s44, s45
    s_and_b32 s53, s38, 1
    v_mov_b64 v[52:53], 0
    v_mov_b64 v[54:55], 0
    v_mov_b64 v[56:57], 0
    v_mov_b64 v[58:59], 0
    v_mov_b64 v[60:61], 0
    v_mov_b64 v[62:63], 0
    v_mov_b64 v[64:65], 0
    v_mov_b64 v[66:67], 0
    v_mov_b64 v[68:69], 0
    v_mov_b64 v[70:71], 0
    v_mov_b64 v[72:73], 0
    v_mov_b64 v[74:75], 0
L_pm_chk_qsc1:
    s_waitcnt vmcnt(0)
    ds_write_b128 v32, v[16:19]
    v_max3_u32 v33, v16, v17, v18
    v_max3_u32 v34, v19, v20, v21
    ds_write_b128 v32, v[20:23] offset:1024
    v_max3_u32 v33, v33, v22, v23
    v_max3_u32 v33, v33, v34, v79
    ds_write_b32 v10, v79
    v_cmp_eq_u32 vcc, -1, v33
    s_cbranch_vccnz L_pm_qsc1
L_pm_done_qsc1:
    s_mov_b64 exec, -1
    v_smfmac_f32_16x16x64_bf16 v[52:55], v[16:19], v[36:43], v1
    ds_read_b128 v[36:39], v2 offset:6144
    ds_read_b128 v[40:43], v2 offset:7168
    v_smfmac_f32_16x16x64_bf16 v[56:59], v[16:19], v[44:51], v1
    ds_read_b128 v[44:47], v2 offset:8192
    ds_read_b128 v[48:51], v2 offset:9216
    v_smfmac_f32_16x16x64_bf16 v[60:63], v[16:19], v[24:31], v1
    v_smfmac_f32_16x16x64_bf16 v[64:67], v[16:19], a[0:7], v1
    s_waitcnt lgkmcnt(4)
    s_barrier
    ds_read_b128 v[24:27], v76 offset:0
    ds_read_b128 v[28:31], v76 offset:1024
    ds_read_b128 v[32:35], v77 offset:0
    v_smfmac_f32_16x16x64_bf16 v[52:55], v[20:23], a[8:15], v1
    v_smfmac_f32_16x16x64_bf16 v[56:59], v[20:23], a[16:23], v1
    v_smfmac_f32_16x16x64_bf16 v[60:63], v[20:23], a[24:31], v1
    v_smfmac_f32_16x16x64_bf16 v[68:71], v[16:19], a[200:207], v1
    v_smfmac_f32_16x16x64_bf16 v[72:75], v[16:19], a[208:215], v1
    v_smfmac_f32_16x16x64_bf16 v[68:71], v[20:23], a[216:223], v1
    v_smfmac_f32_16x16x64_bf16 v[72:75], v[20:23], a[224:231], v1
    s_waitcnt lgkmcnt(5)
    v_smfmac_f32_16x16x64_bf16 v[64:67], v[20:23], v[36:43], v1
    ds_read_b128 v[36:39], v2 offset:10240
    ds_read_b128 v[40:43], v2 offset:11264
    s_waitcnt lgkmcnt(4)
    v_smfmac_f32_16x16x64_bf16 v[52:55], v[24:27], a[32:39], v1
    buffer_load_dwordx4 v[16:19], v0, s[8:11], s50 offen
    v_smfmac_f32_16x16x64_bf16 v[56:59], v[24:27], a[40:47], v1
    s_add_u32 s40, s38, 1
    v_smfmac_f32_16x16x64_bf16 v[60:63], v[24:27], a[48:55], v1
    buffer_load_dwordx4 v[20:23], v0, s[8:11], s50 offen offset:1024
    v_smfmac_f32_16x16x64_bf16 v[64:67], v[24:27], v[44:51], v1
    ds_read_b128 v[44:47], v2 offset:12288
    ds_read_b128 v[48:51], v2 offset:13312
    ds_read_b128 v[24:27], v77 offset:1024
    s_waitcnt lgkmcnt(6)
    v_smfmac_f32_16x16x64_bf16 v[52:55], v[28:31], a[56:63], v1
    s_and_b32 s40, s40, 3
    v_smfmac_f32_16x16x64_bf16 v[56:59], v[28:31], a[64:71], v1
    s_mul_i32 s45, s40, 9216
    v_smfmac_f32_16x16x64_bf16 v[60:63], v[28:31], a[72:79], v1
    v_mov_b64 v[12:13], -1
    s_waitcnt lgkmcnt(3)
    v_smfmac_f32_16x16x64_bf16 v[64:67], v[28:31], v[36:43], v1
    ds_read_b128 v[36:39], v2 offset:14336
    ds_read_b128 v[40:43], v2 offset:15360
    ds_read_b128 v[28:31], v78 offset:0
    v_smfmac_f32_16x16x64_bf16 v[52:55], v[32:35], a[80:87], v1
    buffer_store_dwordx2 v[12:13], v9, s[8:11], s46 offen sc1
    v_smfmac_f32_16x16x64_bf16 v[56:59], v[32:35], a[88:95], v1
    s_add_u32 s45, s45, 61865984
    v_smfmac_f32_16x16x64_bf16 v[60:63], v[32:35], a[96:103], v1
    s_add_u32 s50, s50, 524288
    s_waitcnt lgkmcnt(4)
    v_smfmac_f32_16x16x64_bf16 v[64:67], v[32:35], v[44:51], v1
    ds_read_b128 v[44:47], v2 offset:16384
    ds_read_b128 v[48:51], v2 offset:17408
    ds_read_b128 v[32:35], v78 offset:1024
    s_waitcnt lgkmcnt(6)
    v_smfmac_f32_16x16x64_bf16 v[52:55], v[24:27], a[104:111], v1
    v_smfmac_f32_16x16x64_bf16 v[56:59], v[24:27], a[112:119], v1
    v_smfmac_f32_16x16x64_bf16 v[60:63], v[24:27], a[120:127], v1
    s_waitcnt lgkmcnt(4)
    v_smfmac_f32_16x16x64_bf16 v[64:67], v[24:27], v[36:43], v1
    ds_read_b128 v[36:39], v2 offset:18432
    ds_read_b128 v[40:43], v2 offset:19456
    ds_read_b128 v[24:27], v0 offset:8192
    s_waitcnt lgkmcnt(6)
    v_smfmac_f32_16x16x64_bf16 v[52:55], v[28:31], a[128:135], v1
    v_smfmac_f32_16x16x64_bf16 v[56:59], v[28:31], a[136:143], v1
    s_waitcnt lgkmcnt(4)
    v_smfmac_f32_16x16x64_bf16 v[64:67], v[28:31], v[44:51], v1
    ds_read_b128 v[44:47], v2 offset:20480
    ds_read_b128 v[48:51], v2 offset:21504
    s_waitcnt lgkmcnt(5)
    v_smfmac_f32_16x16x64_bf16 v[52:55], v[32:35], a[152:159], v1
    v_smfmac_f32_16x16x64_bf16 v[56:59], v[32:35], a[160:167], v1
    s_waitcnt lgkmcnt(3)
    v_smfmac_f32_16x16x64_bf16 v[64:67], v[32:35], v[36:43], v1
    s_waitcnt lgkmcnt(2)
    v_smfmac_f32_16x16x64_bf16 v[52:55], v[24:27], a[176:183], v1
    v_mov_b64 v[36:37], 0
    v_smfmac_f32_16x16x64_bf16 v[56:59], v[24:27], a[184:191], v1
    v_mov_b64 v[38:39], 0
    v_smfmac_f32_16x16x64_bf16 v[60:63], v[28:31], a[144:151], v1
    v_mov_b64 v[40:41], 0
    v_smfmac_f32_16x16x64_bf16 v[60:63], v[32:35], a[168:175], v1
    v_mov_b64 v[42:43], 0
    v_smfmac_f32_16x16x64_bf16 v[60:63], v[24:27], a[192:199], v1
    v_add_f32 v52, v52, v54
    s_waitcnt lgkmcnt(0)
    v_smfmac_f32_16x16x64_bf16 v[64:67], v[24:27], v[44:51], v1
    ds_read_b128 v[44:47], v2 offset:22528
    ds_read_b128 v[48:51], v2 offset:23552
    v_add_f32 v53, v53, v55
    v_add_f32 v56, v56, v58
    v_add_f32 v57, v57, v59
    v_cvt_pk_bf16_f32 v54, v52, v56
    v_cvt_pk_bf16_f32 v55, v53, v57
    ds_write2_b32 v3, v54, v55 offset0:0 offset1:16
    v_add_f32 v60, v60, v62
    v_add_f32 v61, v61, v63
    v_add_f32 v64, v64, v66
    v_add_f32 v65, v65, v67
    v_cvt_pk_bf16_f32 v12, v60, v64
    v_cvt_pk_bf16_f32 v13, v61, v65
    ds_write2_b32 v3, v12, v13 offset0:128 offset1:144
    s_mov_b64 exec, s[4:5]
    ds_read_b128 v[36:39], v4
    s_mov_b64 exec, s[6:7]
    ds_read_b128 v[40:43], v4
    s_mov_b64 exec, -1
    ds_read_b128 v[60:63], v5
    ds_read_b128 v[64:67], v5 offset:64
    v_smfmac_f32_16x16x64_bf16 v[68:71], v[32:35], v[232:239], v1
    v_add_u32 v76, s48, v0
    v_smfmac_f32_16x16x64_bf16 v[72:75], v[32:35], v[240:247], v1
    v_add_u32 v10, s69, v0
    ds_read_b128 v[32:35], v10 offset:0
    v_add_u32 v77, s49, v0
    s_waitcnt vmcnt(1)
    s_waitcnt lgkmcnt(4)
    v_mfma_f32_16x16x32_bf16 v[52:55], v[16:19], v[36:39], 0
    s_waitcnt lgkmcnt(2)
    v_mfma_f32_16x16x32_bf16 v[56:59], v[60:63], v[36:39], 0
    s_waitcnt lgkmcnt(1)
    v_mfma_f32_16x16x32_bf16 v[56:59], v[64:67], v[40:43], v[56:59]
    v_mfma_f32_16x16x32_bf16 v[52:55], v[20:23], v[40:43], v[52:55]
    buffer_load_dwordx4 v[16:19], v0, s[8:11], s51 offen
    v_smfmac_f32_16x16x64_bf16 v[68:71], v[28:31], v[224:231], v1
    ds_write_b32 v77, v56
    buffer_load_dwordx4 v[20:23], v0, s[8:11], s51 offen offset:1024
    v_smfmac_f32_16x16x64_bf16 v[68:71], v[24:27], v[248:255], v1
    ds_write_b128 v76, v[52:55]
    v_smfmac_f32_16x16x64_bf16 v[72:75], v[28:31], v[44:51], v1
    ds_read_b128 v[44:47], v2 offset:24576
    ds_read_b128 v[48:51], v2 offset:25600
    ds_read_b128 v[28:31], v10 offset:1024
    buffer_store_dwordx4 v[12:15], v0, s[8:11], s52 offen sc1
    s_waitcnt lgkmcnt(3)
    s_barrier
    ds_read_b128 v[52:55], v0 offset:9216
    ds_read_b128 v[56:59], v0 offset:10240
    ds_read_b128 v[60:63], v0 offset:11264
    ds_read_b128 v[64:67], v0 offset:12288
    ds_read_b128 v[36:39], v0 offset:13312
    v_smfmac_f32_16x16x64_bf16 v[68:71], v[32:35], a[232:239], v1
    v_mov_b64 v[40:41], 0
    v_lshlrev_b32 v13, 2, v0
    buffer_load_dword v12, v13, s[8:11], s73 offen
    s_add_u32 s73, s73, 524288
    v_smfmac_f32_16x16x64_bf16 v[72:75], v[32:35], a[240:247], v1
    v_add_u32 v10, s70, v0
    ds_read_b128 v[32:35], v10 offset:0
    v_mov_b64 v[42:43], 0
    s_waitcnt lgkmcnt(7)
    v_smfmac_f32_16x16x64_bf16 v[72:75], v[24:27], v[44:51], v1
    ds_read_b128 v[44:47], v2 offset:26624
    ds_read_b128 v[48:51], v2 offset:27648
    ds_read_b128 v[24:27], v10 offset:1024
    v_mov_b64 v[76:77], 0
    s_waitcnt lgkmcnt(9)
    v_smfmac_f32_16x16x64_bf16 v[68:71], v[28:31], a[248:255], v1
    v_mov_b64 v[78:79], 0
    s_add_u32 s51, s51, 524288
    s_add_u32 s52, s52, 131072
    s_waitcnt lgkmcnt(4)
    v_pk_add_f32 v[52:53], v[52:53], v[56:57]
    v_pk_add_f32 v[60:61], v[60:61], v[64:65]
    v_pk_add_f32 v[54:55], v[54:55], v[58:59]
    v_pk_add_f32 v[62:63], v[62:63], v[66:67]
    v_pk_add_f32 v[36:37], v[36:37], v[38:39]
    v_pk_add_f32 v[52:53], v[52:53], v[60:61]
    v_pk_add_f32 v[54:55], v[54:55], v[62:63]
    v_add_f32 v36, v36, v37
    v_max3_f32 v56, v52, v53, v54
    v_max3_f32 v56, v56, v55, v36
    s_waitcnt lgkmcnt(3)
    v_smfmac_f32_16x16x64_bf16 v[68:71], v[32:35], v[200:207], v1
    v_mov_b64 v[64:65], s[78:79]
    v_max_f32_dpp v56, v56, v56 quad_perm:[2,3,0,1] row_mask:0xf bank_mask:0xf
    v_mov_b32 v57, v56
    v_smfmac_f32_16x16x64_bf16 v[72:75], v[32:35], v[208:215], v1
    v_mov_b64 v[66:67], s[78:79]
    v_permlane16_swap_b32 v57, v56
    v_max_f32 v56, v56, v57
    v_mov_b32 v57, v56
    s_waitcnt lgkmcnt(1)
    v_smfmac_f32_16x16x64_bf16 v[72:75], v[28:31], v[44:51], v1
    ds_read_b128 v[44:47], v2 offset:28672
    ds_read_b128 v[48:51], v2 offset:29696
    v_mov_b32 v63, 0
    v_permlane32_swap_b32 v57, v56
    v_max_f32 v56, v56, v57
    s_waitcnt lgkmcnt(2)
    v_smfmac_f32_16x16x64_bf16 v[68:71], v[24:27], v[216:223], v1
    v_mul_f32 v56, s56, v56
    v_fma_f32 v52, v52, s56, -v56
    v_fma_f32 v53, v53, s56, -v56
    v_fma_f32 v54, v54, s56, -v56
    v_fma_f32 v55, v55, s56, -v56
    v_fma_f32 v36, v36, s56, -v56
    s_waitcnt lgkmcnt(0)
    v_smfmac_f32_16x16x64_bf16 v[72:75], v[24:27], v[44:51], v1
    ds_read_b128 v[44:47], v2 offset:30720
    ds_read_b128 v[48:51], v2 offset:31744
    v_exp_f32 v52, v52
    v_exp_f32 v53, v53
    v_exp_f32 v54, v54
    v_exp_f32 v55, v55
    v_exp_f32 v36, v36
    v_cvt_pk_bf16_f32 v60, v52, v53
    v_cvt_pk_bf16_f32 v61, v54, v55
    v_cvt_pk_bf16_f32 v62, v36, v63
    s_waitcnt vmcnt(2)
    v_smfmac_f32_16x16x32_bf16 v[40:43], v[60:61], v[16:19], v1
    v_add_f32 v68, v68, v70
    v_add_f32 v69, v69, v71
    v_smfmac_f32_16x16x32_bf16 v[76:79], v[60:61], v[20:23], v1
    v_add_f32 v72, v72, v74
    v_add_f32 v73, v73, v75
    v_mfma_f32_16x16x32_bf16 v[32:35], v[60:63], v[64:67], 0
    v_cvt_pk_bf16_f32 v68, v68, v69
    v_cvt_pk_bf16_f32 v69, v72, v73
    v_cvt_pk_bf16_f32 v70, v72, v73
    v_mov_b32 v71, 0
    v_mov_b32 v72, 0
    ds_read_b128 v[24:27], v2 offset:32768
    ds_read_b128 v[28:31], v2 offset:33792
    v_smfmac_f32_16x16x32_bf16 v[40:43], v[62:63], v[68:71], v1 abid:2
    ds_read_b128 v[16:19], v2 offset:34816
    ds_read_b128 v[20:23], v2 offset:35840
    v_add_f32 v32, v32, v34
    v_smfmac_f32_16x16x32_bf16 v[76:79], v[62:63], v[70:73], v1 abid:2
    v_add_f32 v33, v33, v35
    v_rcp_f32 v32, v32
    v_rcp_f32 v33, v33
    v_mov_b64 v[14:15], v[68:69]
    s_cmp_eq_u32 s38, 63
    s_cbranch_scc1 L_exit_qsc1
    v_mov_b64 v[36:37], 0
    v_mov_b64 v[38:39], 0
    v_add_f32 v40, v40, v42
    v_add_f32 v41, v41, v43
    v_add_f32 v76, v76, v78
    v_add_f32 v77, v77, v79
    v_pk_mul_f32 v[40:41], v[40:41], v[32:33]
    v_pk_mul_f32 v[76:77], v[76:77], v[32:33]
    v_cvt_pk_bf16_f32 v34, v40, v76
    v_cvt_pk_bf16_f32 v35, v41, v77
    ds_write2_b32 v6, v34, v35 offset0:0 offset1:4
    v_and_b32 v10, 32, v0
    v_lshl_add_u32 v10, v10, 5, v11
    v_mov_b64 v[40:41], 0
    v_mov_b64 v[42:43], 0
    v_mov_b64 v[76:77], 0
    v_mov_b64 v[78:79], 0
    s_waitcnt lgkmcnt(0)
    s_barrier
    ds_read_b128 v[52:55], v11 offset:0
    ds_read_b128 v[56:59], v11 offset:512
    ds_read_b128 v[60:63], v11 offset:1024
    ds_read_b128 v[64:67], v11 offset:1536
    ds_read_b128 v[68:71], v10 offset:0
    ds_read_b128 v[72:75], v10 offset:512
    v_mov_b64 v[32:33], 0
    v_mov_b64 v[34:35], 0
    s_waitcnt lgkmcnt(5)
    v_smfmac_f32_16x16x64_bf16 v[40:43], v[52:55], v[88:95], v1
    v_smfmac_f32_16x16x64_bf16 v[76:79], v[52:55], v[96:103], v1
    s_waitcnt lgkmcnt(4)
    v_smfmac_f32_16x16x64_bf16 v[40:43], v[56:59], v[24:31], v1
    v_smfmac_f32_16x16x64_bf16 v[76:79], v[56:59], v[120:127], v1
    v_mov_b64 v[24:25], 0
    s_waitcnt lgkmcnt(3)
    v_smfmac_f32_16x16x64_bf16 v[40:43], v[60:63], v[144:151], v1
    v_mov_b64 v[26:27], 0
    s_waitcnt lgkmcnt(2)
    v_smfmac_f32_16x16x64_bf16 v[40:43], v[64:67], v[16:23], v1
    v_smfmac_f32_16x16x64_bf16 v[76:79], v[60:63], v[152:159], v1
    v_smfmac_f32_16x16x64_bf16 v[76:79], v[64:67], v[176:183], v1
    s_waitcnt lgkmcnt(1)
    v_smfmac_f32_16x16x64_bf16 v[36:39], v[68:71], v[80:87], v1
    v_cvt_pk_bf16_f32 v40, v40, v42
    s_waitcnt lgkmcnt(0)
    v_smfmac_f32_16x16x64_bf16 v[36:39], v[72:75], v[44:51], v1
    v_cvt_pk_bf16_f32 v42, v41, v43
    v_smfmac_f32_16x16x64_bf16 v[32:35], v[52:55], v[104:111], v1
    v_and_or_b32 v40, v40, -2, s53
    v_and_or_b32 v42, v42, -2, s53
    v_smfmac_f32_16x16x64_bf16 v[32:35], v[56:59], v[128:135], v1
    v_cvt_pk_bf16_f32 v41, v76, v78
    v_smfmac_f32_16x16x64_bf16 v[32:35], v[60:63], v[160:167], v1
    v_cvt_pk_bf16_f32 v43, v77, v79
    buffer_store_dwordx4 v[40:43], v0, s[8:11], s47 offen offset:0 sc1
    v_add_f32 v36, v36, v38
    v_smfmac_f32_16x16x64_bf16 v[32:35], v[64:67], v[184:191], v1
    v_add_f32 v37, v37, v39
    v_cndmask_b32 v38, v36, v37, s[76:77]
    v_smfmac_f32_16x16x64_bf16 v[24:27], v[52:55], v[112:119], v1
    s_nop 0
    v_mov_b32_dpp v39, v38 quad_perm:[1,0,3,2] row_mask:0xf bank_mask:0xf
    v_cndmask_b32 v36, v39, v36, s[76:77]
    v_smfmac_f32_16x16x64_bf16 v[24:27], v[56:59], v[136:143], v1
    v_cndmask_b32 v37, v37, v39, s[76:77]
    v_smfmac_f32_16x16x64_bf16 v[24:27], v[60:63], v[168:175], v1
    v_cvt_pk_bf16_f32 v36, v36, v37
    v_and_or_b32 v36, v36, -2, s53
    v_smfmac_f32_16x16x64_bf16 v[24:27], v[64:67], v[192:199], v1
    buffer_store_dword v36, v7, s[8:11], s47 offen sc1
    v_cvt_pk_bf16_f32 v32, v32, v34
    v_cvt_pk_bf16_f32 v34, v33, v35
    v_and_or_b32 v32, v32, -2, s53
    v_and_or_b32 v34, v34, -2, s53
    s_nop 2
    v_cvt_pk_bf16_f32 v33, v24, v26
    v_cvt_pk_bf16_f32 v35, v25, v27
    buffer_store_dwordx4 v[32:35], v0, s[8:11], s47 offen offset:1024 sc1
    ds_read_b128 v[36:39], v2 offset:0
    ds_read_b128 v[40:43], v2 offset:1024
    ds_read_b128 v[44:47], v2 offset:2048
    ds_read_b128 v[48:51], v2 offset:3072
    ds_read_b128 v[24:27], v2 offset:4096
    ds_read_b128 v[28:31], v2 offset:5120
    s_add_u32 s54, s45, s68
    v_lshrrev_b32 v10, 2, v0
    v_add_u32 v10, s55, v10
    v_add_u32 v32, s68, v0
    v_add_u32 v76, s69, v0
    v_add_u32 v77, s70, v0
    v_add_u32 v78, s71, v0
    s_waitcnt lgkmcnt(0)
    v_mov_b32 v18, 0x3f80
    v_mov_b32 v19, 0x3f800000
    v_cndmask_b32 v18, v19, v18, s[76:77]
    v_cndmask_b32 v16, 0, v18, s[100:101]
    v_cndmask_b32 v17, 0, v18, s[2:3]
    v_mov_b64 v[18:19], v[16:17]
    v_mov_b64 v[72:73], 0
    v_mov_b64 v[74:75], 0
    v_mov_b64 v[20:21], 0
    s_waitcnt vmcnt(2)
    s_cmp_eq_u32 s37, 0
    s_cbranch_scc1 L_ew_qsc1
    s_waitcnt vmcnt(0)
L_ew_qsc1:
    buffer_load_dwordx4 v[52:55], v8, s[8:11], s64 offen sc1
L_pp_wait_qsc1:
    s_waitcnt vmcnt(0)
    v_smfmac_f32_16x16x32_bf16 v[72:75], v[16:17], v[52:55], v1
    v_bitop3_b32 v20, v20, v52, s53 bitop3:0xf6
    v_bitop3_b32 v20, v20, v53, s53 bitop3:0xf6
    v_bitop3_b32 v20, v20, v54, s53 bitop3:0xf6
    v_bitop3_b32 v20, v20, v55, s53 bitop3:0xf6
    v_and_b32 v20, 1, v20
    v_cmp_ne_u32 vcc, 0, v20
    s_cbranch_vccnz L_pp_retry_qsc1
L_pp_done_qsc1:
    s_nop 0
    v_add_f32_dpp v72, v72, v72 row_ror:2 row_mask:0xf bank_mask:0xf
    v_add_f32_dpp v73, v73, v73 row_ror:2 row_mask:0xf bank_mask:0xf
    v_add_f32_dpp v74, v74, v74 row_ror:2 row_mask:0xf bank_mask:0xf
    v_add_f32_dpp v75, v75, v75 row_ror:2 row_mask:0xf bank_mask:0xf
    v_add_f32_dpp v72, v72, v72 row_ror:4 row_mask:0xf bank_mask:0xf
    v_add_f32_dpp v73, v73, v73 row_ror:4 row_mask:0xf bank_mask:0xf
    v_add_f32_dpp v74, v74, v74 row_ror:4 row_mask:0xf bank_mask:0xf
    v_add_f32_dpp v75, v75, v75 row_ror:4 row_mask:0xf bank_mask:0xf
    v_add_f32_dpp v72, v72, v72 row_ror:8 row_mask:0xf bank_mask:0xf
    v_add_f32_dpp v73, v73, v73 row_ror:8 row_mask:0xf bank_mask:0xf
    v_add_f32_dpp v74, v74, v74 row_ror:8 row_mask:0xf bank_mask:0xf
    v_add_f32_dpp v75, v75, v75 row_ror:8 row_mask:0xf bank_mask:0xf
    v_cvt_pk_bf16_f32 v72, v72, v73
    v_cvt_pk_bf16_f32 v73, v74, v75
    buffer_store_dwordx2 v[72:73], v9, s[8:11], s45 offen sc1
    s_waitcnt vmcnt(0)
    s_barrier
    s_add_u32 s38, s38, 1
    s_cmp_lt_u32 s38, 64
    s_cbranch_scc1 L_loop_qsc1
    s_branch L_exit_qsc1
L_pm_qsc1:
    s_mov_b64 exec, vcc
    buffer_load_dwordx4 v[16:19], v0, s[8:11], s54 offen sc1
    buffer_load_dwordx4 v[20:23], v0, s[8:11], s54 offen offset:1024 sc1
    buffer_load_dword v79, v10, s[8:11], s45 offen sc1
    s_add_u32 s59, s59, 1
    s_cmp_gt_u32 s59, 300000
    s_cbranch_scc1 L_pm_done_qsc1
    s_branch L_pm_chk_qsc1
L_pp_retry_qsc1:
    s_mov_b64 exec, vcc
    buffer_load_dwordx4 v[52:55], v8, s[8:11], s64 offen sc1
    s_mov_b64 exec, -1
    s_add_u32 s59, s59, 1
    s_cmp_gt_u32 s59, 300000
    s_cbranch_scc1 L_pp_done_qsc1
    s_nop 3
    v_mov_b32 v20, 0
    v_mov_b64 v[72:73], 0
    v_mov_b64 v[74:75], 0
    s_branch L_pp_wait_qsc1
L_exit_qsc1:
    s_branch L_fin
L_step_n:
    s_cmp_eq_u32 s72, 127
    s_cselect_b32 s74, 96, s10
    s_cmp_lt_u32 s41, 32
    s_cbranch_scc1 L_slow_n
    ds_read_b128 v[36:39], v2 offset:0
    ds_read_b128 v[40:43], v2 offset:1024
    ds_read_b128 v[44:47], v2 offset:2048
    ds_read_b128 v[48:51], v2 offset:3072
    ds_read_b128 v[24:27], v2 offset:4096
    ds_read_b128 v[28:31], v2 offset:5120
    s_add_u32 s54, s45, s68
    v_lshrrev_b32 v10, 2, v0
    v_add_u32 v10, s55, v10
    v_add_u32 v32, s68, v0
    v_add_u32 v76, s69, v0
    v_add_u32 v77, s70, v0
    v_add_u32 v78, s71, v0
    s_waitcnt lgkmcnt(0)
L_loop_x:
    buffer_load_dwordx4 v[16:19], v0, s[8:11], s54 offen sc1
    buffer_load_dwordx4 v[20:23], v0, s[8:11], s54 offen offset:1024 sc1
    buffer_load_dword v79, v10, s[8:11], s45 offen sc1
    s_mov_b32 s46, s44
    s_mov_b32 s44, s45
    s_and_b32 s53, s38, 1
    v_mov_b64 v[52:53], 0
    v_mov_b64 v[54:55], 0
    v_mov_b64 v[56:57], 0
    v_mov_b64 v[58:59], 0
    v_mov_b64 v[60:61], 0
    v_mov_b64 v[62:63], 0
    v_mov_b64 v[64:65], 0
    v_mov_b64 v[66:67], 0
    v_mov_b64 v[68:69], 0
    v_mov_b64 v[70:71], 0
    v_mov_b64 v[72:73], 0
    v_mov_b64 v[74:75], 0
L_pm_chk_x:
    s_waitcnt vmcnt(0)
    ds_write_b128 v32, v[16:19]
    v_max3_u32 v33, v16, v17, v18
    v_max3_u32 v34, v19, v20, v21
    ds_write_b128 v32, v[20:23] offset:1024
    v_max3_u32 v33, v33, v22, v23
    v_max3_u32 v33, v33, v34, v79
    ds_write_b32 v10, v79
    v_cmp_eq_u32 vcc, -1, v33
    s_cbranch_vccnz L_pm_x
L_pm_done_x:
    s_mov_b64 exec, -1
    v_smfmac_f32_16x16x64_bf16 v[52:55], v[16:19], v[36:43], v1
    ds_read_b128 v[36:39], v2 offset:6144
    ds_read_b128 v[40:43], v2 offset:7168
    v_smfmac_f32_16x16x64_bf16 v[56:59], v[16:19], v[44:51], v1
    ds_read_b128 v[44:47], v2 offset:8192
    ds_read_b128 v[48:51], v2 offset:9216
    v_smfmac_f32_16x16x64_bf16 v[60:63], v[16:19], v[24:31], v1
    v_smfmac_f32_16x16x64_bf16 v[64:67], v[16:19], a[0:7], v1
    s_waitcnt lgkmcnt(4)
    s_barrier
    ds_read_b128 v[24:27], v76 offset:0
    ds_read_b128 v[28:31], v76 offset:1024
    ds_read_b128 v[32:35], v77 offset:0
    v_smfmac_f32_16x16x64_bf16 v[52:55], v[20:23], a[8:15], v1
    v_smfmac_f32_16x16x64_bf16 v[56:59], v[20:23], a[16:23], v1
    v_smfmac_f32_16x16x64_bf16 v[60:63], v[20:23], a[24:31], v1
    v_smfmac_f32_16x16x64_bf16 v[68:71], v[16:19], a[200:207], v1
    v_smfmac_f32_16x16x64_bf16 v[72:75], v[16:19], a[208:215], v1
    v_smfmac_f32_16x16x64_bf16 v[68:71], v[20:23], a[216:223], v1
    v_smfmac_f32_16x16x64_bf16 v[72:75], v[20:23], a[224:231], v1
    s_waitcnt lgkmcnt(5)
    v_smfmac_f32_16x16x64_bf16 v[64:67], v[20:23], v[36:43], v1
    ds_read_b128 v[36:39], v2 offset:10240
    ds_read_b128 v[40:43], v2 offset:11264
    s_waitcnt lgkmcnt(4)
    v_smfmac_f32_16x16x64_bf16 v[52:55], v[24:27], a[32:39], v1
    buffer_load_dwordx4 v[16:19], v0, s[8:11], s50 offen
    v_smfmac_f32_16x16x64_bf16 v[56:59], v[24:27], a[40:47], v1
    s_add_u32 s40, s38, 1
    v_smfmac_f32_16x16x64_bf16 v[60:63], v[24:27], a[48:55], v1
    buffer_load_dwordx4 v[20:23], v0, s[8:11], s50 offen offset:1024
    v_smfmac_f32_16x16x64_bf16 v[64:67], v[24:27], v[44:51], v1
    ds_read_b128 v[44:47], v2 offset:12288
    ds_read_b128 v[48:51], v2 offset:13312
    ds_read_b128 v[24:27], v77 offset:1024
    s_waitcnt lgkmcnt(6)
    v_smfmac_f32_16x16x64_bf16 v[52:55], v[28:31], a[56:63], v1
    s_and_b32 s40, s40, 3
    v_smfmac_f32_16x16x64_bf16 v[56:59], v[28:31], a[64:71], v1
    s_mul_i32 s45, s40, 9216
    v_smfmac_f32_16x16x64_bf16 v[60:63], v[28:31], a[72:79], v1
    s_add_u32 s45, s45, 61865984
    s_waitcnt lgkmcnt(3)
    v_smfmac_f32_16x16x64_bf16 v[64:67], v[28:31], v[36:43], v1
    ds_read_b128 v[36:39], v2 offset:14336
    ds_read_b128 v[40:43], v2 offset:15360
    ds_read_b128 v[28:31], v78 offset:0
    v_smfmac_f32_16x16x64_bf16 v[52:55], v[32:35], a[80:87], v1
    s_add_u32 s50, s50, 524288
    v_smfmac_f32_16x16x64_bf16 v[56:59], v[32:35], a[88:95], v1
    v_smfmac_f32_16x16x64_bf16 v[60:63], v[32:35], a[96:103], v1
    s_waitcnt lgkmcnt(4)
    v_smfmac_f32_16x16x64_bf16 v[64:67], v[32:35], v[44:51], v1
    ds_read_b128 v[44:47], v2 offset:16384
    ds_read_b128 v[48:51], v2 offset:17408
    ds_read_b128 v[32:35], v78 offset:1024
    s_waitcnt lgkmcnt(6)
    v_smfmac_f32_16x16x64_bf16 v[52:55], v[24:27], a[104:111], v1
    v_smfmac_f32_16x16x64_bf16 v[56:59], v[24:27], a[112:119], v1
    v_smfmac_f32_16x16x64_bf16 v[60:63], v[24:27], a[120:127], v1
    s_waitcnt lgkmcnt(4)
    v_smfmac_f32_16x16x64_bf16 v[64:67], v[24:27], v[36:43], v1
    ds_read_b128 v[36:39], v2 offset:18432
    ds_read_b128 v[40:43], v2 offset:19456
    ds_read_b128 v[24:27], v0 offset:8192
    s_waitcnt lgkmcnt(6)
    v_smfmac_f32_16x16x64_bf16 v[52:55], v[28:31], a[128:135], v1
    v_smfmac_f32_16x16x64_bf16 v[56:59], v[28:31], a[136:143], v1
    s_waitcnt lgkmcnt(4)
    v_smfmac_f32_16x16x64_bf16 v[64:67], v[28:31], v[44:51], v1
    ds_read_b128 v[44:47], v2 offset:20480
    ds_read_b128 v[48:51], v2 offset:21504
    s_waitcnt lgkmcnt(5)
    v_smfmac_f32_16x16x64_bf16 v[52:55], v[32:35], a[152:159], v1
    v_smfmac_f32_16x16x64_bf16 v[56:59], v[32:35], a[160:167], v1
    s_waitcnt lgkmcnt(3)
    v_smfmac_f32_16x16x64_bf16 v[64:67], v[32:35], v[36:43], v1
    s_waitcnt lgkmcnt(2)
    v_smfmac_f32_16x16x64_bf16 v[52:55], v[24:27], a[176:183], v1
    v_mov_b64 v[36:37], 0
    v_smfmac_f32_16x16x64_bf16 v[56:59], v[24:27], a[184:191], v1
    v_mov_b64 v[38:39], 0
    v_smfmac_f32_16x16x64_bf16 v[60:63], v[28:31], a[144:151], v1
    v_mov_b64 v[40:41], 0
    v_smfmac_f32_16x16x64_bf16 v[60:63], v[32:35], a[168:175], v1
    v_mov_b64 v[42:43], 0
    v_smfmac_f32_16x16x64_bf16 v[60:63], v[24:27], a[192:199], v1
    v_add_f32 v52, v52, v54
    s_waitcnt lgkmcnt(0)
    v_smfmac_f32_16x16x64_bf16 v[64:67], v[24:27], v[44:51], v1
    ds_read_b128 v[44:47], v2 offset:22528
    ds_read_b128 v[48:51], v2 offset:23552
    v_add_f32 v53, v53, v55
    v_add_f32 v56, v56, v58
    v_add_f32 v57, v57, v59
    v_cvt_pk_bf16_f32 v54, v52, v56
    v_cvt_pk_bf16_f32 v55, v53, v57
    ds_write2_b32 v3, v54, v55 offset0:0 offset1:16
    v_add_f32 v60, v60, v62
    v_add_f32 v61, v61, v63
    v_add_f32 v64, v64, v66
    v_add_f32 v65, v65, v67
    v_cvt_pk_bf16_f32 v12, v60, v64
    v_cvt_pk_bf16_f32 v13, v61, v65
    ds_write2_b32 v3, v12, v13 offset0:128 offset1:144
    s_mov_b64 exec, s[4:5]
    ds_read_b128 v[36:39], v4
    s_mov_b64 exec, s[6:7]
    ds_read_b128 v[40:43], v4
    s_mov_b64 exec, -1
    ds_read_b128 v[60:63], v5
    ds_read_b128 v[64:67], v5 offset:64
    v_smfmac_f32_16x16x64_bf16 v[68:71], v[32:35], v[232:239], v1
    v_add_u32 v76, s48, v0
    v_smfmac_f32_16x16x64_bf16 v[72:75], v[32:35], v[240:247], v1
    v_add_u32 v10, s69, v0
    ds_read_b128 v[32:35], v10 offset:0
    v_add_u32 v77, s49, v0
    s_waitcnt vmcnt(0)
    s_waitcnt lgkmcnt(4)
    v_mfma_f32_16x16x32_bf16 v[52:55], v[16:19], v[36:39], 0
    s_waitcnt lgkmcnt(2)
    v_mfma_f32_16x16x32_bf16 v[56:59], v[60:63], v[36:39], 0
    s_waitcnt lgkmcnt(1)
    v_mfma_f32_16x16x32_bf16 v[56:59], v[64:67], v[40:43], v[56:59]
    v_mfma_f32_16x16x32_bf16 v[52:55], v[20:23], v[40:43], v[52:55]
    buffer_load_dwordx4 v[16:19], v0, s[8:11], s51 offen
    v_smfmac_f32_16x16x64_bf16 v[68:71], v[28:31], v[224:231], v1
    ds_write_b32 v77, v56
    buffer_load_dwordx4 v[20:23], v0, s[8:11], s51 offen offset:1024
    v_smfmac_f32_16x16x64_bf16 v[68:71], v[24:27], v[248:255], v1
    ds_write_b128 v76, v[52:55]
    v_smfmac_f32_16x16x64_bf16 v[72:75], v[28:31], v[44:51], v1
    ds_read_b128 v[44:47], v2 offset:24576
    ds_read_b128 v[48:51], v2 offset:25600
    ds_read_b128 v[28:31], v10 offset:1024
    buffer_store_dwordx4 v[12:15], v0, s[8:11], s52 offen sc1
    s_waitcnt lgkmcnt(3)
    s_barrier
    ds_read_b128 v[52:55], v0 offset:9216
    ds_read_b128 v[56:59], v0 offset:10240
    ds_read_b128 v[60:63], v0 offset:11264
    ds_read_b128 v[64:67], v0 offset:12288
    ds_read_b128 v[36:39], v0 offset:13312
    v_smfmac_f32_16x16x64_bf16 v[68:71], v[32:35], a[232:239], v1
    v_mov_b64 v[40:41], 0
    v_lshlrev_b32 v13, 2, v0
    buffer_load_dword v12, v13, s[8:11], s73 offen
    s_add_u32 s73, s73, 524288
    v_smfmac_f32_16x16x64_bf16 v[72:75], v[32:35], a[240:247], v1
    v_add_u32 v10, s70, v0
    ds_read_b128 v[32:35], v10 offset:0
    v_mov_b64 v[42:43], 0
    s_waitcnt lgkmcnt(7)
    v_smfmac_f32_16x16x64_bf16 v[72:75], v[24:27], v[44:51], v1
    ds_read_b128 v[44:47], v2 offset:26624
    ds_read_b128 v[48:51], v2 offset:27648
    ds_read_b128 v[24:27], v10 offset:1024
    v_mov_b64 v[76:77], 0
    v_mov_b32 v78, s38
    buffer_store_dword v78, off, s[32:35], s74 sc1
    s_waitcnt lgkmcnt(9)
    v_smfmac_f32_16x16x64_bf16 v[68:71], v[28:31], a[248:255], v1
    v_mov_b64 v[78:79], 0
    s_add_u32 s51, s51, 524288
    s_add_u32 s52, s52, 131072
    s_waitcnt lgkmcnt(4)
    v_pk_add_f32 v[52:53], v[52:53], v[56:57]
    v_pk_add_f32 v[60:61], v[60:61], v[64:65]
    v_pk_add_f32 v[54:55], v[54:55], v[58:59]
    v_pk_add_f32 v[62:63], v[62:63], v[66:67]
    v_pk_add_f32 v[36:37], v[36:37], v[38:39]
    v_pk_add_f32 v[52:53], v[52:53], v[60:61]
    v_pk_add_f32 v[54:55], v[54:55], v[62:63]
    v_add_f32 v36, v36, v37
    v_max3_f32 v56, v52, v53, v54
    v_max3_f32 v56, v56, v55, v36
    s_waitcnt lgkmcnt(3)
    v_smfmac_f32_16x16x64_bf16 v[68:71], v[32:35], v[200:207], v1
    v_mov_b64 v[64:65], s[78:79]
    v_max_f32_dpp v56, v56, v56 quad_perm:[2,3,0,1] row_mask:0xf bank_mask:0xf
    v_mov_b32 v57, v56
    v_smfmac_f32_16x16x64_bf16 v[72:75], v[32:35], v[208:215], v1
    v_mov_b64 v[66:67], s[78:79]
    v_permlane16_swap_b32 v57, v56
    v_max_f32 v56, v56, v57
    v_mov_b32 v57, v56
    s_waitcnt lgkmcnt(1)
    v_smfmac_f32_16x16x64_bf16 v[72:75], v[28:31], v[44:51], v1
    ds_read_b128 v[44:47], v2 offset:28672
    ds_read_b128 v[48:51], v2 offset:29696
    v_mov_b32 v63, 0
    v_permlane32_swap_b32 v57, v56
    v_max_f32 v56, v56, v57
    s_waitcnt lgkmcnt(2)
    v_smfmac_f32_16x16x64_bf16 v[68:71], v[24:27], v[216:223], v1
    v_mul_f32 v56, s56, v56
    v_fma_f32 v52, v52, s56, -v56
    v_fma_f32 v53, v53, s56, -v56
    v_fma_f32 v54, v54, s56, -v56
    v_fma_f32 v55, v55, s56, -v56
    v_fma_f32 v36, v36, s56, -v56
    s_waitcnt lgkmcnt(0)
    v_smfmac_f32_16x16x64_bf16 v[72:75], v[24:27], v[44:51], v1
    ds_read_b128 v[44:47], v2 offset:30720
    ds_read_b128 v[48:51], v2 offset:31744
    v_exp_f32 v52, v52
    v_exp_f32 v53, v53
    v_exp_f32 v54, v54
    v_exp_f32 v55, v55
    v_exp_f32 v36, v36
    v_cvt_pk_bf16_f32 v60, v52, v53
    v_cvt_pk_bf16_f32 v61, v54, v55
    v_cvt_pk_bf16_f32 v62, v36, v63
    s_waitcnt vmcnt(3)
    v_smfmac_f32_16x16x32_bf16 v[40:43], v[60:61], v[16:19], v1
    v_add_f32 v68, v68, v70
    v_add_f32 v69, v69, v71
    v_smfmac_f32_16x16x32_bf16 v[76:79], v[60:61], v[20:23], v1
    v_add_f32 v72, v72, v74
    v_add_f32 v73, v73, v75
    v_mfma_f32_16x16x32_bf16 v[32:35], v[60:63], v[64:67], 0
    v_cvt_pk_bf16_f32 v68, v68, v69
    v_cvt_pk_bf16_f32 v69, v72, v73
    v_cvt_pk_bf16_f32 v70, v72, v73
    v_mov_b32 v71, 0
    v_mov_b32 v72, 0
    ds_read_b128 v[24:27], v2 offset:32768
    ds_read_b128 v[28:31], v2 offset:33792
    v_smfmac_f32_16x16x32_bf16 v[40:43], v[62:63], v[68:71], v1 abid:2
    ds_read_b128 v[16:19], v2 offset:34816
    ds_read_b128 v[20:23], v2 offset:35840
    v_add_f32 v32, v32, v34
    v_smfmac_f32_16x16x32_bf16 v[76:79], v[62:63], v[70:73], v1 abid:2
    v_add_f32 v33, v33, v35
    v_rcp_f32 v32, v32
    v_rcp_f32 v33, v33
    v_mov_b64 v[14:15], v[68:69]
    s_cmp_eq_u32 s38, 63
    s_cbranch_scc1 L_exit_x
    v_mov_b64 v[36:37], 0
    v_mov_b64 v[38:39], 0
    v_add_f32 v40, v40, v42
    v_add_f32 v41, v41, v43
    v_add_f32 v76, v76, v78
    v_add_f32 v77, v77, v79
    v_pk_mul_f32 v[40:41], v[40:41], v[32:33]
    v_pk_mul_f32 v[76:77], v[76:77], v[32:33]
    v_cvt_pk_bf16_f32 v34, v40, v76
    v_cvt_pk_bf16_f32 v35, v41, v77
    ds_write2_b32 v6, v34, v35 offset0:0 offset1:4
    v_and_b32 v10, 32, v0
    v_lshl_add_u32 v10, v10, 5, v11
    v_mov_b64 v[40:41], 0
    v_mov_b64 v[42:43], 0
    v_mov_b64 v[76:77], 0
    v_mov_b64 v[78:79], 0
    s_waitcnt lgkmcnt(0)
    s_barrier
    ds_read_b128 v[52:55], v11 offset:0
    ds_read_b128 v[56:59], v11 offset:512
    ds_read_b128 v[60:63], v11 offset:1024
    ds_read_b128 v[64:67], v11 offset:1536
    ds_read_b128 v[68:71], v10 offset:0
    ds_read_b128 v[72:75], v10 offset:512
    v_mov_b64 v[32:33], 0
    v_mov_b64 v[34:35], 0
    s_waitcnt lgkmcnt(5)
    v_smfmac_f32_16x16x64_bf16 v[40:43], v[52:55], v[88:95], v1
    v_smfmac_f32_16x16x64_bf16 v[76:79], v[52:55], v[96:103], v1
    s_waitcnt lgkmcnt(4)
    v_smfmac_f32_16x16x64_bf16 v[40:43], v[56:59], v[24:31], v1
    v_smfmac_f32_16x16x64_bf16 v[76:79], v[56:59], v[120:127], v1
    v_mov_b64 v[24:25], 0
    s_waitcnt lgkmcnt(3)
    v_smfmac_f32_16x16x64_bf16 v[40:43], v[60:63], v[144:151], v1
    v_mov_b64 v[26:27], 0
    s_waitcnt lgkmcnt(2)
    v_smfmac_f32_16x16x64_bf16 v[40:43], v[64:67], v[16:23], v1
    v_smfmac_f32_16x16x64_bf16 v[76:79], v[60:63], v[152:159], v1
    v_smfmac_f32_16x16x64_bf16 v[76:79], v[64:67], v[176:183], v1
    s_waitcnt lgkmcnt(1)
    v_smfmac_f32_16x16x64_bf16 v[36:39], v[68:71], v[80:87], v1
    v_cvt_pk_bf16_f32 v40, v40, v42
    s_waitcnt lgkmcnt(0)
    v_smfmac_f32_16x16x64_bf16 v[36:39], v[72:75], v[44:51], v1
    v_cvt_pk_bf16_f32 v42, v41, v43
    v_smfmac_f32_16x16x64_bf16 v[32:35], v[52:55], v[104:111], v1
    v_and_or_b32 v40, v40, -2, s53
    v_and_or_b32 v42, v42, -2, s53
    v_smfmac_f32_16x16x64_bf16 v[32:35], v[56:59], v[128:135], v1
    v_cvt_pk_bf16_f32 v41, v76, v78
    v_smfmac_f32_16x16x64_bf16 v[32:35], v[60:63], v[160:167], v1
    v_cvt_pk_bf16_f32 v43, v77, v79
    buffer_store_dwordx4 v[40:43], v0, s[8:11], s47 offen offset:0
    v_add_f32 v36, v36, v38
    v_smfmac_f32_16x16x64_bf16 v[32:35], v[64:67], v[184:191], v1
    v_add_f32 v37, v37, v39
    v_cndmask_b32 v38, v36, v37, s[76:77]
    v_smfmac_f32_16x16x64_bf16 v[24:27], v[52:55], v[112:119], v1
    s_nop 0
    v_mov_b32_dpp v39, v38 quad_perm:[1,0,3,2] row_mask:0xf bank_mask:0xf
    v_cndmask_b32 v36, v39, v36, s[76:77]
    v_smfmac_f32_16x16x64_bf16 v[24:27], v[56:59], v[136:143], v1
    v_cndmask_b32 v37, v37, v39, s[76:77]
    v_smfmac_f32_16x16x64_bf16 v[24:27], v[60:63], v[168:175], v1
    v_cvt_pk_bf16_f32 v36, v36, v37
    v_and_or_b32 v36, v36, -2, s53
    v_smfmac_f32_16x16x64_bf16 v[24:27], v[64:67], v[192:199], v1
    buffer_store_dword v36, v7, s[8:11], s47 offen
    v_cvt_pk_bf16_f32 v32, v32, v34
    v_cvt_pk_bf16_f32 v34, v33, v35
    v_and_or_b32 v32, v32, -2, s53
    v_and_or_b32 v34, v34, -2, s53
    s_nop 2
    v_cvt_pk_bf16_f32 v33, v24, v26
    v_cvt_pk_bf16_f32 v35, v25, v27
    buffer_store_dwordx4 v[32:35], v0, s[8:11], s47 offen offset:1024
    ds_read_b128 v[36:39], v2 offset:0
    ds_read_b128 v[40:43], v2 offset:1024
    ds_read_b128 v[44:47], v2 offset:2048
    ds_read_b128 v[48:51], v2 offset:3072
    ds_read_b128 v[24:27], v2 offset:4096
    ds_read_b128 v[28:31], v2 offset:5120
    s_add_u32 s54, s45, s68
    v_lshrrev_b32 v10, 2, v0
    v_add_u32 v10, s55, v10
    v_add_u32 v32, s68, v0
    v_add_u32 v76, s69, v0
    v_add_u32 v77, s70, v0
    v_add_u32 v78, s71, v0
    s_waitcnt lgkmcnt(0)
    s_add_u32 s39, s38, 3
    s_cmp_ge_u32 s39, s75
    s_cbranch_scc1 L_rdy_x
L_rdy_done_x:
    s_barrier
    s_add_u32 s38, s38, 1
    s_cmp_lt_u32 s38, 64
    s_cbranch_scc1 L_loop_x
    s_branch L_exit_x
L_pm_x:
    s_mov_b64 exec, vcc
    buffer_load_dwordx4 v[16:19], v0, s[8:11], s54 offen sc1
    buffer_load_dwordx4 v[20:23], v0, s[8:11], s54 offen offset:1024 sc1
    buffer_load_dword v79, v10, s[8:11], s45 offen sc1
    s_add_u32 s59, s59, 1
    s_cmp_gt_u32 s59, 300000
    s_cbranch_scc1 L_pm_done_x
    s_branch L_pm_chk_x
L_rdy_x:
    v_lshrrev_b32 v52, 2, v0
    v_and_b32 v52, 60, v52
    buffer_load_dword v53, v52, s[32:35], 0 offen offset:160 sc1
    s_add_u32 s59, s59, 1
    s_waitcnt vmcnt(0)
    v_cmp_gt_u32 vcc, 128, v53
    s_or_b32 s40, vcc_lo, 0x10000
    s_ff1_i32_b32 s40, s40
    s_lshl_b32 s75, s40, 2
    s_cmp_eq_u32 s40, 16
    s_cselect_b32 s75, 100, s75
    s_cmp_gt_u32 s59, 300000
    s_cbranch_scc1 L_rdy_done_x
    s_cmp_ge_u32 s39, s75
    s_cbranch_scc1 L_rdy_x
    s_branch L_rdy_done_x
L_exit_x:
    s_branch L_fin_n
L_slow_n:
    ds_read_b128 v[36:39], v2 offset:0
    ds_read_b128 v[40:43], v2 offset:1024
    ds_read_b128 v[44:47], v2 offset:2048
    ds_read_b128 v[48:51], v2 offset:3072
    ds_read_b128 v[24:27], v2 offset:4096
    ds_read_b128 v[28:31], v2 offset:5120
    s_add_u32 s54, s45, s68
    v_lshrrev_b32 v10, 2, v0
    v_add_u32 v10, s55, v10
    v_add_u32 v32, s68, v0
    v_add_u32 v76, s69, v0
    v_add_u32 v77, s70, v0
    v_add_u32 v78, s71, v0
    s_waitcnt lgkmcnt(0)
L_loop_xsc1:
    buffer_load_dwordx4 v[16:19], v0, s[8:11], s54 offen sc1
    buffer_load_dwordx4 v[20:23], v0, s[8:11], s54 offen offset:1024 sc1
    buffer_load_dword v79, v10, s[8:11], s45 offen sc1
    s_mov_b32 s46, s44
    s_mov_b32 s44, s45
    s_and_b32 s53, s38, 1
    v_mov_b64 v[52:53], 0
    v_mov_b64 v[54:55], 0
    v_mov_b64 v[56:57], 0
    v_mov_b64 v[58:59], 0
    v_mov_b64 v[60:61], 0
    v_mov_b64 v[62:63], 0
    v_mov_b64 v[64:65], 0
    v_mov_b64 v[66:67], 0
    v_mov_b64 v[68:69], 0
    v_mov_b64 v[70:71], 0
    v_mov_b64 v[72:73], 0
    v_mov_b64 v[74:75], 0
L_pm_chk_xsc1:
    s_waitcnt vmcnt(0)
    ds_write_b128 v32, v[16:19]
    v_max3_u32 v33, v16, v17, v18
    v_max3_u32 v34, v19, v20, v21
    ds_write_b128 v32, v[20:23] offset:1024
    v_max3_u32 v33, v33, v22, v23
    v_max3_u32 v33, v33, v34, v79
    ds_write_b32 v10, v79
    v_cmp_eq_u32 vcc, -1, v33
    s_cbranch_vccnz L_pm_xsc1
L_pm_done_xsc1:
    s_mov_b64 exec, -1
    v_smfmac_f32_16x16x64_bf16 v[52:55], v[16:19], v[36:43], v1
    ds_read_b128 v[36:39], v2 offset:6144
    ds_read_b128 v[40:43], v2 offset:7168
    v_smfmac_f32_16x16x64_bf16 v[56:59], v[16:19], v[44:51], v1
    ds_read_b128 v[44:47], v2 offset:8192
    ds_read_b128 v[48:51], v2 offset:9216
    v_smfmac_f32_16x16x64_bf16 v[60:63], v[16:19], v[24:31], v1
    v_smfmac_f32_16x16x64_bf16 v[64:67], v[16:19], a[0:7], v1
    s_waitcnt lgkmcnt(4)
    s_barrier
    ds_read_b128 v[24:27], v76 offset:0
    ds_read_b128 v[28:31], v76 offset:1024
    ds_read_b128 v[32:35], v77 offset:0
    v_smfmac_f32_16x16x64_bf16 v[52:55], v[20:23], a[8:15], v1
    v_smfmac_f32_16x16x64_bf16 v[56:59], v[20:23], a[16:23], v1
    v_smfmac_f32_16x16x64_bf16 v[60:63], v[20:23], a[24:31], v1
    v_smfmac_f32_16x16x64_bf16 v[68:71], v[16:19], a[200:207], v1
    v_smfmac_f32_16x16x64_bf16 v[72:75], v[16:19], a[208:215], v1
    v_smfmac_f32_16x16x64_bf16 v[68:71], v[20:23], a[216:223], v1
    v_smfmac_f32_16x16x64_bf16 v[72:75], v[20:23], a[224:231], v1
    s_waitcnt lgkmcnt(5)
    v_smfmac_f32_16x16x64_bf16 v[64:67], v[20:23], v[36:43], v1
    ds_read_b128 v[36:39], v2 offset:10240
    ds_read_b128 v[40:43], v2 offset:11264
    s_waitcnt lgkmcnt(4)
    v_smfmac_f32_16x16x64_bf16 v[52:55], v[24:27], a[32:39], v1
    buffer_load_dwordx4 v[16:19], v0, s[8:11], s50 offen
    v_smfmac_f32_16x16x64_bf16 v[56:59], v[24:27], a[40:47], v1
    s_add_u32 s40, s38, 1
    v_smfmac_f32_16x16x64_bf16 v[60:63], v[24:27], a[48:55], v1
    buffer_load_dwordx4 v[20:23], v0, s[8:11], s50 offen offset:1024
    v_smfmac_f32_16x16x64_bf16 v[64:67], v[24:27], v[44:51], v1
    ds_read_b128 v[44:47], v2 offset:12288
    ds_read_b128 v[48:51], v2 offset:13312
    ds_read_b128 v[24:27], v77 offset:1024
    s_waitcnt lgkmcnt(6)
    v_smfmac_f32_16x16x64_bf16 v[52:55], v[28:31], a[56:63], v1
    s_and_b32 s40, s40, 3
    v_smfmac_f32_16x16x64_bf16 v[56:59], v[28:31], a[64:71], v1
    s_mul_i32 s45, s40, 9216
    v_smfmac_f32_16x16x64_bf16 v[60:63], v[28:31], a[72:79], v1
    s_add_u32 s45, s45, 61865984
    s_waitcnt lgkmcnt(3)
    v_smfmac_f32_16x16x64_bf16 v[64:67], v[28:31], v[36:43], v1
    ds_read_b128 v[36:39], v2 offset:14336
    ds_read_b128 v[40:43], v2 offset:15360
    ds_read_b128 v[28:31], v78 offset:0
    v_smfmac_f32_16x16x64_bf16 v[52:55], v[32:35], a[80:87], v1
    s_add_u32 s50, s50, 524288
    v_smfmac_f32_16x16x64_bf16 v[56:59], v[32:35], a[88:95], v1
    v_smfmac_f32_16x16x64_bf16 v[60:63], v[32:35], a[96:103], v1
    s_waitcnt lgkmcnt(4)
    v_smfmac_f32_16x16x64_bf16 v[64:67], v[32:35], v[44:51], v1
    ds_read_b128 v[44:47], v2 offset:16384
    ds_read_b128 v[48:51], v2 offset:17408
    ds_read_b128 v[32:35], v78 offset:1024
    s_waitcnt lgkmcnt(6)
    v_smfmac_f32_16x16x64_bf16 v[52:55], v[24:27], a[104:111], v1
    v_smfmac_f32_16x16x64_bf16 v[56:59], v[24:27], a[112:119], v1
    v_smfmac_f32_16x16x64_bf16 v[60:63], v[24:27], a[120:127], v1
    s_waitcnt lgkmcnt(4)
    v_smfmac_f32_16x16x64_bf16 v[64:67], v[24:27], v[36:43], v1
    ds_read_b128 v[36:39], v2 offset:18432
    ds_read_b128 v[40:43], v2 offset:19456
    ds_read_b128 v[24:27], v0 offset:8192
    s_waitcnt lgkmcnt(6)
    v_smfmac_f32_16x16x64_bf16 v[52:55], v[28:31], a[128:135], v1
    v_smfmac_f32_16x16x64_bf16 v[56:59], v[28:31], a[136:143], v1
    s_waitcnt lgkmcnt(4)
    v_smfmac_f32_16x16x64_bf16 v[64:67], v[28:31], v[44:51], v1
    ds_read_b128 v[44:47], v2 offset:20480
    ds_read_b128 v[48:51], v2 offset:21504
    s_waitcnt lgkmcnt(5)
    v_smfmac_f32_16x16x64_bf16 v[52:55], v[32:35], a[152:159], v1
    v_smfmac_f32_16x16x64_bf16 v[56:59], v[32:35], a[160:167], v1
    s_waitcnt lgkmcnt(3)
    v_smfmac_f32_16x16x64_bf16 v[64:67], v[32:35], v[36:43], v1
    s_waitcnt lgkmcnt(2)
    v_smfmac_f32_16x16x64_bf16 v[52:55], v[24:27], a[176:183], v1
    v_mov_b64 v[36:37], 0
    v_smfmac_f32_16x16x64_bf16 v[56:59], v[24:27], a[184:191], v1
    v_mov_b64 v[38:39], 0
    v_smfmac_f32_16x16x64_bf16 v[60:63], v[28:31], a[144:151], v1
    v_mov_b64 v[40:41], 0
    v_smfmac_f32_16x16x64_bf16 v[60:63], v[32:35], a[168:175], v1
    v_mov_b64 v[42:43], 0
    v_smfmac_f32_16x16x64_bf16 v[60:63], v[24:27], a[192:199], v1
    v_add_f32 v52, v52, v54
    s_waitcnt lgkmcnt(0)
    v_smfmac_f32_16x16x64_bf16 v[64:67], v[24:27], v[44:51], v1
    ds_read_b128 v[44:47], v2 offset:22528
    ds_read_b128 v[48:51], v2 offset:23552
    v_add_f32 v53, v53, v55
    v_add_f32 v56, v56, v58
    v_add_f32 v57, v57, v59
    v_cvt_pk_bf16_f32 v54, v52, v56
    v_cvt_pk_bf16_f32 v55, v53, v57
    ds_write2_b32 v3, v54, v55 offset0:0 offset1:16
    v_add_f32 v60, v60, v62
    v_add_f32 v61, v61, v63
    v_add_f32 v64, v64, v66
    v_add_f32 v65, v65, v67
    v_cvt_pk_bf16_f32 v12, v60, v64
    v_cvt_pk_bf16_f32 v13, v61, v65
    ds_write2_b32 v3, v12, v13 offset0:128 offset1:144
    s_mov_b64 exec, s[4:5]
    ds_read_b128 v[36:39], v4
    s_mov_b64 exec, s[6:7]
    ds_read_b128 v[40:43], v4
    s_mov_b64 exec, -1
    ds_read_b128 v[60:63], v5
    ds_read_b128 v[64:67], v5 offset:64
    v_smfmac_f32_16x16x64_bf16 v[68:71], v[32:35], v[232:239], v1
    v_add_u32 v76, s48, v0
    v_smfmac_f32_16x16x64_bf16 v[72:75], v[32:35], v[240:247], v1
    v_add_u32 v10, s69, v0
    ds_read_b128 v[32:35], v10 offset:0
    v_add_u32 v77, s49, v0
    s_waitcnt vmcnt(0)
    s_waitcnt lgkmcnt(4)
    v_mfma_f32_16x16x32_bf16 v[52:55], v[16:19], v[36:39], 0
    s_waitcnt lgkmcnt(2)
    v_mfma_f32_16x16x32_bf16 v[56:59], v[60:63], v[36:39], 0
    s_waitcnt lgkmcnt(1)
    v_mfma_f32_16x16x32_bf16 v[56:59], v[64:67], v[40:43], v[56:59]
    v_mfma_f32_16x16x32_bf16 v[52:55], v[20:23], v[40:43], v[52:55]
    buffer_load_dwordx4 v[16:19], v0, s[8:11], s51 offen
    v_smfmac_f32_16x16x64_bf16 v[68:71], v[28:31], v[224:231], v1
    ds_write_b32 v77, v56
    buffer_load_dwordx4 v[20:23], v0, s[8:11], s51 offen offset:1024
    v_smfmac_f32_16x16x64_bf16 v[68:71], v[24:27], v[248:255], v1
    ds_write_b128 v76, v[52:55]
    v_smfmac_f32_16x16x64_bf16 v[72:75], v[28:31], v[44:51], v1
    ds_read_b128 v[44:47], v2 offset:24576
    ds_read_b128 v[48:51], v2 offset:25600
    ds_read_b128 v[28:31], v10 offset:1024
    buffer_store_dwordx4 v[12:15], v0, s[8:11], s52 offen sc1
    s_waitcnt lgkmcnt(3)
    s_barrier
    ds_read_b128 v[52:55], v0 offset:9216
    ds_read_b128 v[56:59], v0 offset:10240
    ds_read_b128 v[60:63], v0 offset:11264
    ds_read_b128 v[64:67], v0 offset:12288
    ds_read_b128 v[36:39], v0 offset:13312
    v_smfmac_f32_16x16x64_bf16 v[68:71], v[32:35], a[232:239], v1
    v_mov_b64 v[40:41], 0
    v_lshlrev_b32 v13, 2, v0
    buffer_load_dword v12, v13, s[8:11], s73 offen
    s_add_u32 s73, s73, 524288
    v_smfmac_f32_16x16x64_bf16 v[72:75], v[32:35], a[240:247], v1
    v_add_u32 v10, s70, v0
    ds_read_b128 v[32:35], v10 offset:0
    v_mov_b64 v[42:43], 0
    s_waitcnt lgkmcnt(7)
    v_smfmac_f32_16x16x64_bf16 v[72:75], v[24:27], v[44:51], v1
    ds_read_b128 v[44:47], v2 offset:26624
    ds_read_b128 v[48:51], v2 offset:27648
    ds_read_b128 v[24:27], v10 offset:1024
    v_mov_b64 v[76:77], 0
    v_mov_b32 v78, s38
    buffer_store_dword v78, off, s[32:35], s74 sc1
    s_waitcnt lgkmcnt(9)
    v_smfmac_f32_16x16x64_bf16 v[68:71], v[28:31], a[248:255], v1
    v_mov_b64 v[78:79], 0
    s_add_u32 s51, s51, 524288
    s_add_u32 s52, s52, 131072
    s_waitcnt lgkmcnt(4)
    v_pk_add_f32 v[52:53], v[52:53], v[56:57]
    v_pk_add_f32 v[60:61], v[60:61], v[64:65]
    v_pk_add_f32 v[54:55], v[54:55], v[58:59]
    v_pk_add_f32 v[62:63], v[62:63], v[66:67]
    v_pk_add_f32 v[36:37], v[36:37], v[38:39]
    v_pk_add_f32 v[52:53], v[52:53], v[60:61]
    v_pk_add_f32 v[54:55], v[54:55], v[62:63]
    v_add_f32 v36, v36, v37
    v_max3_f32 v56, v52, v53, v54
    v_max3_f32 v56, v56, v55, v36
    s_waitcnt lgkmcnt(3)
    v_smfmac_f32_16x16x64_bf16 v[68:71], v[32:35], v[200:207], v1
    v_mov_b64 v[64:65], s[78:79]
    v_max_f32_dpp v56, v56, v56 quad_perm:[2,3,0,1] row_mask:0xf bank_mask:0xf
    v_mov_b32 v57, v56
    v_smfmac_f32_16x16x64_bf16 v[72:75], v[32:35], v[208:215], v1
    v_mov_b64 v[66:67], s[78:79]
    v_permlane16_swap_b32 v57, v56
    v_max_f32 v56, v56, v57
    v_mov_b32 v57, v56
    s_waitcnt lgkmcnt(1)
    v_smfmac_f32_16x16x64_bf16 v[72:75], v[28:31], v[44:51], v1
    ds_read_b128 v[44:47], v2 offset:28672
    ds_read_b128 v[48:51], v2 offset:29696
    v_mov_b32 v63, 0
    v_permlane32_swap_b32 v57, v56
    v_max_f32 v56, v56, v57
    s_waitcnt lgkmcnt(2)
    v_smfmac_f32_16x16x64_bf16 v[68:71], v[24:27], v[216:223], v1
    v_mul_f32 v56, s56, v56
    v_fma_f32 v52, v52, s56, -v56
    v_fma_f32 v53, v53, s56, -v56
    v_fma_f32 v54, v54, s56, -v56
    v_fma_f32 v55, v55, s56, -v56
    v_fma_f32 v36, v36, s56, -v56
    s_waitcnt lgkmcnt(0)
    v_smfmac_f32_16x16x64_bf16 v[72:75], v[24:27], v[44:51], v1
    ds_read_b128 v[44:47], v2 offset:30720
    ds_read_b128 v[48:51], v2 offset:31744
    v_exp_f32 v52, v52
    v_exp_f32 v53, v53
    v_exp_f32 v54, v54
    v_exp_f32 v55, v55
    v_exp_f32 v36, v36
    v_cvt_pk_bf16_f32 v60, v52, v53
    v_cvt_pk_bf16_f32 v61, v54, v55
    v_cvt_pk_bf16_f32 v62, v36, v63
    s_waitcnt vmcnt(3)
    v_smfmac_f32_16x16x32_bf16 v[40:43], v[60:61], v[16:19], v1
    v_add_f32 v68, v68, v70
    v_add_f32 v69, v69, v71
    v_smfmac_f32_16x16x32_bf16 v[76:79], v[60:61], v[20:23], v1
    v_add_f32 v72, v72, v74
    v_add_f32 v73, v73, v75
    v_mfma_f32_16x16x32_bf16 v[32:35], v[60:63], v[64:67], 0
    v_cvt_pk_bf16_f32 v68, v68, v69
    v_cvt_pk_bf16_f32 v69, v72, v73
    v_cvt_pk_bf16_f32 v70, v72, v73
    v_mov_b32 v71, 0
    v_mov_b32 v72, 0
    ds_read_b128 v[24:27], v2 offset:32768
    ds_read_b128 v[28:31], v2 offset:33792
    v_smfmac_f32_16x16x32_bf16 v[40:43], v[62:63], v[68:71], v1 abid:2
    ds_read_b128 v[16:19], v2 offset:34816
    ds_read_b128 v[20:23], v2 offset:35840
    v_add_f32 v32, v32, v34
    v_smfmac_f32_16x16x32_bf16 v[76:79], v[62:63], v[70:73], v1 abid:2
    v_add_f32 v33, v33, v35
    v_rcp_f32 v32, v32
    v_rcp_f32 v33, v33
    v_mov_b64 v[14:15], v[68:69]
    s_cmp_eq_u32 s38, 63
    s_cbranch_scc1 L_exit_xsc1
    v_mov_b64 v[36:37], 0
    v_mov_b64 v[38:39], 0
    v_add_f32 v40, v40, v42
    v_add_f32 v41, v41, v43
    v_add_f32 v76, v76, v78
    v_add_f32 v77, v77, v79
    v_pk_mul_f32 v[40:41], v[40:41], v[32:33]
    v_pk_mul_f32 v[76:77], v[76:77], v[32:33]
    v_cvt_pk_bf16_f32 v34, v40, v76
    v_cvt_pk_bf16_f32 v35, v41, v77
    ds_write2_b32 v6, v34, v35 offset0:0 offset1:4
    v_and_b32 v10, 32, v0
    v_lshl_add_u32 v10, v10, 5, v11
    v_mov_b64 v[40:41], 0
    v_mov_b64 v[42:43], 0
    v_mov_b64 v[76:77], 0
    v_mov_b64 v[78:79], 0
    s_waitcnt lgkmcnt(0)
    s_barrier
    ds_read_b128 v[52:55], v11 offset:0
    ds_read_b128 v[56:59], v11 offset:512
    ds_read_b128 v[60:63], v11 offset:1024
    ds_read_b128 v[64:67], v11 offset:1536
    ds_read_b128 v[68:71], v10 offset:0
    ds_read_b128 v[72:75], v10 offset:512
    v_mov_b64 v[32:33], 0
    v_mov_b64 v[34:35], 0
    s_waitcnt lgkmcnt(5)
    v_smfmac_f32_16x16x64_bf16 v[40:43], v[52:55], v[88:95], v1
    v_smfmac_f32_16x16x64_bf16 v[76:79], v[52:55], v[96:103], v1
    s_waitcnt lgkmcnt(4)
    v_smfmac_f32_16x16x64_bf16 v[40:43], v[56:59], v[24:31], v1
    v_smfmac_f32_16x16x64_bf16 v[76:79], v[56:59], v[120:127], v1
    v_mov_b64 v[24:25], 0
    s_waitcnt lgkmcnt(3)
    v_smfmac_f32_16x16x64_bf16 v[40:43], v[60:63], v[144:151], v1
    v_mov_b64 v[26:27], 0
    s_waitcnt lgkmcnt(2)
    v_smfmac_f32_16x16x64_bf16 v[40:43], v[64:67], v[16:23], v1
    v_smfmac_f32_16x16x64_bf16 v[76:79], v[60:63], v[152:159], v1
    v_smfmac_f32_16x16x64_bf16 v[76:79], v[64:67], v[176:183], v1
    s_waitcnt lgkmcnt(1)
    v_smfmac_f32_16x16x64_bf16 v[36:39], v[68:71], v[80:87], v1
    v_cvt_pk_bf16_f32 v40, v40, v42
    s_waitcnt lgkmcnt(0)
    v_smfmac_f32_16x16x64_bf16 v[36:39], v[72:75], v[44:51], v1
    v_cvt_pk_bf16_f32 v42, v41, v43
    v_smfmac_f32_16x16x64_bf16 v[32:35], v[52:55], v[104:111], v1
    v_and_or_b32 v40, v40, -2, s53
    v_and_or_b32 v42, v42, -2, s53
    v_smfmac_f32_16x16x64_bf16 v[32:35], v[56:59], v[128:135], v1
    v_cvt_pk_bf16_f32 v41, v76, v78
    v_smfmac_f32_16x16x64_bf16 v[32:35], v[60:63], v[160:167], v1
    v_cvt_pk_bf16_f32 v43, v77, v79
    buffer_store_dwordx4 v[40:43], v0, s[8:11], s47 offen offset:0 sc1
    v_add_f32 v36, v36, v38
    v_smfmac_f32_16x16x64_bf16 v[32:35], v[64:67], v[184:191], v1
    v_add_f32 v37, v37, v39
    v_cndmask_b32 v38, v36, v37, s[76:77]
    v_smfmac_f32_16x16x64_bf16 v[24:27], v[52:55], v[112:119], v1
    s_nop 0
    v_mov_b32_dpp v39, v38 quad_perm:[1,0,3,2] row_mask:0xf bank_mask:0xf
    v_cndmask_b32 v36, v39, v36, s[76:77]
    v_smfmac_f32_16x16x64_bf16 v[24:27], v[56:59], v[136:143], v1
    v_cndmask_b32 v37, v37, v39, s[76:77]
    v_smfmac_f32_16x16x64_bf16 v[24:27], v[60:63], v[168:175], v1
    v_cvt_pk_bf16_f32 v36, v36, v37
    v_and_or_b32 v36, v36, -2, s53
    v_smfmac_f32_16x16x64_bf16 v[24:27], v[64:67], v[192:199], v1
    buffer_store_dword v36, v7, s[8:11], s47 offen sc1
    v_cvt_pk_bf16_f32 v32, v32, v34
    v_cvt_pk_bf16_f32 v34, v33, v35
    v_and_or_b32 v32, v32, -2, s53
    v_and_or_b32 v34, v34, -2, s53
    s_nop 2
    v_cvt_pk_bf16_f32 v33, v24, v26
    v_cvt_pk_bf16_f32 v35, v25, v27
    buffer_store_dwordx4 v[32:35], v0, s[8:11], s47 offen offset:1024 sc1
    ds_read_b128 v[36:39], v2 offset:0
    ds_read_b128 v[40:43], v2 offset:1024
    ds_read_b128 v[44:47], v2 offset:2048
    ds_read_b128 v[48:51], v2 offset:3072
    ds_read_b128 v[24:27], v2 offset:4096
    ds_read_b128 v[28:31], v2 offset:5120
    s_add_u32 s54, s45, s68
    v_lshrrev_b32 v10, 2, v0
    v_add_u32 v10, s55, v10
    v_add_u32 v32, s68, v0
    v_add_u32 v76, s69, v0
    v_add_u32 v77, s70, v0
    v_add_u32 v78, s71, v0
    s_waitcnt lgkmcnt(0)
    s_add_u32 s39, s38, 3
    s_cmp_ge_u32 s39, s75
    s_cbranch_scc1 L_rdy_xsc1
L_rdy_done_xsc1:
    s_barrier
    s_add_u32 s38, s38, 1
    s_cmp_lt_u32 s38, 64
    s_cbranch_scc1 L_loop_xsc1
    s_branch L_exit_xsc1
L_pm_xsc1:
    s_mov_b64 exec, vcc
    buffer_load_dwordx4 v[16:19], v0, s[8:11], s54 offen sc1
    buffer_load_dwordx4 v[20:23], v0, s[8:11], s54 offen offset:1024 sc1
    buffer_load_dword v79, v10, s[8:11], s45 offen sc1
    s_add_u32 s59, s59, 1
    s_cmp_gt_u32 s59, 300000
    s_cbranch_scc1 L_pm_done_xsc1
    s_branch L_pm_chk_xsc1
L_rdy_xsc1:
    v_lshrrev_b32 v52, 2, v0
    v_and_b32 v52, 60, v52
    buffer_load_dword v53, v52, s[32:35], 0 offen offset:160 sc1
    s_add_u32 s59, s59, 1
    s_waitcnt vmcnt(0)
    v_cmp_gt_u32 vcc, 128, v53
    s_or_b32 s40, vcc_lo, 0x10000
    s_ff1_i32_b32 s40, s40
    s_lshl_b32 s75, s40, 2
    s_cmp_eq_u32 s40, 16
    s_cselect_b32 s75, 100, s75
    s_cmp_gt_u32 s59, 300000
    s_cbranch_scc1 L_rdy_done_xsc1
    s_cmp_ge_u32 s39, s75
    s_cbranch_scc1 L_rdy_xsc1
    s_branch L_rdy_done_xsc1
L_exit_xsc1:
L_fin_n:
    v_mov_b32 v20, 100
    buffer_store_dword v20, off, s[32:35], s74 sc1
L_fin:
    buffer_store_dwordx4 v[12:15], v0, s[8:11], s52 offen sc1
    s_branch L_end
L_worker:
    s_mov_b32 s20, s88
    s_mov_b32 s21, s89
    s_mov_b32 s22, 256
    s_mov_b32 s23, 0x00020000
    s_mov_b32 s8, s90
    s_mov_b32 s9, s91
    s_mov_b32 s10, 268435456
    s_mov_b32 s11, 0x00020000
    s_mov_b32 s33, s93
    s_sub_u32 s39, s3, 1
    s_lshl_b32 s34, s39, 5
    s_add_u32 s34, s34, s92
    s_mov_b32 s12, s64
    s_mov_b32 s13, s65
    s_mov_b32 s14, 2359296
    s_mov_b32 s15, 0x00020000
    s_mov_b32 s28, s84
    s_mov_b32 s29, s85
    s_mov_b32 s30, 1152
    s_mov_b32 s31, 0x00020000
    s_mov_b32 s40, 0x05040100
    s_mov_b32 s41, 0x07060302
    v_and_b32 v4, 15, v0
    v_lshrrev_b32 v5, 4, v0
    v_mov_b32 v1, v0
    v_lshlrev_b32 v0, 4, v0
    s_lshl_b32 s35, s33, 12
    s_add_u32 s35, s35, 110592
    v_add_u32 v57, s35, v0
    v_lshlrev_b32 v58, 9, v5
    v_lshl_add_u32 v58, v4, 2, v58
    v_add_u32 v58, s35, v58
    s_cmp_lt_u32 s34, 128
    s_cbranch_scc1 L_noinit
    s_sub_u32 s36, s34, 128
    s_lshl_b32 s36, s36, 2
    s_add_u32 s36, s36, s33
    s_mov_b32 s16, s74
    s_mov_b32 s17, s75
    s_mov_b32 s18, 4718592
    s_mov_b32 s19, 0x00020000
    s_mov_b32 s24, s68
    s_mov_b32 s25, s69
    s_mov_b32 s26, 4718592
    s_mov_b32 s27, 0x00020000
    v_lshlrev_b32 v2, 3, v0
    s_mul_i32 s35, s36, 12288
    s_add_u32 s37, s35, 4096
    buffer_load_dword v250, v2, s[16:19], s35 offen
    buffer_load_dword v251, v2, s[16:19], s37 offen
    buffer_load_dword v250, v2, s[24:27], s35 offen
    buffer_load_dword v251, v2, s[24:27], s37 offen
    v_mov_b32 v24, -1
    v_mov_b32 v25, -1
    v_mov_b32 v26, -1
    v_mov_b32 v27, -1
    s_lshl_b32 s35, s36, 10
    s_add_u32 s35, s35, 50331648
    buffer_store_dwordx4 v[24:27], v0, s[8:11], s35 offen sc1
    s_add_u32 s35, s35, 393216
    buffer_store_dwordx4 v[24:27], v0, s[8:11], s35 offen sc1
    s_add_u32 s35, s35, 393216
    buffer_store_dwordx4 v[24:27], v0, s[8:11], s35 offen sc1
    s_add_u32 s35, s35, 393216
    buffer_store_dwordx4 v[24:27], v0, s[8:11], s35 offen sc1
    s_add_u32 s35, s35, 393216
    buffer_store_dwordx4 v[24:27], v0, s[8:11], s35 offen sc1
    s_add_u32 s35, s35, 393216
    buffer_store_dwordx4 v[24:27], v0, s[8:11], s35 offen sc1
    s_add_u32 s35, s35, 393216
    buffer_store_dwordx4 v[24:27], v0, s[8:11], s35 offen sc1
    s_add_u32 s35, s35, 393216
    buffer_store_dwordx4 v[24:27], v0, s[8:11], s35 offen sc1
    s_add_u32 s35, s35, 393216
    buffer_store_dwordx4 v[24:27], v0, s[8:11], s35 offen sc1
    s_add_u32 s35, s35, 393216
    buffer_store_dwordx4 v[24:27], v0, s[8:11], s35 offen sc1
    s_add_u32 s35, s35, 393216
    buffer_store_dwordx4 v[24:27], v0, s[8:11], s35 offen sc1
    s_add_u32 s35, s35, 393216
    buffer_store_dwordx4 v[24:27], v0, s[8:11], s35 offen sc1
    s_add_u32 s35, s35, 393216
    buffer_store_dwordx4 v[24:27], v0, s[8:11], s35 offen sc1
    s_add_u32 s35, s35, 393216
    buffer_store_dwordx4 v[24:27], v0, s[8:11], s35 offen sc1
    s_add_u32 s35, s35, 393216
    buffer_store_dwordx4 v[24:27], v0, s[8:11], s35 offen sc1
    s_add_u32 s35, s35, 393216
    buffer_store_dwordx4 v[24:27], v0, s[8:11], s35 offen sc1
    s_add_u32 s35, s35, 393216
    buffer_store_dwordx4 v[24:27], v0, s[8:11], s35 offen sc1
    s_add_u32 s35, s35, 393216
    buffer_store_dwordx4 v[24:27], v0, s[8:11], s35 offen sc1
    s_add_u32 s35, s35, 393216
    buffer_store_dwordx4 v[24:27], v0, s[8:11], s35 offen sc1
    s_add_u32 s35, s35, 393216
    buffer_store_dwordx4 v[24:27], v0, s[8:11], s35 offen sc1
    s_add_u32 s35, s35, 393216
    buffer_store_dwordx4 v[24:27], v0, s[8:11], s35 offen sc1
    s_add_u32 s35, s35, 393216
    s_cmp_ge_u32 s36, 256
    s_cbranch_scc1 L_pz_done
    buffer_store_dwordx4 v[24:27], v0, s[8:11], s35 offen sc1
    s_add_u32 s35, s35, 393216
L_pz_done:
    s_cmp_ge_u32 s36, 256
    s_cbranch_scc1 L_g_done
    v_lshrrev_b32 v2, 3, v1
    v_and_b32 v3, 7, v1
    v_lshlrev_b32 v3, 4, v3
    v_mul_u32_u24 v6, 1152, v2
    v_add_u32 v6, v6, v3
    s_mul_i32 s35, s36, 9216
    buffer_load_dwordx4 v[64:67], v6, s[12:15], s35 offen offset:0
    buffer_load_dwordx4 v[100:103], v3, s[28:31], 0 offen offset:0
    buffer_load_dwordx4 v[68:71], v6, s[12:15], s35 offen offset:128
    buffer_load_dwordx4 v[104:107], v3, s[28:31], 0 offen offset:128
    buffer_load_dwordx4 v[72:75], v6, s[12:15], s35 offen offset:256
    buffer_load_dwordx4 v[108:111], v3, s[28:31], 0 offen offset:256
    buffer_load_dwordx4 v[76:79], v6, s[12:15], s35 offen offset:384
    buffer_load_dwordx4 v[112:115], v3, s[28:31], 0 offen offset:384
    buffer_load_dwordx4 v[80:83], v6, s[12:15], s35 offen offset:512
    buffer_load_dwordx4 v[116:119], v3, s[28:31], 0 offen offset:512
    buffer_load_dwordx4 v[84:87], v6, s[12:15], s35 offen offset:640
    buffer_load_dwordx4 v[120:123], v3, s[28:31], 0 offen offset:640
    buffer_load_dwordx4 v[88:91], v6, s[12:15], s35 offen offset:768
    buffer_load_dwordx4 v[124:127], v3, s[28:31], 0 offen offset:768
    buffer_load_dwordx4 v[92:95], v6, s[12:15], s35 offen offset:896
    buffer_load_dwordx4 v[128:131], v3, s[28:31], 0 offen offset:896
    buffer_load_dwordx4 v[96:99], v6, s[12:15], s35 offen offset:1024
    buffer_load_dwordx4 v[132:135], v3, s[28:31], 0 offen offset:1024
    v_mov_b32 v7, 0
    v_mov_b32 v8, 0
    s_waitcnt vmcnt(0)
    v_dot2_f32_bf16 v7, v64, v100, v7
    v_dot2_f32_bf16 v8, v65, v101, v8
    v_dot2_f32_bf16 v7, v66, v102, v7
    v_dot2_f32_bf16 v8, v67, v103, v8
    v_dot2_f32_bf16 v7, v68, v104, v7
    v_dot2_f32_bf16 v8, v69, v105, v8
    v_dot2_f32_bf16 v7, v70, v106, v7
    v_dot2_f32_bf16 v8, v71, v107, v8
    v_dot2_f32_bf16 v7, v72, v108, v7
    v_dot2_f32_bf16 v8, v73, v109, v8
    v_dot2_f32_bf16 v7, v74, v110, v7
    v_dot2_f32_bf16 v8, v75, v111, v8
    v_dot2_f32_bf16 v7, v76, v112, v7
    v_dot2_f32_bf16 v8, v77, v113, v8
    v_dot2_f32_bf16 v7, v78, v114, v7
    v_dot2_f32_bf16 v8, v79, v115, v8
    v_dot2_f32_bf16 v7, v80, v116, v7
    v_dot2_f32_bf16 v8, v81, v117, v8
    v_dot2_f32_bf16 v7, v82, v118, v7
    v_dot2_f32_bf16 v8, v83, v119, v8
    v_dot2_f32_bf16 v7, v84, v120, v7
    v_dot2_f32_bf16 v8, v85, v121, v8
    v_dot2_f32_bf16 v7, v86, v122, v7
    v_dot2_f32_bf16 v8, v87, v123, v8
    v_dot2_f32_bf16 v7, v88, v124, v7
    v_dot2_f32_bf16 v8, v89, v125, v8
    v_dot2_f32_bf16 v7, v90, v126, v7
    v_dot2_f32_bf16 v8, v91, v127, v8
    v_dot2_f32_bf16 v7, v92, v128, v7
    v_dot2_f32_bf16 v8, v93, v129, v8
    v_dot2_f32_bf16 v7, v94, v130, v7
    v_dot2_f32_bf16 v8, v95, v131, v8
    v_dot2_f32_bf16 v7, v96, v132, v7
    v_dot2_f32_bf16 v8, v97, v133, v8
    v_dot2_f32_bf16 v7, v98, v134, v7
    v_dot2_f32_bf16 v8, v99, v135, v8
    s_nop 3
    v_add_f32 v7, v7, v8
    s_nop 1
    v_add_f32_dpp v7, v7, v7 quad_perm:[1,0,3,2] row_mask:0xf bank_mask:0xf
    s_nop 1
    v_add_f32_dpp v7, v7, v7 quad_perm:[2,3,0,1] row_mask:0xf bank_mask:0xf
    s_nop 1
    v_add_f32_dpp v7, v7, v7 row_half_mirror row_mask:0xf bank_mask:0xf
    v_mul_f32 v7, 0xbfb8aa3b, v7
    v_exp_f32 v7, v7
    s_nop 0
    v_add_f32 v7, 1.0, v7
    v_rcp_f32 v7, v7
    v_lshlrev_b32 v2, 2, v2
    s_lshl_b32 s35, s36, 5
    s_add_u32 s35, s35, 67108864
    buffer_store_dword v7, v2, s[8:11], s35 offen sc1
L_g_done:
    s_waitcnt vmcnt(0)
    s_barrier
    s_cmp_lg_u32 s33, 0
    s_cbranch_scc1 L_siginit
    v_mov_b32 v2, 8
    v_mov_b32 v3, 1
    s_mov_b64 exec, 1
    buffer_atomic_add v3, v2, s[20:23], 0 offen
    s_mov_b64 exec, -1
L_siginit:
L_noinit:
    v_lshrrev_b32 v2, 2, v4
    v_lshlrev_b32 v2, 3, v2
    v_bfe_u32 v3, v4, 1, 1
    v_lshl_add_u32 v2, v3, 2, v2
    v_and_b32 v3, 1, v4
    v_add_u32 v2, v2, v3
    v_mul_u32_u24 v2, 1152, v2
    v_lshrrev_b32 v3, 1, v4
    v_xor_b32 v3, v3, v5
    v_lshl_add_u32 v16, v3, 4, v2
    v_xor_b32 v3, 4, v3
    v_lshl_add_u32 v17, v3, 4, v2
    v_add_u32 v18, 2304, v16
    v_add_u32 v19, 2304, v17
    s_lshl_b32 s35, s33, 6
    s_add_u32 s35, s35, 0
    v_lshrrev_b32 v2, 4, v0
    v_add_u32 v2, s35, v2
    v_mul_u32_u24 v3, 3641, v2
    v_lshrrev_b32 v3, 18, v3
    v_bfe_u32 v24, v3, 2, 3
    v_xor_b32 v2, v2, v24
    v_lshlrev_b32 v6, 4, v2
    s_lshl_b32 s35, s33, 6
    s_add_u32 s35, s35, 256
    v_lshrrev_b32 v2, 4, v0
    v_add_u32 v2, s35, v2
    v_mul_u32_u24 v3, 3641, v2
    v_lshrrev_b32 v3, 18, v3
    v_bfe_u32 v24, v3, 2, 3
    v_xor_b32 v2, v2, v24
    v_lshlrev_b32 v7, 4, v2
    s_lshl_b32 s35, s33, 6
    s_add_u32 s35, s35, 512
    v_lshrrev_b32 v2, 4, v0
    v_add_u32 v2, s35, v2
    v_mul_u32_u24 v3, 3641, v2
    v_lshrrev_b32 v3, 18, v3
    v_bfe_u32 v24, v3, 2, 3
    v_xor_b32 v2, v2, v24
    v_lshlrev_b32 v8, 4, v2
    s_lshl_b32 s35, s33, 6
    s_add_u32 s35, s35, 768
    v_lshrrev_b32 v2, 4, v0
    v_add_u32 v2, s35, v2
    v_mul_u32_u24 v3, 3641, v2
    v_lshrrev_b32 v3, 18, v3
    v_bfe_u32 v24, v3, 2, 3
    v_xor_b32 v2, v2, v24
    v_lshlrev_b32 v9, 4, v2
    s_lshl_b32 s35, s33, 6
    s_add_u32 s35, s35, 1024
    v_lshrrev_b32 v2, 4, v0
    v_add_u32 v2, s35, v2
    v_mul_u32_u24 v3, 3641, v2
    v_lshrrev_b32 v3, 18, v3
    v_bfe_u32 v24, v3, 2, 3
    v_xor_b32 v2, v2, v24
    v_lshlrev_b32 v10, 4, v2
    s_lshl_b32 s35, s33, 6
    s_add_u32 s35, s35, 1280
    v_lshrrev_b32 v2, 4, v0
    v_add_u32 v2, s35, v2
    v_mul_u32_u24 v3, 3641, v2
    v_lshrrev_b32 v3, 18, v3
    v_bfe_u32 v24, v3, 2, 3
    v_xor_b32 v2, v2, v24
    v_lshlrev_b32 v11, 4, v2
    s_lshl_b32 s35, s33, 6
    s_add_u32 s35, s35, 1536
    v_lshrrev_b32 v2, 4, v0
    v_add_u32 v2, s35, v2
    v_mul_u32_u24 v3, 3641, v2
    v_lshrrev_b32 v3, 18, v3
    v_bfe_u32 v24, v3, 2, 3
    v_xor_b32 v2, v2, v24
    v_lshlrev_b32 v12, 4, v2
    s_lshl_b32 s35, s33, 6
    s_add_u32 s35, s35, 1792
    v_lshrrev_b32 v2, 4, v0
    v_add_u32 v2, s35, v2
    v_mul_u32_u24 v3, 3641, v2
    v_lshrrev_b32 v3, 18, v3
    v_bfe_u32 v24, v3, 2, 3
    v_xor_b32 v2, v2, v24
    v_lshlrev_b32 v13, 4, v2
    s_lshl_b32 s35, s33, 6
    s_add_u32 s35, s35, 2048
    v_lshrrev_b32 v2, 4, v0
    v_add_u32 v2, s35, v2
    v_mul_u32_u24 v3, 3641, v2
    v_lshrrev_b32 v3, 18, v3
    v_bfe_u32 v24, v3, 2, 3
    v_xor_b32 v2, v2, v24
    v_lshlrev_b32 v14, 4, v2
    s_mov_b32 s45, 8192
    s_mov_b32 s18, 4718592
    s_mov_b32 s19, 0x00020000
    s_mov_b32 s52, 0
    v_lshrrev_b32 v2, 3, v1
    v_lshlrev_b32 v56, 13, v2
    v_and_b32 v3, 7, v1
    v_lshl_add_u32 v56, v3, 4, v56
    v_lshlrev_b32 v59, 10, v5
    v_lshl_add_u32 v59, v4, 2, v59
    s_and_b32 s35, s33, 1
    s_lshl_b32 s36, s35, 6
    s_lshr_b32 s37, s33, 1
    s_lshl_b32 s38, s37, 13
    s_add_u32 s36, s36, s38
    s_add_u32 s36, s36, 110592
    v_add_u32 v59, s36, v59
    s_lshl_b32 s50, s35, 18
    s_lshl_b32 s37, s37, 7
    s_add_u32 s50, s50, s37
    v_lshrrev_b32 v2, 2, v1
    v_and_b32 v3, 3, v1
    s_cmp_ge_u32 s34, 176
    s_cbranch_scc1 L_job_b
    s_cmp_ge_u32 s34, 128
    s_cbranch_scc1 L_job_q
    s_lshr_b32 s32, s34, 2
    s_and_b32 s42, s34, 3
    s_mov_b32 s62, 4
    s_lshl_b32 s46, s32, 8
    s_add_u32 s46, s46, s50
    s_lshl_b32 s44, s42, 19
    s_lshl_b32 s35, s32, 14
    s_add_u32 s44, s44, s35
    s_lshl_b32 s35, s33, 11
    s_add_u32 s44, s44, s35
    s_add_u32 s60, s44, 8192
    s_mov_b32 s55, 2097152
    s_mov_b32 s48, 40
    s_mov_b32 s16, s72
    s_mov_b32 s17, s73
    s_mov_b32 s63, s46
    s_mov_b32 s28, s70
    s_mov_b32 s29, s71
    s_mov_b32 s30, 4718592
    s_mov_b32 s31, 0x00020000
    s_mov_b32 s53, 0
    s_branch L_lwf2
L_run0:
    s_barrier
    s_mul_i32 s49, s42, 36864
    s_mul_i32 s43, s62, 36864
    s_lshl_b32 s58, s33, 10
    s_mov_b32 s59, 0
    s_mov_b32 s47, 0
    s_mov_b32 s61, 0
    s_mov_b32 s38, 1069066811
    s_mov_b32 s37, 0x358637bd
    s_add_u32 m0, s58, 0
    s_nop 0
    buffer_load_dwordx4 v6, s[12:15], s49 offen lds
    s_add_u32 m0, s58, 4096
    s_nop 0
    buffer_load_dwordx4 v7, s[12:15], s49 offen lds
    s_add_u32 m0, s58, 8192
    s_nop 0
    buffer_load_dwordx4 v8, s[12:15], s49 offen lds
    s_add_u32 m0, s58, 12288
    s_nop 0
    buffer_load_dwordx4 v9, s[12:15], s49 offen lds
    s_add_u32 m0, s58, 16384
    s_nop 0
    buffer_load_dwordx4 v10, s[12:15], s49 offen lds
    s_add_u32 m0, s58, 20480
    s_nop 0
    buffer_load_dwordx4 v11, s[12:15], s49 offen lds
    s_add_u32 m0, s58, 24576
    s_nop 0
    buffer_load_dwordx4 v12, s[12:15], s49 offen lds
    s_add_u32 m0, s58, 28672
    s_nop 0
    buffer_load_dwordx4 v13, s[12:15], s49 offen lds
    s_add_u32 m0, s58, 32768
    s_nop 0
    buffer_load_dwordx4 v14, s[12:15], s49 offen lds
    s_add_u32 s49, s49, s43
    s_add_u32 s58, s58, 36864
    s_add_u32 m0, s58, 0
    s_nop 0
    buffer_load_dwordx4 v6, s[12:15], s49 offen lds
    s_add_u32 m0, s58, 4096
    s_nop 0
    buffer_load_dwordx4 v7, s[12:15], s49 offen lds
    s_add_u32 m0, s58, 8192
    s_nop 0
    buffer_load_dwordx4 v8, s[12:15], s49 offen lds
    s_add_u32 m0, s58, 12288
    s_nop 0
    buffer_load_dwordx4 v9, s[12:15], s49 offen lds
    s_add_u32 m0, s58, 16384
    s_nop 0
    buffer_load_dwordx4 v10, s[12:15], s49 offen lds
    s_add_u32 m0, s58, 20480
    s_nop 0
    buffer_load_dwordx4 v11, s[12:15], s49 offen lds
    s_add_u32 m0, s58, 24576
    s_nop 0
    buffer_load_dwordx4 v12, s[12:15], s49 offen lds
    s_add_u32 m0, s58, 28672
    s_nop 0
    buffer_load_dwordx4 v13, s[12:15], s49 offen lds
    s_add_u32 m0, s58, 32768
    s_nop 0
    buffer_load_dwordx4 v14, s[12:15], s49 offen lds
    s_add_u32 s49, s49, s43
    s_add_u32 s58, s58, 36864
    s_waitcnt vmcnt(9)
L_gKV_top:
    s_barrier
    v_add_u32 v20, s59, v16
    v_add_u32 v21, s59, v17
    v_add_u32 v22, s59, v18
    v_add_u32 v23, s59, v19
    ds_read_b128 v[24:27], v20 offset:0
    ds_read_b128 v[28:31], v22 offset:0
    ds_read_b128 v[32:35], v21 offset:0
    ds_read_b128 v[36:39], v23 offset:0
    s_cmp_eq_u32 s61, 0
    s_cbranch_scc1 L_gKV_np
    s_cmp_lg_u32 s33, 0
    s_cbranch_scc1 L_gKV_np
    s_lshr_b32 s35, s61, 8
    s_and_b32 s36, s61, 0xff
    v_mov_b32 v2, s35
    v_mov_b32 v3, s36
    s_mov_b64 exec, 1
    buffer_atomic_add v3, v2, s[20:23], 0 offen
    s_mov_b64 exec, -1
L_gKV_np:
    s_mov_b32 s61, 0
    ds_read_b128 v[240:243], v20 offset:128
    ds_read_b128 v[244:247], v22 offset:128
    s_waitcnt lgkmcnt(4)
    v_mfma_f32_16x16x32_bf16 v[40:43], v[64:67], v[24:27], 0
    s_add_u32 m0, s58, 0
    s_nop 0
    buffer_load_dwordx4 v6, s[12:15], s49 offen lds
    v_mfma_f32_16x16x32_bf16 v[44:47], v[68:71], v[24:27], 0
    v_mfma_f32_16x16x32_bf16 v[224:227], v[24:27], a[0:3], 0
    v_mfma_f32_16x16x32_bf16 v[228:231], v[24:27], a[4:7], 0
    v_mfma_f32_16x16x32_bf16 v[48:51], v[64:67], v[28:31], 0
    v_mfma_f32_16x16x32_bf16 v[52:55], v[68:71], v[28:31], 0
    v_mfma_f32_16x16x32_bf16 v[232:235], v[28:31], a[0:3], 0
    v_mfma_f32_16x16x32_bf16 v[236:239], v[28:31], a[4:7], 0
    ds_read_b128 v[248:251], v21 offset:128
    ds_read_b128 v[252:255], v23 offset:128
    s_waitcnt lgkmcnt(4)
    v_mfma_f32_16x16x32_bf16 v[40:43], v[72:75], v[32:35], v[40:43]
    v_mfma_f32_16x16x32_bf16 v[44:47], v[76:79], v[32:35], v[44:47]
    v_mfma_f32_16x16x32_bf16 v[224:227], v[32:35], a[8:11], v[224:227]
    v_mfma_f32_16x16x32_bf16 v[228:231], v[32:35], a[12:15], v[228:231]
    v_mfma_f32_16x16x32_bf16 v[48:51], v[72:75], v[36:39], v[48:51]
    v_mfma_f32_16x16x32_bf16 v[52:55], v[76:79], v[36:39], v[52:55]
    v_mfma_f32_16x16x32_bf16 v[232:235], v[36:39], a[8:11], v[232:235]
    v_mfma_f32_16x16x32_bf16 v[236:239], v[36:39], a[12:15], v[236:239]
    ds_read_b128 v[24:27], v20 offset:256
    ds_read_b128 v[28:31], v22 offset:256
    s_waitcnt lgkmcnt(4)
    v_mfma_f32_16x16x32_bf16 v[40:43], v[80:83], v[240:243], v[40:43]
    s_add_u32 m0, s58, 4096
    s_nop 0
    buffer_load_dwordx4 v7, s[12:15], s49 offen lds
    v_mfma_f32_16x16x32_bf16 v[44:47], v[84:87], v[240:243], v[44:47]
    v_mfma_f32_16x16x32_bf16 v[224:227], v[240:243], a[16:19], v[224:227]
    v_mfma_f32_16x16x32_bf16 v[228:231], v[240:243], a[20:23], v[228:231]
    v_mfma_f32_16x16x32_bf16 v[48:51], v[80:83], v[244:247], v[48:51]
    v_mfma_f32_16x16x32_bf16 v[52:55], v[84:87], v[244:247], v[52:55]
    v_mfma_f32_16x16x32_bf16 v[232:235], v[244:247], a[16:19], v[232:235]
    v_mfma_f32_16x16x32_bf16 v[236:239], v[244:247], a[20:23], v[236:239]
    ds_read_b128 v[32:35], v21 offset:256
    ds_read_b128 v[36:39], v23 offset:256
    s_waitcnt lgkmcnt(4)
    v_mfma_f32_16x16x32_bf16 v[40:43], v[88:91], v[248:251], v[40:43]
    v_mfma_f32_16x16x32_bf16 v[44:47], v[92:95], v[248:251], v[44:47]
    v_mfma_f32_16x16x32_bf16 v[224:227], v[248:251], a[24:27], v[224:227]
    v_mfma_f32_16x16x32_bf16 v[228:231], v[248:251], a[28:31], v[228:231]
    v_mfma_f32_16x16x32_bf16 v[48:51], v[88:91], v[252:255], v[48:51]
    v_mfma_f32_16x16x32_bf16 v[52:55], v[92:95], v[252:255], v[52:55]
    v_mfma_f32_16x16x32_bf16 v[232:235], v[252:255], a[24:27], v[232:235]
    v_mfma_f32_16x16x32_bf16 v[236:239], v[252:255], a[28:31], v[236:239]
    ds_read_b128 v[240:243], v20 offset:384
    ds_read_b128 v[244:247], v22 offset:384
    s_waitcnt lgkmcnt(4)
    v_mfma_f32_16x16x32_bf16 v[40:43], v[96:99], v[24:27], v[40:43]
    s_add_u32 m0, s58, 8192
    s_nop 0
    buffer_load_dwordx4 v8, s[12:15], s49 offen lds
    v_mfma_f32_16x16x32_bf16 v[44:47], v[100:103], v[24:27], v[44:47]
    v_mfma_f32_16x16x32_bf16 v[224:227], v[24:27], a[32:35], v[224:227]
    v_mfma_f32_16x16x32_bf16 v[228:231], v[24:27], a[36:39], v[228:231]
    v_mfma_f32_16x16x32_bf16 v[48:51], v[96:99], v[28:31], v[48:51]
    v_mfma_f32_16x16x32_bf16 v[52:55], v[100:103], v[28:31], v[52:55]
    v_mfma_f32_16x16x32_bf16 v[232:235], v[28:31], a[32:35], v[232:235]
    v_mfma_f32_16x16x32_bf16 v[236:239], v[28:31], a[36:39], v[236:239]
    ds_read_b128 v[248:251], v21 offset:384
    ds_read_b128 v[252:255], v23 offset:384
    s_waitcnt lgkmcnt(4)
    v_mfma_f32_16x16x32_bf16 v[40:43], v[104:107], v[32:35], v[40:43]
    v_mfma_f32_16x16x32_bf16 v[44:47], v[108:111], v[32:35], v[44:47]
    v_mfma_f32_16x16x32_bf16 v[224:227], v[32:35], a[40:43], v[224:227]
    v_mfma_f32_16x16x32_bf16 v[228:231], v[32:35], a[44:47], v[228:231]
    v_mfma_f32_16x16x32_bf16 v[48:51], v[104:107], v[36:39], v[48:51]
    v_mfma_f32_16x16x32_bf16 v[52:55], v[108:111], v[36:39], v[52:55]
    v_mfma_f32_16x16x32_bf16 v[232:235], v[36:39], a[40:43], v[232:235]
    v_mfma_f32_16x16x32_bf16 v[236:239], v[36:39], a[44:47], v[236:239]
    ds_read_b128 v[24:27], v20 offset:512
    ds_read_b128 v[28:31], v22 offset:512
    s_waitcnt lgkmcnt(4)
    v_mfma_f32_16x16x32_bf16 v[40:43], v[112:115], v[240:243], v[40:43]
    s_add_u32 m0, s58, 12288
    s_nop 0
    buffer_load_dwordx4 v9, s[12:15], s49 offen lds
    v_mfma_f32_16x16x32_bf16 v[44:47], v[116:119], v[240:243], v[44:47]
    v_mfma_f32_16x16x32_bf16 v[224:227], v[240:243], a[48:51], v[224:227]
    v_mfma_f32_16x16x32_bf16 v[228:231], v[240:243], a[52:55], v[228:231]
    v_mfma_f32_16x16x32_bf16 v[48:51], v[112:115], v[244:247], v[48:51]
    v_mfma_f32_16x16x32_bf16 v[52:55], v[116:119], v[244:247], v[52:55]
    v_mfma_f32_16x16x32_bf16 v[232:235], v[244:247], a[48:51], v[232:235]
    v_mfma_f32_16x16x32_bf16 v[236:239], v[244:247], a[52:55], v[236:239]
    ds_read_b128 v[32:35], v21 offset:512
    ds_read_b128 v[36:39], v23 offset:512
    s_waitcnt lgkmcnt(4)
    v_mfma_f32_16x16x32_bf16 v[40:43], v[120:123], v[248:251], v[40:43]
    v_mfma_f32_16x16x32_bf16 v[44:47], v[124:127], v[248:251], v[44:47]
    v_mfma_f32_16x16x32_bf16 v[224:227], v[248:251], a[56:59], v[224:227]
    v_mfma_f32_16x16x32_bf16 v[228:231], v[248:251], a[60:63], v[228:231]
    v_mfma_f32_16x16x32_bf16 v[48:51], v[120:123], v[252:255], v[48:51]
    v_mfma_f32_16x16x32_bf16 v[52:55], v[124:127], v[252:255], v[52:55]
    v_mfma_f32_16x16x32_bf16 v[232:235], v[252:255], a[56:59], v[232:235]
    v_mfma_f32_16x16x32_bf16 v[236:239], v[252:255], a[60:63], v[236:239]
    ds_read_b128 v[240:243], v20 offset:640
    ds_read_b128 v[244:247], v22 offset:640
    s_waitcnt lgkmcnt(4)
    v_mfma_f32_16x16x32_bf16 v[40:43], v[128:131], v[24:27], v[40:43]
    s_add_u32 m0, s58, 16384
    s_nop 0
    buffer_load_dwordx4 v10, s[12:15], s49 offen lds
    v_mfma_f32_16x16x32_bf16 v[44:47], v[132:135], v[24:27], v[44:47]
    v_mfma_f32_16x16x32_bf16 v[224:227], v[24:27], a[64:67], v[224:227]
    v_mfma_f32_16x16x32_bf16 v[228:231], v[24:27], a[68:71], v[228:231]
    v_mfma_f32_16x16x32_bf16 v[48:51], v[128:131], v[28:31], v[48:51]
    v_mfma_f32_16x16x32_bf16 v[52:55], v[132:135], v[28:31], v[52:55]
    v_mfma_f32_16x16x32_bf16 v[232:235], v[28:31], a[64:67], v[232:235]
    v_mfma_f32_16x16x32_bf16 v[236:239], v[28:31], a[68:71], v[236:239]
    ds_read_b128 v[248:251], v21 offset:640
    ds_read_b128 v[252:255], v23 offset:640
    s_waitcnt lgkmcnt(4)
    v_mfma_f32_16x16x32_bf16 v[40:43], v[136:139], v[32:35], v[40:43]
    v_mfma_f32_16x16x32_bf16 v[44:47], v[140:143], v[32:35], v[44:47]
    v_mfma_f32_16x16x32_bf16 v[224:227], v[32:35], a[72:75], v[224:227]
    v_mfma_f32_16x16x32_bf16 v[228:231], v[32:35], a[76:79], v[228:231]
    v_mfma_f32_16x16x32_bf16 v[48:51], v[136:139], v[36:39], v[48:51]
    v_mfma_f32_16x16x32_bf16 v[52:55], v[140:143], v[36:39], v[52:55]
    v_mfma_f32_16x16x32_bf16 v[232:235], v[36:39], a[72:75], v[232:235]
    v_mfma_f32_16x16x32_bf16 v[236:239], v[36:39], a[76:79], v[236:239]
    ds_read_b128 v[24:27], v20 offset:768
    ds_read_b128 v[28:31], v22 offset:768
    s_waitcnt lgkmcnt(4)
    v_mfma_f32_16x16x32_bf16 v[40:43], v[144:147], v[240:243], v[40:43]
    s_add_u32 m0, s58, 20480
    s_nop 0
    buffer_load_dwordx4 v11, s[12:15], s49 offen lds
    v_mfma_f32_16x16x32_bf16 v[44:47], v[148:151], v[240:243], v[44:47]
    v_mfma_f32_16x16x32_bf16 v[224:227], v[240:243], a[80:83], v[224:227]
    v_mfma_f32_16x16x32_bf16 v[228:231], v[240:243], a[84:87], v[228:231]
    v_mfma_f32_16x16x32_bf16 v[48:51], v[144:147], v[244:247], v[48:51]
    v_mfma_f32_16x16x32_bf16 v[52:55], v[148:151], v[244:247], v[52:55]
    v_mfma_f32_16x16x32_bf16 v[232:235], v[244:247], a[80:83], v[232:235]
    v_mfma_f32_16x16x32_bf16 v[236:239], v[244:247], a[84:87], v[236:239]
    ds_read_b128 v[32:35], v21 offset:768
    ds_read_b128 v[36:39], v23 offset:768
    s_waitcnt lgkmcnt(4)
    v_mfma_f32_16x16x32_bf16 v[40:43], v[152:155], v[248:251], v[40:43]
    v_mfma_f32_16x16x32_bf16 v[44:47], v[156:159], v[248:251], v[44:47]
    v_mfma_f32_16x16x32_bf16 v[224:227], v[248:251], a[88:91], v[224:227]
    v_mfma_f32_16x16x32_bf16 v[228:231], v[248:251], a[92:95], v[228:231]
    v_mfma_f32_16x16x32_bf16 v[48:51], v[152:155], v[252:255], v[48:51]
    v_mfma_f32_16x16x32_bf16 v[52:55], v[156:159], v[252:255], v[52:55]
    v_mfma_f32_16x16x32_bf16 v[232:235], v[252:255], a[88:91], v[232:235]
    v_mfma_f32_16x16x32_bf16 v[236:239], v[252:255], a[92:95], v[236:239]
    ds_read_b128 v[240:243], v20 offset:896
    ds_read_b128 v[244:247], v22 offset:896
    s_waitcnt lgkmcnt(4)
    v_mfma_f32_16x16x32_bf16 v[40:43], v[160:163], v[24:27], v[40:43]
    s_add_u32 m0, s58, 24576
    s_nop 0
    buffer_load_dwordx4 v12, s[12:15], s49 offen lds
    v_mfma_f32_16x16x32_bf16 v[44:47], v[164:167], v[24:27], v[44:47]
    v_mfma_f32_16x16x32_bf16 v[224:227], v[24:27], a[96:99], v[224:227]
    v_mfma_f32_16x16x32_bf16 v[228:231], v[24:27], a[100:103], v[228:231]
    v_mfma_f32_16x16x32_bf16 v[48:51], v[160:163], v[28:31], v[48:51]
    v_mfma_f32_16x16x32_bf16 v[52:55], v[164:167], v[28:31], v[52:55]
    v_mfma_f32_16x16x32_bf16 v[232:235], v[28:31], a[96:99], v[232:235]
    v_mfma_f32_16x16x32_bf16 v[236:239], v[28:31], a[100:103], v[236:239]
    ds_read_b128 v[248:251], v21 offset:896
    ds_read_b128 v[252:255], v23 offset:896
    s_waitcnt lgkmcnt(4)
    v_mfma_f32_16x16x32_bf16 v[40:43], v[168:171], v[32:35], v[40:43]
    v_mfma_f32_16x16x32_bf16 v[44:47], v[172:175], v[32:35], v[44:47]
    v_mfma_f32_16x16x32_bf16 v[224:227], v[32:35], a[104:107], v[224:227]
    v_mfma_f32_16x16x32_bf16 v[228:231], v[32:35], a[108:111], v[228:231]
    v_mfma_f32_16x16x32_bf16 v[48:51], v[168:171], v[36:39], v[48:51]
    v_mfma_f32_16x16x32_bf16 v[52:55], v[172:175], v[36:39], v[52:55]
    v_mfma_f32_16x16x32_bf16 v[232:235], v[36:39], a[104:107], v[232:235]
    v_mfma_f32_16x16x32_bf16 v[236:239], v[36:39], a[108:111], v[236:239]
    ds_read_b128 v[24:27], v20 offset:1024
    ds_read_b128 v[28:31], v22 offset:1024
    s_waitcnt lgkmcnt(4)
    v_mfma_f32_16x16x32_bf16 v[40:43], v[176:179], v[240:243], v[40:43]
    s_add_u32 m0, s58, 28672
    s_nop 0
    buffer_load_dwordx4 v13, s[12:15], s49 offen lds
    v_mfma_f32_16x16x32_bf16 v[44:47], v[180:183], v[240:243], v[44:47]
    v_mfma_f32_16x16x32_bf16 v[224:227], v[240:243], a[112:115], v[224:227]
    v_mfma_f32_16x16x32_bf16 v[228:231], v[240:243], a[116:119], v[228:231]
    v_mfma_f32_16x16x32_bf16 v[48:51], v[176:179], v[244:247], v[48:51]
    v_mfma_f32_16x16x32_bf16 v[52:55], v[180:183], v[244:247], v[52:55]
    v_mfma_f32_16x16x32_bf16 v[232:235], v[244:247], a[112:115], v[232:235]
    v_mfma_f32_16x16x32_bf16 v[236:239], v[244:247], a[116:119], v[236:239]
    ds_read_b128 v[32:35], v21 offset:1024
    ds_read_b128 v[36:39], v23 offset:1024
    s_waitcnt lgkmcnt(4)
    v_mfma_f32_16x16x32_bf16 v[40:43], v[184:187], v[248:251], v[40:43]
    v_mfma_f32_16x16x32_bf16 v[44:47], v[188:191], v[248:251], v[44:47]
    v_mfma_f32_16x16x32_bf16 v[224:227], v[248:251], a[120:123], v[224:227]
    v_mfma_f32_16x16x32_bf16 v[228:231], v[248:251], a[124:127], v[228:231]
    v_mfma_f32_16x16x32_bf16 v[48:51], v[184:187], v[252:255], v[48:51]
    v_mfma_f32_16x16x32_bf16 v[52:55], v[188:191], v[252:255], v[52:55]
    v_mfma_f32_16x16x32_bf16 v[232:235], v[252:255], a[120:123], v[232:235]
    v_mfma_f32_16x16x32_bf16 v[236:239], v[252:255], a[124:127], v[236:239]
    s_waitcnt lgkmcnt(2)
    v_mfma_f32_16x16x32_bf16 v[40:43], v[192:195], v[24:27], v[40:43]
    s_add_u32 m0, s58, 32768
    s_nop 0
    buffer_load_dwordx4 v14, s[12:15], s49 offen lds
    v_mfma_f32_16x16x32_bf16 v[44:47], v[196:199], v[24:27], v[44:47]
    v_mfma_f32_16x16x32_bf16 v[224:227], v[24:27], a[128:131], v[224:227]
    v_mfma_f32_16x16x32_bf16 v[228:231], v[24:27], a[132:135], v[228:231]
    v_mfma_f32_16x16x32_bf16 v[48:51], v[192:195], v[28:31], v[48:51]
    v_mfma_f32_16x16x32_bf16 v[52:55], v[196:199], v[28:31], v[52:55]
    v_mfma_f32_16x16x32_bf16 v[232:235], v[28:31], a[128:131], v[232:235]
    v_mfma_f32_16x16x32_bf16 v[236:239], v[28:31], a[132:135], v[236:239]
    s_waitcnt lgkmcnt(0)
    v_mfma_f32_16x16x32_bf16 v[40:43], v[200:203], v[32:35], v[40:43]
    v_mfma_f32_16x16x32_bf16 v[44:47], v[204:207], v[32:35], v[44:47]
    v_mfma_f32_16x16x32_bf16 v[224:227], v[32:35], a[136:139], v[224:227]
    v_mfma_f32_16x16x32_bf16 v[228:231], v[32:35], a[140:143], v[228:231]
    v_mfma_f32_16x16x32_bf16 v[48:51], v[200:203], v[36:39], v[48:51]
    v_mfma_f32_16x16x32_bf16 v[52:55], v[204:207], v[36:39], v[52:55]
    v_mfma_f32_16x16x32_bf16 v[232:235], v[36:39], a[136:139], v[232:235]
    v_mfma_f32_16x16x32_bf16 v[236:239], v[36:39], a[140:143], v[236:239]
    s_add_u32 s49, s49, s43
    s_add_u32 s58, s58, 36864
    s_sub_u32 s35, s58, 110592
    s_cmp_ge_u32 s58, 110592
    s_cselect_b32 s58, s35, s58
    s_add_u32 s59, s59, 36864
    s_cmp_ge_u32 s59, 110592
    s_cselect_b32 s59, 0, s59
    s_lshr_b32 s35, s42, 2
    s_cmp_eq_u32 s35, s52
    s_cbranch_scc1 L_gKV_same
    s_add_u32 s36, s52, s48
    s_lshl_b32 s36, s36, 10
    s_or_b32 s61, s36, s47
    s_cmp_eq_u32 s47, 0
    s_cselect_b32 s61, 0, s61
    s_mov_b32 s47, 0
    s_mov_b32 s52, s35
L_gKV_same:
    s_add_u32 s47, s47, 1
    v_cvt_pk_bf16_f32 v208, v40, v44
    v_cvt_pk_bf16_f32 v209, v41, v45
    v_cvt_pk_bf16_f32 v210, v42, v46
    v_cvt_pk_bf16_f32 v211, v43, v47
    buffer_store_dwordx4 v[208:211], v0, s[8:11], s44 offen offset:0 sc1
    v_cvt_pk_bf16_f32 v212, v48, v52
    v_cvt_pk_bf16_f32 v213, v49, v53
    v_cvt_pk_bf16_f32 v214, v50, v54
    v_cvt_pk_bf16_f32 v215, v51, v55
    buffer_store_dwordx4 v[212:215], v0, s[8:11], s44 offen offset:1024 sc1
    v_cvt_pk_bf16_f32 v216, v224, v225
    v_cvt_pk_bf16_f32 v218, v226, v227
    v_cvt_pk_bf16_f32 v217, v232, v233
    v_cvt_pk_bf16_f32 v219, v234, v235
    buffer_store_dwordx4 v[216:219], v0, s[8:11], s60 offen offset:0 sc1
    v_cvt_pk_bf16_f32 v220, v228, v229
    v_cvt_pk_bf16_f32 v222, v230, v231
    v_cvt_pk_bf16_f32 v221, v236, v237
    v_cvt_pk_bf16_f32 v223, v238, v239
    buffer_store_dwordx4 v[220:223], v0, s[8:11], s60 offen offset:1024 sc1
    s_add_u32 s44, s44, s55
    s_add_u32 s60, s60, s55
    s_cmp_ge_u32 s42, 4
    s_cbranch_scc1 L_gKV_ne
    s_waitcnt vmcnt(0)
    s_barrier
    s_cmp_lg_u32 s33, 0
    s_cbranch_scc1 L_sigeager
    v_mov_b32 v2, 160
    v_mov_b32 v3, 1
    s_mov_b64 exec, 1
    buffer_atomic_add v3, v2, s[20:23], 0 offen
    s_mov_b64 exec, -1
L_sigeager:
    s_mov_b32 s47, 0
L_gKV_ne:
    s_add_u32 s42, s42, s62
    s_waitcnt vmcnt(13)
    s_cmp_lt_u32 s42, 64
    s_cbranch_scc1 L_gKV_top
    s_lshr_b32 s35, s61, 8
    s_and_b32 s36, s61, 0xff
    s_waitcnt vmcnt(0)
    s_barrier
    s_cmp_lg_u32 s33, 0
    s_cbranch_scc1 L_sigKVa
    v_mov_b32 v2, s35
    v_mov_b32 v3, s36
    s_mov_b64 exec, 1
    buffer_atomic_add v3, v2, s[20:23], 0 offen
    s_mov_b64 exec, -1
L_sigKVa:
    s_add_u32 s35, s52, s48
    s_lshl_b32 s35, s35, 2
    s_waitcnt vmcnt(0)
    s_barrier
    s_cmp_lg_u32 s33, 0
    s_cbranch_scc1 L_sigKVb
    v_mov_b32 v2, s35
    v_mov_b32 v3, s47
    s_mov_b64 exec, 1
    buffer_atomic_add v3, v2, s[20:23], 0 offen
    s_mov_b64 exec, -1
L_sigKVb:
    s_branch L_gemm_done
L_job_q:
    s_sub_u32 s36, s34, 128
    s_mul_i32 s32, s36, 43691
    s_lshr_b32 s32, s32, 17
    s_mul_i32 s42, s32, 3
    s_sub_u32 s42, s36, s42
    s_lshl_b32 s32, s32, 1
    s_mov_b32 s62, 3
    s_lshl_b32 s46, s32, 8
    s_add_u32 s46, s46, s50
    s_add_u32 s46, s46, 256
    s_lshl_b32 s44, s42, 18
    s_lshl_b32 s35, s32, 13
    s_add_u32 s44, s44, s35
    s_lshl_b32 s35, s33, 11
    s_add_u32 s44, s44, s35
    s_add_u32 s44, s44, 33554432
    s_add_u32 s60, s44, 8192
    s_mov_b32 s55, 786432
    s_mov_b32 s48, 25
    s_mov_b32 s16, s68
    s_mov_b32 s17, s69
    s_sub_u32 s63, s46, 256
    s_mov_b32 s28, s68
    s_mov_b32 s29, s69
    s_mov_b32 s30, 4718592
    s_mov_b32 s31, 0x00020000
    s_mov_b32 s53, 1
L_lwf2:
    buffer_load_dwordx4 a[0:3], v56, s[16:19], s46 offen
    s_add_u32 s46, s46, 65536
    buffer_load_dwordx4 a[4:7], v56, s[16:19], s46 offen
    s_add_u32 s46, s46, 65536
    buffer_load_dwordx4 a[8:11], v56, s[16:19], s46 offen
    s_add_u32 s46, s46, 65536
    buffer_load_dwordx4 a[12:15], v56, s[16:19], s46 offen
    s_add_u32 s46, s46, 327680
    buffer_load_dwordx4 a[16:19], v56, s[16:19], s46 offen
    s_add_u32 s46, s46, 65536
    buffer_load_dwordx4 a[20:23], v56, s[16:19], s46 offen
    s_add_u32 s46, s46, 65536
    buffer_load_dwordx4 a[24:27], v56, s[16:19], s46 offen
    s_add_u32 s46, s46, 65536
    buffer_load_dwordx4 a[28:31], v56, s[16:19], s46 offen
    s_add_u32 s46, s46, 327680
    buffer_load_dwordx4 a[32:35], v56, s[16:19], s46 offen
    s_add_u32 s46, s46, 65536
    buffer_load_dwordx4 a[36:39], v56, s[16:19], s46 offen
    s_add_u32 s46, s46, 65536
    buffer_load_dwordx4 a[40:43], v56, s[16:19], s46 offen
    s_add_u32 s46, s46, 65536
    buffer_load_dwordx4 a[44:47], v56, s[16:19], s46 offen
    s_add_u32 s46, s46, 327680
    buffer_load_dwordx4 a[48:51], v56, s[16:19], s46 offen
    s_add_u32 s46, s46, 65536
    buffer_load_dwordx4 a[52:55], v56, s[16:19], s46 offen
    s_add_u32 s46, s46, 65536
    buffer_load_dwordx4 a[56:59], v56, s[16:19], s46 offen
    s_add_u32 s46, s46, 65536
    buffer_load_dwordx4 a[60:63], v56, s[16:19], s46 offen
    s_add_u32 s46, s46, 327680
    buffer_load_dwordx4 a[64:67], v56, s[16:19], s46 offen
    s_add_u32 s46, s46, 65536
    buffer_load_dwordx4 a[68:71], v56, s[16:19], s46 offen
    s_add_u32 s46, s46, 65536
    buffer_load_dwordx4 a[72:75], v56, s[16:19], s46 offen
    s_add_u32 s46, s46, 65536
    buffer_load_dwordx4 a[76:79], v56, s[16:19], s46 offen
    s_add_u32 s46, s46, 327680
    buffer_load_dwordx4 a[80:83], v56, s[16:19], s46 offen
    s_add_u32 s46, s46, 65536
    buffer_load_dwordx4 a[84:87], v56, s[16:19], s46 offen
    s_add_u32 s46, s46, 65536
    buffer_load_dwordx4 a[88:91], v56, s[16:19], s46 offen
    s_add_u32 s46, s46, 65536
    buffer_load_dwordx4 a[92:95], v56, s[16:19], s46 offen
    s_add_u32 s46, s46, 327680
    buffer_load_dwordx4 a[96:99], v56, s[16:19], s46 offen
    s_add_u32 s46, s46, 65536
    buffer_load_dwordx4 a[100:103], v56, s[16:19], s46 offen
    s_add_u32 s46, s46, 65536
    buffer_load_dwordx4 a[104:107], v56, s[16:19], s46 offen
    s_add_u32 s46, s46, 65536
    buffer_load_dwordx4 a[108:111], v56, s[16:19], s46 offen
    s_add_u32 s46, s46, 327680
    buffer_load_dwordx4 a[112:115], v56, s[16:19], s46 offen
    s_add_u32 s46, s46, 65536
    buffer_load_dwordx4 a[116:119], v56, s[16:19], s46 offen
    s_add_u32 s46, s46, 65536
    buffer_load_dwordx4 a[120:123], v56, s[16:19], s46 offen
    s_add_u32 s46, s46, 65536
    buffer_load_dwordx4 a[124:127], v56, s[16:19], s46 offen
    s_add_u32 s46, s46, 327680
    buffer_load_dwordx4 a[128:131], v56, s[16:19], s46 offen
    s_add_u32 s46, s46, 65536
    buffer_load_dwordx4 a[132:135], v56, s[16:19], s46 offen
    s_add_u32 s46, s46, 65536
    buffer_load_dwordx4 a[136:139], v56, s[16:19], s46 offen
    s_add_u32 s46, s46, 65536
    buffer_load_dwordx4 a[140:143], v56, s[16:19], s46 offen
    s_add_u32 s46, s46, 327680
    buffer_load_dwordx4 v[64:67], v56, s[28:31], s63 offen
    s_add_u32 s63, s63, 65536
    buffer_load_dwordx4 v[68:71], v56, s[28:31], s63 offen
    s_add_u32 s63, s63, 65536
    buffer_load_dwordx4 v[72:75], v56, s[28:31], s63 offen
    s_add_u32 s63, s63, 65536
    buffer_load_dwordx4 v[76:79], v56, s[28:31], s63 offen
    s_add_u32 s63, s63, 327680
    v_add_u32 v32, 0, v59
    v_add_u32 v33, 4096, v59
    v_add_u32 v34, 16384, v59
    v_add_u32 v35, 20480, v59
    s_waitcnt vmcnt(36)
    ds_write_b128 v57, a[0:3] offset:0
    ds_write_b128 v57, a[4:7] offset:1024
    ds_write_b128 v57, a[8:11] offset:2048
    ds_write_b128 v57, a[12:15] offset:3072
    s_waitcnt lgkmcnt(0)
    s_barrier
    ds_read2_b32 v[208:209], v32 offset0:0 offset1:32
    ds_read2_b32 v[210:211], v32 offset0:64 offset1:96
    ds_read2_b32 v[212:213], v32 offset0:128 offset1:160
    ds_read2_b32 v[214:215], v32 offset0:192 offset1:224
    ds_read2_b32 v[216:217], v33 offset0:0 offset1:32
    ds_read2_b32 v[218:219], v33 offset0:64 offset1:96
    ds_read2_b32 v[220:221], v33 offset0:128 offset1:160
    ds_read2_b32 v[222:223], v33 offset0:192 offset1:224
    s_waitcnt vmcnt(32)
    ds_write_b128 v57, a[16:19] offset:16384
    ds_write_b128 v57, a[20:23] offset:17408
    ds_write_b128 v57, a[24:27] offset:18432
    ds_write_b128 v57, a[28:31] offset:19456
    buffer_load_dwordx4 v[80:83], v56, s[28:31], s63 offen
    s_add_u32 s63, s63, 65536
    buffer_load_dwordx4 v[84:87], v56, s[28:31], s63 offen
    s_add_u32 s63, s63, 65536
    buffer_load_dwordx4 v[88:91], v56, s[28:31], s63 offen
    s_add_u32 s63, s63, 65536
    buffer_load_dwordx4 v[92:95], v56, s[28:31], s63 offen
    s_add_u32 s63, s63, 327680
    s_waitcnt lgkmcnt(0)
    s_barrier
    ds_read2_b32 v[224:225], v34 offset0:0 offset1:32
    ds_read2_b32 v[226:227], v34 offset0:64 offset1:96
    ds_read2_b32 v[228:229], v34 offset0:128 offset1:160
    ds_read2_b32 v[230:231], v34 offset0:192 offset1:224
    ds_read2_b32 v[232:233], v35 offset0:0 offset1:32
    ds_read2_b32 v[234:235], v35 offset0:64 offset1:96
    ds_read2_b32 v[236:237], v35 offset0:128 offset1:160
    ds_read2_b32 v[238:239], v35 offset0:192 offset1:224
    s_waitcnt vmcnt(32)
    ds_write_b128 v57, a[32:35] offset:0
    ds_write_b128 v57, a[36:39] offset:1024
    ds_write_b128 v57, a[40:43] offset:2048
    ds_write_b128 v57, a[44:47] offset:3072
    buffer_load_dwordx4 v[96:99], v56, s[28:31], s63 offen
    s_add_u32 s63, s63, 65536
    buffer_load_dwordx4 v[100:103], v56, s[28:31], s63 offen
    s_add_u32 s63, s63, 65536
    buffer_load_dwordx4 v[104:107], v56, s[28:31], s63 offen
    s_add_u32 s63, s63, 65536
    buffer_load_dwordx4 v[108:111], v56, s[28:31], s63 offen
    s_add_u32 s63, s63, 327680
    v_perm_b32 v24, v209, v208, s40
    v_accvgpr_write_b32 a0, v24
    v_perm_b32 v25, v211, v210, s40
    v_accvgpr_write_b32 a1, v25
    v_perm_b32 v26, v213, v212, s40
    v_accvgpr_write_b32 a2, v26
    v_perm_b32 v27, v215, v214, s40
    v_accvgpr_write_b32 a3, v27
    v_perm_b32 v28, v209, v208, s41
    v_accvgpr_write_b32 a4, v28
    v_perm_b32 v29, v211, v210, s41
    v_accvgpr_write_b32 a5, v29
    v_perm_b32 v30, v213, v212, s41
    v_accvgpr_write_b32 a6, v30
    v_perm_b32 v31, v215, v214, s41
    v_accvgpr_write_b32 a7, v31
    v_perm_b32 v24, v217, v216, s40
    v_accvgpr_write_b32 a8, v24
    v_perm_b32 v25, v219, v218, s40
    v_accvgpr_write_b32 a9, v25
    v_perm_b32 v26, v221, v220, s40
    v_accvgpr_write_b32 a10, v26
    v_perm_b32 v27, v223, v222, s40
    v_accvgpr_write_b32 a11, v27
    v_perm_b32 v28, v217, v216, s41
    v_accvgpr_write_b32 a12, v28
    v_perm_b32 v29, v219, v218, s41
    v_accvgpr_write_b32 a13, v29
    v_perm_b32 v30, v221, v220, s41
    v_accvgpr_write_b32 a14, v30
    v_perm_b32 v31, v223, v222, s41
    v_accvgpr_write_b32 a15, v31
    s_waitcnt lgkmcnt(0)
    s_barrier
    ds_read2_b32 v[208:209], v32 offset0:0 offset1:32
    ds_read2_b32 v[210:211], v32 offset0:64 offset1:96
    ds_read2_b32 v[212:213], v32 offset0:128 offset1:160
    ds_read2_b32 v[214:215], v32 offset0:192 offset1:224
    ds_read2_b32 v[216:217], v33 offset0:0 offset1:32
    ds_read2_b32 v[218:219], v33 offset0:64 offset1:96
    ds_read2_b32 v[220:221], v33 offset0:128 offset1:160
    ds_read2_b32 v[222:223], v33 offset0:192 offset1:224
    s_waitcnt vmcnt(32)
    ds_write_b128 v57, a[48:51] offset:16384
    ds_write_b128 v57, a[52:55] offset:17408
    ds_write_b128 v57, a[56:59] offset:18432
    ds_write_b128 v57, a[60:63] offset:19456
    buffer_load_dwordx4 v[112:115], v56, s[28:31], s63 offen
    s_add_u32 s63, s63, 65536
    buffer_load_dwordx4 v[116:119], v56, s[28:31], s63 offen
    s_add_u32 s63, s63, 65536
    buffer_load_dwordx4 v[120:123], v56, s[28:31], s63 offen
    s_add_u32 s63, s63, 65536
    buffer_load_dwordx4 v[124:127], v56, s[28:31], s63 offen
    s_add_u32 s63, s63, 327680
    v_perm_b32 v24, v225, v224, s40
    v_accvgpr_write_b32 a16, v24
    v_perm_b32 v25, v227, v226, s40
    v_accvgpr_write_b32 a17, v25
    v_perm_b32 v26, v229, v228, s40
    v_accvgpr_write_b32 a18, v26
    v_perm_b32 v27, v231, v230, s40
    v_accvgpr_write_b32 a19, v27
    v_perm_b32 v28, v225, v224, s41
    v_accvgpr_write_b32 a20, v28
    v_perm_b32 v29, v227, v226, s41
    v_accvgpr_write_b32 a21, v29
    v_perm_b32 v30, v229, v228, s41
    v_accvgpr_write_b32 a22, v30
    v_perm_b32 v31, v231, v230, s41
    v_accvgpr_write_b32 a23, v31
    v_perm_b32 v24, v233, v232, s40
    v_accvgpr_write_b32 a24, v24
    v_perm_b32 v25, v235, v234, s40
    v_accvgpr_write_b32 a25, v25
    v_perm_b32 v26, v237, v236, s40
    v_accvgpr_write_b32 a26, v26
    v_perm_b32 v27, v239, v238, s40
    v_accvgpr_write_b32 a27, v27
    v_perm_b32 v28, v233, v232, s41
    v_accvgpr_write_b32 a28, v28
    v_perm_b32 v29, v235, v234, s41
    v_accvgpr_write_b32 a29, v29
    v_perm_b32 v30, v237, v236, s41
    v_accvgpr_write_b32 a30, v30
    v_perm_b32 v31, v239, v238, s41
    v_accvgpr_write_b32 a31, v31
    s_waitcnt lgkmcnt(0)
    s_barrier
    ds_read2_b32 v[224:225], v34 offset0:0 offset1:32
    ds_read2_b32 v[226:227], v34 offset0:64 offset1:96
    ds_read2_b32 v[228:229], v34 offset0:128 offset1:160
    ds_read2_b32 v[230:231], v34 offset0:192 offset1:224
    ds_read2_b32 v[232:233], v35 offset0:0 offset1:32
    ds_read2_b32 v[234:235], v35 offset0:64 offset1:96
    ds_read2_b32 v[236:237], v35 offset0:128 offset1:160
    ds_read2_b32 v[238:239], v35 offset0:192 offset1:224
    s_waitcnt vmcnt(32)
    ds_write_b128 v57, a[64:67] offset:0
    ds_write_b128 v57, a[68:71] offset:1024
    ds_write_b128 v57, a[72:75] offset:2048
    ds_write_b128 v57, a[76:79] offset:3072
    buffer_load_dwordx4 v[128:131], v56, s[28:31], s63 offen
    s_add_u32 s63, s63, 65536
    buffer_load_dwordx4 v[132:135], v56, s[28:31], s63 offen
    s_add_u32 s63, s63, 65536
    buffer_load_dwordx4 v[136:139], v56, s[28:31], s63 offen
    s_add_u32 s63, s63, 65536
    buffer_load_dwordx4 v[140:143], v56, s[28:31], s63 offen
    s_add_u32 s63, s63, 327680
    v_perm_b32 v24, v209, v208, s40
    v_accvgpr_write_b32 a32, v24
    v_perm_b32 v25, v211, v210, s40
    v_accvgpr_write_b32 a33, v25
    v_perm_b32 v26, v213, v212, s40
    v_accvgpr_write_b32 a34, v26
    v_perm_b32 v27, v215, v214, s40
    v_accvgpr_write_b32 a35, v27
    v_perm_b32 v28, v209, v208, s41
    v_accvgpr_write_b32 a36, v28
    v_perm_b32 v29, v211, v210, s41
    v_accvgpr_write_b32 a37, v29
    v_perm_b32 v30, v213, v212, s41
    v_accvgpr_write_b32 a38, v30
    v_perm_b32 v31, v215, v214, s41
    v_accvgpr_write_b32 a39, v31
    v_perm_b32 v24, v217, v216, s40
    v_accvgpr_write_b32 a40, v24
    v_perm_b32 v25, v219, v218, s40
    v_accvgpr_write_b32 a41, v25
    v_perm_b32 v26, v221, v220, s40
    v_accvgpr_write_b32 a42, v26
    v_perm_b32 v27, v223, v222, s40
    v_accvgpr_write_b32 a43, v27
    v_perm_b32 v28, v217, v216, s41
    v_accvgpr_write_b32 a44, v28
    v_perm_b32 v29, v219, v218, s41
    v_accvgpr_write_b32 a45, v29
    v_perm_b32 v30, v221, v220, s41
    v_accvgpr_write_b32 a46, v30
    v_perm_b32 v31, v223, v222, s41
    v_accvgpr_write_b32 a47, v31
    s_waitcnt lgkmcnt(0)
    s_barrier
    ds_read2_b32 v[208:209], v32 offset0:0 offset1:32
    ds_read2_b32 v[210:211], v32 offset0:64 offset1:96
    ds_read2_b32 v[212:213], v32 offset0:128 offset1:160
    ds_read2_b32 v[214:215], v32 offset0:192 offset1:224
    ds_read2_b32 v[216:217], v33 offset0:0 offset1:32
    ds_read2_b32 v[218:219], v33 offset0:64 offset1:96
    ds_read2_b32 v[220:221], v33 offset0:128 offset1:160
    ds_read2_b32 v[222:223], v33 offset0:192 offset1:224
    s_waitcnt vmcnt(32)
    ds_write_b128 v57, a[80:83] offset:16384
    ds_write_b128 v57, a[84:87] offset:17408
    ds_write_b128 v57, a[88:91] offset:18432
    ds_write_b128 v57, a[92:95] offset:19456
    buffer_load_dwordx4 v[144:147], v56, s[28:31], s63 offen
    s_add_u32 s63, s63, 65536
    buffer_load_dwordx4 v[148:151], v56, s[28:31], s63 offen
    s_add_u32 s63, s63, 65536
    buffer_load_dwordx4 v[152:155], v56, s[28:31], s63 offen
    s_add_u32 s63, s63, 65536
    buffer_load_dwordx4 v[156:159], v56, s[28:31], s63 offen
    s_add_u32 s63, s63, 327680
    v_perm_b32 v24, v225, v224, s40
    v_accvgpr_write_b32 a48, v24
    v_perm_b32 v25, v227, v226, s40
    v_accvgpr_write_b32 a49, v25
    v_perm_b32 v26, v229, v228, s40
    v_accvgpr_write_b32 a50, v26
    v_perm_b32 v27, v231, v230, s40
    v_accvgpr_write_b32 a51, v27
    v_perm_b32 v28, v225, v224, s41
    v_accvgpr_write_b32 a52, v28
    v_perm_b32 v29, v227, v226, s41
    v_accvgpr_write_b32 a53, v29
    v_perm_b32 v30, v229, v228, s41
    v_accvgpr_write_b32 a54, v30
    v_perm_b32 v31, v231, v230, s41
    v_accvgpr_write_b32 a55, v31
    v_perm_b32 v24, v233, v232, s40
    v_accvgpr_write_b32 a56, v24
    v_perm_b32 v25, v235, v234, s40
    v_accvgpr_write_b32 a57, v25
    v_perm_b32 v26, v237, v236, s40
    v_accvgpr_write_b32 a58, v26
    v_perm_b32 v27, v239, v238, s40
    v_accvgpr_write_b32 a59, v27
    v_perm_b32 v28, v233, v232, s41
    v_accvgpr_write_b32 a60, v28
    v_perm_b32 v29, v235, v234, s41
    v_accvgpr_write_b32 a61, v29
    v_perm_b32 v30, v237, v236, s41
    v_accvgpr_write_b32 a62, v30
    v_perm_b32 v31, v239, v238, s41
    v_accvgpr_write_b32 a63, v31
    s_waitcnt lgkmcnt(0)
    s_barrier
    ds_read2_b32 v[224:225], v34 offset0:0 offset1:32
    ds_read2_b32 v[226:227], v34 offset0:64 offset1:96
    ds_read2_b32 v[228:229], v34 offset0:128 offset1:160
    ds_read2_b32 v[230:231], v34 offset0:192 offset1:224
    ds_read2_b32 v[232:233], v35 offset0:0 offset1:32
    ds_read2_b32 v[234:235], v35 offset0:64 offset1:96
    ds_read2_b32 v[236:237], v35 offset0:128 offset1:160
    ds_read2_b32 v[238:239], v35 offset0:192 offset1:224
    s_waitcnt vmcnt(32)
    ds_write_b128 v57, a[96:99] offset:0
    ds_write_b128 v57, a[100:103] offset:1024
    ds_write_b128 v57, a[104:107] offset:2048
    ds_write_b128 v57, a[108:111] offset:3072
    buffer_load_dwordx4 v[160:163], v56, s[28:31], s63 offen
    s_add_u32 s63, s63, 65536
    buffer_load_dwordx4 v[164:167], v56, s[28:31], s63 offen
    s_add_u32 s63, s63, 65536
    buffer_load_dwordx4 v[168:171], v56, s[28:31], s63 offen
    s_add_u32 s63, s63, 65536
    buffer_load_dwordx4 v[172:175], v56, s[28:31], s63 offen
    s_add_u32 s63, s63, 327680
    v_perm_b32 v24, v209, v208, s40
    v_accvgpr_write_b32 a64, v24
    v_perm_b32 v25, v211, v210, s40
    v_accvgpr_write_b32 a65, v25
    v_perm_b32 v26, v213, v212, s40
    v_accvgpr_write_b32 a66, v26
    v_perm_b32 v27, v215, v214, s40
    v_accvgpr_write_b32 a67, v27
    v_perm_b32 v28, v209, v208, s41
    v_accvgpr_write_b32 a68, v28
    v_perm_b32 v29, v211, v210, s41
    v_accvgpr_write_b32 a69, v29
    v_perm_b32 v30, v213, v212, s41
    v_accvgpr_write_b32 a70, v30
    v_perm_b32 v31, v215, v214, s41
    v_accvgpr_write_b32 a71, v31
    v_perm_b32 v24, v217, v216, s40
    v_accvgpr_write_b32 a72, v24
    v_perm_b32 v25, v219, v218, s40
    v_accvgpr_write_b32 a73, v25
    v_perm_b32 v26, v221, v220, s40
    v_accvgpr_write_b32 a74, v26
    v_perm_b32 v27, v223, v222, s40
    v_accvgpr_write_b32 a75, v27
    v_perm_b32 v28, v217, v216, s41
    v_accvgpr_write_b32 a76, v28
    v_perm_b32 v29, v219, v218, s41
    v_accvgpr_write_b32 a77, v29
    v_perm_b32 v30, v221, v220, s41
    v_accvgpr_write_b32 a78, v30
    v_perm_b32 v31, v223, v222, s41
    v_accvgpr_write_b32 a79, v31
    s_waitcnt lgkmcnt(0)
    s_barrier
    ds_read2_b32 v[208:209], v32 offset0:0 offset1:32
    ds_read2_b32 v[210:211], v32 offset0:64 offset1:96
    ds_read2_b32 v[212:213], v32 offset0:128 offset1:160
    ds_read2_b32 v[214:215], v32 offset0:192 offset1:224
    ds_read2_b32 v[216:217], v33 offset0:0 offset1:32
    ds_read2_b32 v[218:219], v33 offset0:64 offset1:96
    ds_read2_b32 v[220:221], v33 offset0:128 offset1:160
    ds_read2_b32 v[222:223], v33 offset0:192 offset1:224
    s_waitcnt vmcnt(32)
    ds_write_b128 v57, a[112:115] offset:16384
    ds_write_b128 v57, a[116:119] offset:17408
    ds_write_b128 v57, a[120:123] offset:18432
    ds_write_b128 v57, a[124:127] offset:19456
    buffer_load_dwordx4 v[176:179], v56, s[28:31], s63 offen
    s_add_u32 s63, s63, 65536
    buffer_load_dwordx4 v[180:183], v56, s[28:31], s63 offen
    s_add_u32 s63, s63, 65536
    buffer_load_dwordx4 v[184:187], v56, s[28:31], s63 offen
    s_add_u32 s63, s63, 65536
    buffer_load_dwordx4 v[188:191], v56, s[28:31], s63 offen
    s_add_u32 s63, s63, 327680
    v_perm_b32 v24, v225, v224, s40
    v_accvgpr_write_b32 a80, v24
    v_perm_b32 v25, v227, v226, s40
    v_accvgpr_write_b32 a81, v25
    v_perm_b32 v26, v229, v228, s40
    v_accvgpr_write_b32 a82, v26
    v_perm_b32 v27, v231, v230, s40
    v_accvgpr_write_b32 a83, v27
    v_perm_b32 v28, v225, v224, s41
    v_accvgpr_write_b32 a84, v28
    v_perm_b32 v29, v227, v226, s41
    v_accvgpr_write_b32 a85, v29
    v_perm_b32 v30, v229, v228, s41
    v_accvgpr_write_b32 a86, v30
    v_perm_b32 v31, v231, v230, s41
    v_accvgpr_write_b32 a87, v31
    v_perm_b32 v24, v233, v232, s40
    v_accvgpr_write_b32 a88, v24
    v_perm_b32 v25, v235, v234, s40
    v_accvgpr_write_b32 a89, v25
    v_perm_b32 v26, v237, v236, s40
    v_accvgpr_write_b32 a90, v26
    v_perm_b32 v27, v239, v238, s40
    v_accvgpr_write_b32 a91, v27
    v_perm_b32 v28, v233, v232, s41
    v_accvgpr_write_b32 a92, v28
    v_perm_b32 v29, v235, v234, s41
    v_accvgpr_write_b32 a93, v29
    v_perm_b32 v30, v237, v236, s41
    v_accvgpr_write_b32 a94, v30
    v_perm_b32 v31, v239, v238, s41
    v_accvgpr_write_b32 a95, v31
    s_waitcnt lgkmcnt(0)
    s_barrier
    ds_read2_b32 v[224:225], v34 offset0:0 offset1:32
    ds_read2_b32 v[226:227], v34 offset0:64 offset1:96
    ds_read2_b32 v[228:229], v34 offset0:128 offset1:160
    ds_read2_b32 v[230:231], v34 offset0:192 offset1:224
    ds_read2_b32 v[232:233], v35 offset0:0 offset1:32
    ds_read2_b32 v[234:235], v35 offset0:64 offset1:96
    ds_read2_b32 v[236:237], v35 offset0:128 offset1:160
    ds_read2_b32 v[238:239], v35 offset0:192 offset1:224
    s_waitcnt vmcnt(32)
    ds_write_b128 v57, a[128:131] offset:0
    ds_write_b128 v57, a[132:135] offset:1024
    ds_write_b128 v57, a[136:139] offset:2048
    ds_write_b128 v57, a[140:143] offset:3072
    buffer_load_dwordx4 v[192:195], v56, s[28:31], s63 offen
    s_add_u32 s63, s63, 65536
    buffer_load_dwordx4 v[196:199], v56, s[28:31], s63 offen
    s_add_u32 s63, s63, 65536
    buffer_load_dwordx4 v[200:203], v56, s[28:31], s63 offen
    s_add_u32 s63, s63, 65536
    buffer_load_dwordx4 v[204:207], v56, s[28:31], s63 offen
    s_add_u32 s63, s63, 327680
    v_perm_b32 v24, v209, v208, s40
    v_accvgpr_write_b32 a96, v24
    v_perm_b32 v25, v211, v210, s40
    v_accvgpr_write_b32 a97, v25
    v_perm_b32 v26, v213, v212, s40
    v_accvgpr_write_b32 a98, v26
    v_perm_b32 v27, v215, v214, s40
    v_accvgpr_write_b32 a99, v27
    v_perm_b32 v28, v209, v208, s41
    v_accvgpr_write_b32 a100, v28
    v_perm_b32 v29, v211, v210, s41
    v_accvgpr_write_b32 a101, v29
    v_perm_b32 v30, v213, v212, s41
    v_accvgpr_write_b32 a102, v30
    v_perm_b32 v31, v215, v214, s41
    v_accvgpr_write_b32 a103, v31
    v_perm_b32 v24, v217, v216, s40
    v_accvgpr_write_b32 a104, v24
    v_perm_b32 v25, v219, v218, s40
    v_accvgpr_write_b32 a105, v25
    v_perm_b32 v26, v221, v220, s40
    v_accvgpr_write_b32 a106, v26
    v_perm_b32 v27, v223, v222, s40
    v_accvgpr_write_b32 a107, v27
    v_perm_b32 v28, v217, v216, s41
    v_accvgpr_write_b32 a108, v28
    v_perm_b32 v29, v219, v218, s41
    v_accvgpr_write_b32 a109, v29
    v_perm_b32 v30, v221, v220, s41
    v_accvgpr_write_b32 a110, v30
    v_perm_b32 v31, v223, v222, s41
    v_accvgpr_write_b32 a111, v31
    s_waitcnt lgkmcnt(0)
    s_barrier
    ds_read2_b32 v[208:209], v32 offset0:0 offset1:32
    ds_read2_b32 v[210:211], v32 offset0:64 offset1:96
    ds_read2_b32 v[212:213], v32 offset0:128 offset1:160
    ds_read2_b32 v[214:215], v32 offset0:192 offset1:224
    ds_read2_b32 v[216:217], v33 offset0:0 offset1:32
    ds_read2_b32 v[218:219], v33 offset0:64 offset1:96
    ds_read2_b32 v[220:221], v33 offset0:128 offset1:160
    ds_read2_b32 v[222:223], v33 offset0:192 offset1:224
    s_waitcnt vmcnt(32)
    ds_write_b128 v57, v[64:67] offset:16384
    ds_write_b128 v57, v[68:71] offset:17408
    ds_write_b128 v57, v[72:75] offset:18432
    ds_write_b128 v57, v[76:79] offset:19456
    v_perm_b32 v24, v225, v224, s40
    v_accvgpr_write_b32 a112, v24
    v_perm_b32 v25, v227, v226, s40
    v_accvgpr_write_b32 a113, v25
    v_perm_b32 v26, v229, v228, s40
    v_accvgpr_write_b32 a114, v26
    v_perm_b32 v27, v231, v230, s40
    v_accvgpr_write_b32 a115, v27
    v_perm_b32 v28, v225, v224, s41
    v_accvgpr_write_b32 a116, v28
    v_perm_b32 v29, v227, v226, s41
    v_accvgpr_write_b32 a117, v29
    v_perm_b32 v30, v229, v228, s41
    v_accvgpr_write_b32 a118, v30
    v_perm_b32 v31, v231, v230, s41
    v_accvgpr_write_b32 a119, v31
    v_perm_b32 v24, v233, v232, s40
    v_accvgpr_write_b32 a120, v24
    v_perm_b32 v25, v235, v234, s40
    v_accvgpr_write_b32 a121, v25
    v_perm_b32 v26, v237, v236, s40
    v_accvgpr_write_b32 a122, v26
    v_perm_b32 v27, v239, v238, s40
    v_accvgpr_write_b32 a123, v27
    v_perm_b32 v28, v233, v232, s41
    v_accvgpr_write_b32 a124, v28
    v_perm_b32 v29, v235, v234, s41
    v_accvgpr_write_b32 a125, v29
    v_perm_b32 v30, v237, v236, s41
    v_accvgpr_write_b32 a126, v30
    v_perm_b32 v31, v239, v238, s41
    v_accvgpr_write_b32 a127, v31
    s_waitcnt lgkmcnt(0)
    s_barrier
    ds_read2_b32 v[224:225], v34 offset0:0 offset1:32
    ds_read2_b32 v[226:227], v34 offset0:64 offset1:96
    ds_read2_b32 v[228:229], v34 offset0:128 offset1:160
    ds_read2_b32 v[230:231], v34 offset0:192 offset1:224
    ds_read2_b32 v[232:233], v35 offset0:0 offset1:32
    ds_read2_b32 v[234:235], v35 offset0:64 offset1:96
    ds_read2_b32 v[236:237], v35 offset0:128 offset1:160
    ds_read2_b32 v[238:239], v35 offset0:192 offset1:224
    s_waitcnt vmcnt(28)
    ds_write_b128 v57, v[80:83] offset:0
    ds_write_b128 v57, v[84:87] offset:1024
    ds_write_b128 v57, v[88:91] offset:2048
    ds_write_b128 v57, v[92:95] offset:3072
    v_perm_b32 v24, v209, v208, s40
    v_accvgpr_write_b32 a128, v24
    v_perm_b32 v25, v211, v210, s40
    v_accvgpr_write_b32 a129, v25
    v_perm_b32 v26, v213, v212, s40
    v_accvgpr_write_b32 a130, v26
    v_perm_b32 v27, v215, v214, s40
    v_accvgpr_write_b32 a131, v27
    v_perm_b32 v28, v209, v208, s41
    v_accvgpr_write_b32 a132, v28
    v_perm_b32 v29, v211, v210, s41
    v_accvgpr_write_b32 a133, v29
    v_perm_b32 v30, v213, v212, s41
    v_accvgpr_write_b32 a134, v30
    v_perm_b32 v31, v215, v214, s41
    v_accvgpr_write_b32 a135, v31
    v_perm_b32 v24, v217, v216, s40
    v_accvgpr_write_b32 a136, v24
    v_perm_b32 v25, v219, v218, s40
    v_accvgpr_write_b32 a137, v25
    v_perm_b32 v26, v221, v220, s40
    v_accvgpr_write_b32 a138, v26
    v_perm_b32 v27, v223, v222, s40
    v_accvgpr_write_b32 a139, v27
    v_perm_b32 v28, v217, v216, s41
    v_accvgpr_write_b32 a140, v28
    v_perm_b32 v29, v219, v218, s41
    v_accvgpr_write_b32 a141, v29
    v_perm_b32 v30, v221, v220, s41
    v_accvgpr_write_b32 a142, v30
    v_perm_b32 v31, v223, v222, s41
    v_accvgpr_write_b32 a143, v31
    s_waitcnt lgkmcnt(0)
    s_barrier
    ds_read2_b32 v[208:209], v32 offset0:0 offset1:32
    ds_read2_b32 v[210:211], v32 offset0:64 offset1:96
    ds_read2_b32 v[212:213], v32 offset0:128 offset1:160
    ds_read2_b32 v[214:215], v32 offset0:192 offset1:224
    ds_read2_b32 v[216:217], v33 offset0:0 offset1:32
    ds_read2_b32 v[218:219], v33 offset0:64 offset1:96
    ds_read2_b32 v[220:221], v33 offset0:128 offset1:160
    ds_read2_b32 v[222:223], v33 offset0:192 offset1:224
    s_waitcnt vmcnt(24)
    ds_write_b128 v57, v[96:99] offset:16384
    ds_write_b128 v57, v[100:103] offset:17408
    ds_write_b128 v57, v[104:107] offset:18432
    ds_write_b128 v57, v[108:111] offset:19456
    v_perm_b32 v64, v225, v224, s40
    v_perm_b32 v65, v227, v226, s40
    v_perm_b32 v66, v229, v228, s40
    v_perm_b32 v67, v231, v230, s40
    v_perm_b32 v68, v225, v224, s41
    v_perm_b32 v69, v227, v226, s41
    v_perm_b32 v70, v229, v228, s41
    v_perm_b32 v71, v231, v230, s41
    v_perm_b32 v72, v233, v232, s40
    v_perm_b32 v73, v235, v234, s40
    v_perm_b32 v74, v237, v236, s40
    v_perm_b32 v75, v239, v238, s40
    v_perm_b32 v76, v233, v232, s41
    v_perm_b32 v77, v235, v234, s41
    v_perm_b32 v78, v237, v236, s41
    v_perm_b32 v79, v239, v238, s41
    s_waitcnt lgkmcnt(0)
    s_barrier
    ds_read2_b32 v[224:225], v34 offset0:0 offset1:32
    ds_read2_b32 v[226:227], v34 offset0:64 offset1:96
    ds_read2_b32 v[228:229], v34 offset0:128 offset1:160
    ds_read2_b32 v[230:231], v34 offset0:192 offset1:224
    ds_read2_b32 v[232:233], v35 offset0:0 offset1:32
    ds_read2_b32 v[234:235], v35 offset0:64 offset1:96
    ds_read2_b32 v[236:237], v35 offset0:128 offset1:160
    ds_read2_b32 v[238:239], v35 offset0:192 offset1:224
    s_waitcnt vmcnt(20)
    ds_write_b128 v57, v[112:115] offset:0
    ds_write_b128 v57, v[116:119] offset:1024
    ds_write_b128 v57, v[120:123] offset:2048
    ds_write_b128 v57, v[124:127] offset:3072
    v_perm_b32 v80, v209, v208, s40
    v_perm_b32 v81, v211, v210, s40
    v_perm_b32 v82, v213, v212, s40
    v_perm_b32 v83, v215, v214, s40
    v_perm_b32 v84, v209, v208, s41
    v_perm_b32 v85, v211, v210, s41
    v_perm_b32 v86, v213, v212, s41
    v_perm_b32 v87, v215, v214, s41
    v_perm_b32 v88, v217, v216, s40
    v_perm_b32 v89, v219, v218, s40
    v_perm_b32 v90, v221, v220, s40
    v_perm_b32 v91, v223, v222, s40
    v_perm_b32 v92, v217, v216, s41
    v_perm_b32 v93, v219, v218, s41
    v_perm_b32 v94, v221, v220, s41
    v_perm_b32 v95, v223, v222, s41
    s_waitcnt lgkmcnt(0)
    s_barrier
    ds_read2_b32 v[208:209], v32 offset0:0 offset1:32
    ds_read2_b32 v[210:211], v32 offset0:64 offset1:96
    ds_read2_b32 v[212:213], v32 offset0:128 offset1:160
    ds_read2_b32 v[214:215], v32 offset0:192 offset1:224
    ds_read2_b32 v[216:217], v33 offset0:0 offset1:32
    ds_read2_b32 v[218:219], v33 offset0:64 offset1:96
    ds_read2_b32 v[220:221], v33 offset0:128 offset1:160
    ds_read2_b32 v[222:223], v33 offset0:192 offset1:224
    s_waitcnt vmcnt(16)
    ds_write_b128 v57, v[128:131] offset:16384
    ds_write_b128 v57, v[132:135] offset:17408
    ds_write_b128 v57, v[136:139] offset:18432
    ds_write_b128 v57, v[140:143] offset:19456
    v_perm_b32 v96, v225, v224, s40
    v_perm_b32 v97, v227, v226, s40
    v_perm_b32 v98, v229, v228, s40
    v_perm_b32 v99, v231, v230, s40
    v_perm_b32 v100, v225, v224, s41
    v_perm_b32 v101, v227, v226, s41
    v_perm_b32 v102, v229, v228, s41
    v_perm_b32 v103, v231, v230, s41
    v_perm_b32 v104, v233, v232, s40
    v_perm_b32 v105, v235, v234, s40
    v_perm_b32 v106, v237, v236, s40
    v_perm_b32 v107, v239, v238, s40
    v_perm_b32 v108, v233, v232, s41
    v_perm_b32 v109, v235, v234, s41
    v_perm_b32 v110, v237, v236, s41
    v_perm_b32 v111, v239, v238, s41
    s_waitcnt lgkmcnt(0)
    s_barrier
    ds_read2_b32 v[224:225], v34 offset0:0 offset1:32
    ds_read2_b32 v[226:227], v34 offset0:64 offset1:96
    ds_read2_b32 v[228:229], v34 offset0:128 offset1:160
    ds_read2_b32 v[230:231], v34 offset0:192 offset1:224
    ds_read2_b32 v[232:233], v35 offset0:0 offset1:32
    ds_read2_b32 v[234:235], v35 offset0:64 offset1:96
    ds_read2_b32 v[236:237], v35 offset0:128 offset1:160
    ds_read2_b32 v[238:239], v35 offset0:192 offset1:224
    s_waitcnt vmcnt(12)
    ds_write_b128 v57, v[144:147] offset:0
    ds_write_b128 v57, v[148:151] offset:1024
    ds_write_b128 v57, v[152:155] offset:2048
    ds_write_b128 v57, v[156:159] offset:3072
    v_perm_b32 v112, v209, v208, s40
    v_perm_b32 v113, v211, v210, s40
    v_perm_b32 v114, v213, v212, s40
    v_perm_b32 v115, v215, v214, s40
    v_perm_b32 v116, v209, v208, s41
    v_perm_b32 v117, v211, v210, s41
    v_perm_b32 v118, v213, v212, s41
    v_perm_b32 v119, v215, v214, s41
    v_perm_b32 v120, v217, v216, s40
    v_perm_b32 v121, v219, v218, s40
    v_perm_b32 v122, v221, v220, s40
    v_perm_b32 v123, v223, v222, s40
    v_perm_b32 v124, v217, v216, s41
    v_perm_b32 v125, v219, v218, s41
    v_perm_b32 v126, v221, v220, s41
    v_perm_b32 v127, v223, v222, s41
    s_waitcnt lgkmcnt(0)
    s_barrier
    ds_read2_b32 v[208:209], v32 offset0:0 offset1:32
    ds_read2_b32 v[210:211], v32 offset0:64 offset1:96
    ds_read2_b32 v[212:213], v32 offset0:128 offset1:160
    ds_read2_b32 v[214:215], v32 offset0:192 offset1:224
    ds_read2_b32 v[216:217], v33 offset0:0 offset1:32
    ds_read2_b32 v[218:219], v33 offset0:64 offset1:96
    ds_read2_b32 v[220:221], v33 offset0:128 offset1:160
    ds_read2_b32 v[222:223], v33 offset0:192 offset1:224
    s_waitcnt vmcnt(8)
    ds_write_b128 v57, v[160:163] offset:16384
    ds_write_b128 v57, v[164:167] offset:17408
    ds_write_b128 v57, v[168:171] offset:18432
    ds_write_b128 v57, v[172:175] offset:19456
    v_perm_b32 v128, v225, v224, s40
    v_perm_b32 v129, v227, v226, s40
    v_perm_b32 v130, v229, v228, s40
    v_perm_b32 v131, v231, v230, s40
    v_perm_b32 v132, v225, v224, s41
    v_perm_b32 v133, v227, v226, s41
    v_perm_b32 v134, v229, v228, s41
    v_perm_b32 v135, v231, v230, s41
    v_perm_b32 v136, v233, v232, s40
    v_perm_b32 v137, v235, v234, s40
    v_perm_b32 v138, v237, v236, s40
    v_perm_b32 v139, v239, v238, s40
    v_perm_b32 v140, v233, v232, s41
    v_perm_b32 v141, v235, v234, s41
    v_perm_b32 v142, v237, v236, s41
    v_perm_b32 v143, v239, v238, s41
    s_waitcnt lgkmcnt(0)
    s_barrier
    ds_read2_b32 v[224:225], v34 offset0:0 offset1:32
    ds_read2_b32 v[226:227], v34 offset0:64 offset1:96
    ds_read2_b32 v[228:229], v34 offset0:128 offset1:160
    ds_read2_b32 v[230:231], v34 offset0:192 offset1:224
    ds_read2_b32 v[232:233], v35 offset0:0 offset1:32
    ds_read2_b32 v[234:235], v35 offset0:64 offset1:96
    ds_read2_b32 v[236:237], v35 offset0:128 offset1:160
    ds_read2_b32 v[238:239], v35 offset0:192 offset1:224
    s_waitcnt vmcnt(4)
    ds_write_b128 v57, v[176:179] offset:0
    ds_write_b128 v57, v[180:183] offset:1024
    ds_write_b128 v57, v[184:187] offset:2048
    ds_write_b128 v57, v[188:191] offset:3072
    v_perm_b32 v144, v209, v208, s40
    v_perm_b32 v145, v211, v210, s40
    v_perm_b32 v146, v213, v212, s40
    v_perm_b32 v147, v215, v214, s40
    v_perm_b32 v148, v209, v208, s41
    v_perm_b32 v149, v211, v210, s41
    v_perm_b32 v150, v213, v212, s41
    v_perm_b32 v151, v215, v214, s41
    v_perm_b32 v152, v217, v216, s40
    v_perm_b32 v153, v219, v218, s40
    v_perm_b32 v154, v221, v220, s40
    v_perm_b32 v155, v223, v222, s40
    v_perm_b32 v156, v217, v216, s41
    v_perm_b32 v157, v219, v218, s41
    v_perm_b32 v158, v221, v220, s41
    v_perm_b32 v159, v223, v222, s41
    s_waitcnt lgkmcnt(0)
    s_barrier
    ds_read2_b32 v[208:209], v32 offset0:0 offset1:32
    ds_read2_b32 v[210:211], v32 offset0:64 offset1:96
    ds_read2_b32 v[212:213], v32 offset0:128 offset1:160
    ds_read2_b32 v[214:215], v32 offset0:192 offset1:224
    ds_read2_b32 v[216:217], v33 offset0:0 offset1:32
    ds_read2_b32 v[218:219], v33 offset0:64 offset1:96
    ds_read2_b32 v[220:221], v33 offset0:128 offset1:160
    ds_read2_b32 v[222:223], v33 offset0:192 offset1:224
    s_waitcnt vmcnt(0)
    ds_write_b128 v57, v[192:195] offset:16384
    ds_write_b128 v57, v[196:199] offset:17408
    ds_write_b128 v57, v[200:203] offset:18432
    ds_write_b128 v57, v[204:207] offset:19456
    v_perm_b32 v160, v225, v224, s40
    v_perm_b32 v161, v227, v226, s40
    v_perm_b32 v162, v229, v228, s40
    v_perm_b32 v163, v231, v230, s40
    v_perm_b32 v164, v225, v224, s41
    v_perm_b32 v165, v227, v226, s41
    v_perm_b32 v166, v229, v228, s41
    v_perm_b32 v167, v231, v230, s41
    v_perm_b32 v168, v233, v232, s40
    v_perm_b32 v169, v235, v234, s40
    v_perm_b32 v170, v237, v236, s40
    v_perm_b32 v171, v239, v238, s40
    v_perm_b32 v172, v233, v232, s41
    v_perm_b32 v173, v235, v234, s41
    v_perm_b32 v174, v237, v236, s41
    v_perm_b32 v175, v239, v238, s41
    s_waitcnt lgkmcnt(0)
    s_barrier
    ds_read2_b32 v[224:225], v34 offset0:0 offset1:32
    ds_read2_b32 v[226:227], v34 offset0:64 offset1:96
    ds_read2_b32 v[228:229], v34 offset0:128 offset1:160
    ds_read2_b32 v[230:231], v34 offset0:192 offset1:224
    ds_read2_b32 v[232:233], v35 offset0:0 offset1:32
    ds_read2_b32 v[234:235], v35 offset0:64 offset1:96
    ds_read2_b32 v[236:237], v35 offset0:128 offset1:160
    ds_read2_b32 v[238:239], v35 offset0:192 offset1:224
    v_perm_b32 v176, v209, v208, s40
    v_perm_b32 v177, v211, v210, s40
    v_perm_b32 v178, v213, v212, s40
    v_perm_b32 v179, v215, v214, s40
    v_perm_b32 v180, v209, v208, s41
    v_perm_b32 v181, v211, v210, s41
    v_perm_b32 v182, v213, v212, s41
    v_perm_b32 v183, v215, v214, s41
    v_perm_b32 v184, v217, v216, s40
    v_perm_b32 v185, v219, v218, s40
    v_perm_b32 v186, v221, v220, s40
    v_perm_b32 v187, v223, v222, s40
    v_perm_b32 v188, v217, v216, s41
    v_perm_b32 v189, v219, v218, s41
    v_perm_b32 v190, v221, v220, s41
    v_perm_b32 v191, v223, v222, s41
    s_waitcnt lgkmcnt(0)
    v_perm_b32 v192, v225, v224, s40
    v_perm_b32 v193, v227, v226, s40
    v_perm_b32 v194, v229, v228, s40
    v_perm_b32 v195, v231, v230, s40
    v_perm_b32 v196, v225, v224, s41
    v_perm_b32 v197, v227, v226, s41
    v_perm_b32 v198, v229, v228, s41
    v_perm_b32 v199, v231, v230, s41
    v_perm_b32 v200, v233, v232, s40
    v_perm_b32 v201, v235, v234, s40
    v_perm_b32 v202, v237, v236, s40
    v_perm_b32 v203, v239, v238, s40
    v_perm_b32 v204, v233, v232, s41
    v_perm_b32 v205, v235, v234, s41
    v_perm_b32 v206, v237, v236, s41
    v_perm_b32 v207, v239, v238, s41
    s_cmp_eq_u32 s53, 0
    s_cbranch_scc1 L_run0
L_run1:
    s_barrier
    s_mul_i32 s49, s42, 36864
    s_mul_i32 s43, s62, 36864
    s_lshl_b32 s58, s33, 10
    s_mov_b32 s59, 0
    s_mov_b32 s47, 0
    s_mov_b32 s61, 0
    s_mov_b32 s38, 1069066811
    s_mov_b32 s37, 0x358637bd
    s_add_u32 m0, s58, 0
    s_nop 0
    buffer_load_dwordx4 v6, s[12:15], s49 offen lds
    s_add_u32 m0, s58, 4096
    s_nop 0
    buffer_load_dwordx4 v7, s[12:15], s49 offen lds
    s_add_u32 m0, s58, 8192
    s_nop 0
    buffer_load_dwordx4 v8, s[12:15], s49 offen lds
    s_add_u32 m0, s58, 12288
    s_nop 0
    buffer_load_dwordx4 v9, s[12:15], s49 offen lds
    s_add_u32 m0, s58, 16384
    s_nop 0
    buffer_load_dwordx4 v10, s[12:15], s49 offen lds
    s_add_u32 m0, s58, 20480
    s_nop 0
    buffer_load_dwordx4 v11, s[12:15], s49 offen lds
    s_add_u32 m0, s58, 24576
    s_nop 0
    buffer_load_dwordx4 v12, s[12:15], s49 offen lds
    s_add_u32 m0, s58, 28672
    s_nop 0
    buffer_load_dwordx4 v13, s[12:15], s49 offen lds
    s_add_u32 m0, s58, 32768
    s_nop 0
    buffer_load_dwordx4 v14, s[12:15], s49 offen lds
    s_add_u32 s49, s49, s43
    s_add_u32 s58, s58, 36864
    s_add_u32 m0, s58, 0
    s_nop 0
    buffer_load_dwordx4 v6, s[12:15], s49 offen lds
    s_add_u32 m0, s58, 4096
    s_nop 0
    buffer_load_dwordx4 v7, s[12:15], s49 offen lds
    s_add_u32 m0, s58, 8192
    s_nop 0
    buffer_load_dwordx4 v8, s[12:15], s49 offen lds
    s_add_u32 m0, s58, 12288
    s_nop 0
    buffer_load_dwordx4 v9, s[12:15], s49 offen lds
    s_add_u32 m0, s58, 16384
    s_nop 0
    buffer_load_dwordx4 v10, s[12:15], s49 offen lds
    s_add_u32 m0, s58, 20480
    s_nop 0
    buffer_load_dwordx4 v11, s[12:15], s49 offen lds
    s_add_u32 m0, s58, 24576
    s_nop 0
    buffer_load_dwordx4 v12, s[12:15], s49 offen lds
    s_add_u32 m0, s58, 28672
    s_nop 0
    buffer_load_dwordx4 v13, s[12:15], s49 offen lds
    s_add_u32 m0, s58, 32768
    s_nop 0
    buffer_load_dwordx4 v14, s[12:15], s49 offen lds
    s_add_u32 s49, s49, s43
    s_add_u32 s58, s58, 36864
    s_waitcnt vmcnt(9)
L_gQQ_top:
    s_barrier
    v_add_u32 v20, s59, v16
    v_add_u32 v21, s59, v17
    v_add_u32 v22, s59, v18
    v_add_u32 v23, s59, v19
    ds_read_b128 v[24:27], v20 offset:0
    ds_read_b128 v[28:31], v22 offset:0
    ds_read_b128 v[32:35], v21 offset:0
    ds_read_b128 v[36:39], v23 offset:0
    s_cmp_eq_u32 s61, 0
    s_cbranch_scc1 L_gQQ_np
    s_cmp_lg_u32 s33, 0
    s_cbranch_scc1 L_gQQ_np
    s_lshr_b32 s35, s61, 8
    s_and_b32 s36, s61, 0xff
    v_mov_b32 v2, s35
    v_mov_b32 v3, s36
    s_mov_b64 exec, 1
    buffer_atomic_add v3, v2, s[20:23], 0 offen
    s_mov_b64 exec, -1
L_gQQ_np:
    s_mov_b32 s61, 0
    ds_read_b128 v[240:243], v20 offset:128
    ds_read_b128 v[244:247], v22 offset:128
    s_waitcnt lgkmcnt(4)
    v_mfma_f32_16x16x32_bf16 v[40:43], v[64:67], v[24:27], 0
    s_add_u32 m0, s58, 0
    s_nop 0
    buffer_load_dwordx4 v6, s[12:15], s49 offen lds
    v_mfma_f32_16x16x32_bf16 v[44:47], v[68:71], v[24:27], 0
    v_mfma_f32_16x16x32_bf16 v[224:227], a[0:3], v[24:27], 0
    v_mfma_f32_16x16x32_bf16 v[228:231], a[4:7], v[24:27], 0
    v_mfma_f32_16x16x32_bf16 v[48:51], v[64:67], v[28:31], 0
    v_mfma_f32_16x16x32_bf16 v[52:55], v[68:71], v[28:31], 0
    v_mfma_f32_16x16x32_bf16 v[232:235], a[0:3], v[28:31], 0
    v_mfma_f32_16x16x32_bf16 v[236:239], a[4:7], v[28:31], 0
    ds_read_b128 v[248:251], v21 offset:128
    ds_read_b128 v[252:255], v23 offset:128
    s_waitcnt lgkmcnt(4)
    v_mfma_f32_16x16x32_bf16 v[40:43], v[72:75], v[32:35], v[40:43]
    v_mfma_f32_16x16x32_bf16 v[44:47], v[76:79], v[32:35], v[44:47]
    v_mfma_f32_16x16x32_bf16 v[224:227], a[8:11], v[32:35], v[224:227]
    v_mfma_f32_16x16x32_bf16 v[228:231], a[12:15], v[32:35], v[228:231]
    v_mfma_f32_16x16x32_bf16 v[48:51], v[72:75], v[36:39], v[48:51]
    v_mfma_f32_16x16x32_bf16 v[52:55], v[76:79], v[36:39], v[52:55]
    v_mfma_f32_16x16x32_bf16 v[232:235], a[8:11], v[36:39], v[232:235]
    v_mfma_f32_16x16x32_bf16 v[236:239], a[12:15], v[36:39], v[236:239]
    ds_read_b128 v[24:27], v20 offset:256
    ds_read_b128 v[28:31], v22 offset:256
    s_waitcnt lgkmcnt(4)
    v_mfma_f32_16x16x32_bf16 v[40:43], v[80:83], v[240:243], v[40:43]
    s_add_u32 m0, s58, 4096
    s_nop 0
    buffer_load_dwordx4 v7, s[12:15], s49 offen lds
    v_mfma_f32_16x16x32_bf16 v[44:47], v[84:87], v[240:243], v[44:47]
    v_mfma_f32_16x16x32_bf16 v[224:227], a[16:19], v[240:243], v[224:227]
    v_mfma_f32_16x16x32_bf16 v[228:231], a[20:23], v[240:243], v[228:231]
    v_mfma_f32_16x16x32_bf16 v[48:51], v[80:83], v[244:247], v[48:51]
    v_mfma_f32_16x16x32_bf16 v[52:55], v[84:87], v[244:247], v[52:55]
    v_mfma_f32_16x16x32_bf16 v[232:235], a[16:19], v[244:247], v[232:235]
    v_mfma_f32_16x16x32_bf16 v[236:239], a[20:23], v[244:247], v[236:239]
    ds_read_b128 v[32:35], v21 offset:256
    ds_read_b128 v[36:39], v23 offset:256
    s_waitcnt lgkmcnt(4)
    v_mfma_f32_16x16x32_bf16 v[40:43], v[88:91], v[248:251], v[40:43]
    v_mfma_f32_16x16x32_bf16 v[44:47], v[92:95], v[248:251], v[44:47]
    v_mfma_f32_16x16x32_bf16 v[224:227], a[24:27], v[248:251], v[224:227]
    v_mfma_f32_16x16x32_bf16 v[228:231], a[28:31], v[248:251], v[228:231]
    v_mfma_f32_16x16x32_bf16 v[48:51], v[88:91], v[252:255], v[48:51]
    v_mfma_f32_16x16x32_bf16 v[52:55], v[92:95], v[252:255], v[52:55]
    v_mfma_f32_16x16x32_bf16 v[232:235], a[24:27], v[252:255], v[232:235]
    v_mfma_f32_16x16x32_bf16 v[236:239], a[28:31], v[252:255], v[236:239]
    ds_read_b128 v[240:243], v20 offset:384
    ds_read_b128 v[244:247], v22 offset:384
    s_waitcnt lgkmcnt(4)
    v_mfma_f32_16x16x32_bf16 v[40:43], v[96:99], v[24:27], v[40:43]
    s_add_u32 m0, s58, 8192
    s_nop 0
    buffer_load_dwordx4 v8, s[12:15], s49 offen lds
    v_mfma_f32_16x16x32_bf16 v[44:47], v[100:103], v[24:27], v[44:47]
    v_mfma_f32_16x16x32_bf16 v[224:227], a[32:35], v[24:27], v[224:227]
    v_mfma_f32_16x16x32_bf16 v[228:231], a[36:39], v[24:27], v[228:231]
    v_mfma_f32_16x16x32_bf16 v[48:51], v[96:99], v[28:31], v[48:51]
    v_mfma_f32_16x16x32_bf16 v[52:55], v[100:103], v[28:31], v[52:55]
    v_mfma_f32_16x16x32_bf16 v[232:235], a[32:35], v[28:31], v[232:235]
    v_mfma_f32_16x16x32_bf16 v[236:239], a[36:39], v[28:31], v[236:239]
    ds_read_b128 v[248:251], v21 offset:384
    ds_read_b128 v[252:255], v23 offset:384
    s_waitcnt lgkmcnt(4)
    v_mfma_f32_16x16x32_bf16 v[40:43], v[104:107], v[32:35], v[40:43]
    v_mfma_f32_16x16x32_bf16 v[44:47], v[108:111], v[32:35], v[44:47]
    v_mfma_f32_16x16x32_bf16 v[224:227], a[40:43], v[32:35], v[224:227]
    v_mfma_f32_16x16x32_bf16 v[228:231], a[44:47], v[32:35], v[228:231]
    v_mfma_f32_16x16x32_bf16 v[48:51], v[104:107], v[36:39], v[48:51]
    v_mfma_f32_16x16x32_bf16 v[52:55], v[108:111], v[36:39], v[52:55]
    v_mfma_f32_16x16x32_bf16 v[232:235], a[40:43], v[36:39], v[232:235]
    v_mfma_f32_16x16x32_bf16 v[236:239], a[44:47], v[36:39], v[236:239]
    ds_read_b128 v[24:27], v20 offset:512
    ds_read_b128 v[28:31], v22 offset:512
    s_waitcnt lgkmcnt(4)
    v_mfma_f32_16x16x32_bf16 v[40:43], v[112:115], v[240:243], v[40:43]
    s_add_u32 m0, s58, 12288
    s_nop 0
    buffer_load_dwordx4 v9, s[12:15], s49 offen lds
    v_mfma_f32_16x16x32_bf16 v[44:47], v[116:119], v[240:243], v[44:47]
    v_mfma_f32_16x16x32_bf16 v[224:227], a[48:51], v[240:243], v[224:227]
    v_mfma_f32_16x16x32_bf16 v[228:231], a[52:55], v[240:243], v[228:231]
    v_mfma_f32_16x16x32_bf16 v[48:51], v[112:115], v[244:247], v[48:51]
    v_mfma_f32_16x16x32_bf16 v[52:55], v[116:119], v[244:247], v[52:55]
    v_mfma_f32_16x16x32_bf16 v[232:235], a[48:51], v[244:247], v[232:235]
    v_mfma_f32_16x16x32_bf16 v[236:239], a[52:55], v[244:247], v[236:239]
    ds_read_b128 v[32:35], v21 offset:512
    ds_read_b128 v[36:39], v23 offset:512
    s_waitcnt lgkmcnt(4)
    v_mfma_f32_16x16x32_bf16 v[40:43], v[120:123], v[248:251], v[40:43]
    v_mfma_f32_16x16x32_bf16 v[44:47], v[124:127], v[248:251], v[44:47]
    v_mfma_f32_16x16x32_bf16 v[224:227], a[56:59], v[248:251], v[224:227]
    v_mfma_f32_16x16x32_bf16 v[228:231], a[60:63], v[248:251], v[228:231]
    v_mfma_f32_16x16x32_bf16 v[48:51], v[120:123], v[252:255], v[48:51]
    v_mfma_f32_16x16x32_bf16 v[52:55], v[124:127], v[252:255], v[52:55]
    v_mfma_f32_16x16x32_bf16 v[232:235], a[56:59], v[252:255], v[232:235]
    v_mfma_f32_16x16x32_bf16 v[236:239], a[60:63], v[252:255], v[236:239]
    ds_read_b128 v[240:243], v20 offset:640
    ds_read_b128 v[244:247], v22 offset:640
    s_waitcnt lgkmcnt(4)
    v_mfma_f32_16x16x32_bf16 v[40:43], v[128:131], v[24:27], v[40:43]
    s_add_u32 m0, s58, 16384
    s_nop 0
    buffer_load_dwordx4 v10, s[12:15], s49 offen lds
    v_mfma_f32_16x16x32_bf16 v[44:47], v[132:135], v[24:27], v[44:47]
    v_mfma_f32_16x16x32_bf16 v[224:227], a[64:67], v[24:27], v[224:227]
    v_mfma_f32_16x16x32_bf16 v[228:231], a[68:71], v[24:27], v[228:231]
    v_mfma_f32_16x16x32_bf16 v[48:51], v[128:131], v[28:31], v[48:51]
    v_mfma_f32_16x16x32_bf16 v[52:55], v[132:135], v[28:31], v[52:55]
    v_mfma_f32_16x16x32_bf16 v[232:235], a[64:67], v[28:31], v[232:235]
    v_mfma_f32_16x16x32_bf16 v[236:239], a[68:71], v[28:31], v[236:239]
    ds_read_b128 v[248:251], v21 offset:640
    ds_read_b128 v[252:255], v23 offset:640
    s_waitcnt lgkmcnt(4)
    v_mfma_f32_16x16x32_bf16 v[40:43], v[136:139], v[32:35], v[40:43]
    v_mfma_f32_16x16x32_bf16 v[44:47], v[140:143], v[32:35], v[44:47]
    v_mfma_f32_16x16x32_bf16 v[224:227], a[72:75], v[32:35], v[224:227]
    v_mfma_f32_16x16x32_bf16 v[228:231], a[76:79], v[32:35], v[228:231]
    v_mfma_f32_16x16x32_bf16 v[48:51], v[136:139], v[36:39], v[48:51]
    v_mfma_f32_16x16x32_bf16 v[52:55], v[140:143], v[36:39], v[52:55]
    v_mfma_f32_16x16x32_bf16 v[232:235], a[72:75], v[36:39], v[232:235]
    v_mfma_f32_16x16x32_bf16 v[236:239], a[76:79], v[36:39], v[236:239]
    ds_read_b128 v[24:27], v20 offset:768
    ds_read_b128 v[28:31], v22 offset:768
    s_waitcnt lgkmcnt(4)
    v_mfma_f32_16x16x32_bf16 v[40:43], v[144:147], v[240:243], v[40:43]
    s_add_u32 m0, s58, 20480
    s_nop 0
    buffer_load_dwordx4 v11, s[12:15], s49 offen lds
    v_mfma_f32_16x16x32_bf16 v[44:47], v[148:151], v[240:243], v[44:47]
    v_mfma_f32_16x16x32_bf16 v[224:227], a[80:83], v[240:243], v[224:227]
    v_mfma_f32_16x16x32_bf16 v[228:231], a[84:87], v[240:243], v[228:231]
    v_mfma_f32_16x16x32_bf16 v[48:51], v[144:147], v[244:247], v[48:51]
    v_mfma_f32_16x16x32_bf16 v[52:55], v[148:151], v[244:247], v[52:55]
    v_mfma_f32_16x16x32_bf16 v[232:235], a[80:83], v[244:247], v[232:235]
    v_mfma_f32_16x16x32_bf16 v[236:239], a[84:87], v[244:247], v[236:239]
    ds_read_b128 v[32:35], v21 offset:768
    ds_read_b128 v[36:39], v23 offset:768
    s_waitcnt lgkmcnt(4)
    v_mfma_f32_16x16x32_bf16 v[40:43], v[152:155], v[248:251], v[40:43]
    v_mfma_f32_16x16x32_bf16 v[44:47], v[156:159], v[248:251], v[44:47]
    v_mfma_f32_16x16x32_bf16 v[224:227], a[88:91], v[248:251], v[224:227]
    v_mfma_f32_16x16x32_bf16 v[228:231], a[92:95], v[248:251], v[228:231]
    v_mfma_f32_16x16x32_bf16 v[48:51], v[152:155], v[252:255], v[48:51]
    v_mfma_f32_16x16x32_bf16 v[52:55], v[156:159], v[252:255], v[52:55]
    v_mfma_f32_16x16x32_bf16 v[232:235], a[88:91], v[252:255], v[232:235]
    v_mfma_f32_16x16x32_bf16 v[236:239], a[92:95], v[252:255], v[236:239]
    ds_read_b128 v[240:243], v20 offset:896
    ds_read_b128 v[244:247], v22 offset:896
    s_waitcnt lgkmcnt(4)
    v_mfma_f32_16x16x32_bf16 v[40:43], v[160:163], v[24:27], v[40:43]
    s_add_u32 m0, s58, 24576
    s_nop 0
    buffer_load_dwordx4 v12, s[12:15], s49 offen lds
    v_mfma_f32_16x16x32_bf16 v[44:47], v[164:167], v[24:27], v[44:47]
    v_mfma_f32_16x16x32_bf16 v[224:227], a[96:99], v[24:27], v[224:227]
    v_mfma_f32_16x16x32_bf16 v[228:231], a[100:103], v[24:27], v[228:231]
    v_mfma_f32_16x16x32_bf16 v[48:51], v[160:163], v[28:31], v[48:51]
    v_mfma_f32_16x16x32_bf16 v[52:55], v[164:167], v[28:31], v[52:55]
    v_mfma_f32_16x16x32_bf16 v[232:235], a[96:99], v[28:31], v[232:235]
    v_mfma_f32_16x16x32_bf16 v[236:239], a[100:103], v[28:31], v[236:239]
    ds_read_b128 v[248:251], v21 offset:896
    ds_read_b128 v[252:255], v23 offset:896
    s_waitcnt lgkmcnt(4)
    v_mfma_f32_16x16x32_bf16 v[40:43], v[168:171], v[32:35], v[40:43]
    v_mfma_f32_16x16x32_bf16 v[44:47], v[172:175], v[32:35], v[44:47]
    v_mfma_f32_16x16x32_bf16 v[224:227], a[104:107], v[32:35], v[224:227]
    v_mfma_f32_16x16x32_bf16 v[228:231], a[108:111], v[32:35], v[228:231]
    v_mfma_f32_16x16x32_bf16 v[48:51], v[168:171], v[36:39], v[48:51]
    v_mfma_f32_16x16x32_bf16 v[52:55], v[172:175], v[36:39], v[52:55]
    v_mfma_f32_16x16x32_bf16 v[232:235], a[104:107], v[36:39], v[232:235]
    v_mfma_f32_16x16x32_bf16 v[236:239], a[108:111], v[36:39], v[236:239]
    ds_read_b128 v[24:27], v20 offset:1024
    ds_read_b128 v[28:31], v22 offset:1024
    s_waitcnt lgkmcnt(4)
    v_mfma_f32_16x16x32_bf16 v[40:43], v[176:179], v[240:243], v[40:43]
    s_add_u32 m0, s58, 28672
    s_nop 0
    buffer_load_dwordx4 v13, s[12:15], s49 offen lds
    v_mfma_f32_16x16x32_bf16 v[44:47], v[180:183], v[240:243], v[44:47]
    v_mfma_f32_16x16x32_bf16 v[224:227], a[112:115], v[240:243], v[224:227]
    v_mfma_f32_16x16x32_bf16 v[228:231], a[116:119], v[240:243], v[228:231]
    v_mfma_f32_16x16x32_bf16 v[48:51], v[176:179], v[244:247], v[48:51]
    v_mfma_f32_16x16x32_bf16 v[52:55], v[180:183], v[244:247], v[52:55]
    v_mfma_f32_16x16x32_bf16 v[232:235], a[112:115], v[244:247], v[232:235]
    v_mfma_f32_16x16x32_bf16 v[236:239], a[116:119], v[244:247], v[236:239]
    ds_read_b128 v[32:35], v21 offset:1024
    ds_read_b128 v[36:39], v23 offset:1024
    s_waitcnt lgkmcnt(4)
    v_mfma_f32_16x16x32_bf16 v[40:43], v[184:187], v[248:251], v[40:43]
    v_mfma_f32_16x16x32_bf16 v[44:47], v[188:191], v[248:251], v[44:47]
    v_mfma_f32_16x16x32_bf16 v[224:227], a[120:123], v[248:251], v[224:227]
    v_mfma_f32_16x16x32_bf16 v[228:231], a[124:127], v[248:251], v[228:231]
    v_mfma_f32_16x16x32_bf16 v[48:51], v[184:187], v[252:255], v[48:51]
    v_mfma_f32_16x16x32_bf16 v[52:55], v[188:191], v[252:255], v[52:55]
    v_mfma_f32_16x16x32_bf16 v[232:235], a[120:123], v[252:255], v[232:235]
    v_mfma_f32_16x16x32_bf16 v[236:239], a[124:127], v[252:255], v[236:239]
    s_waitcnt lgkmcnt(2)
    v_mfma_f32_16x16x32_bf16 v[40:43], v[192:195], v[24:27], v[40:43]
    s_add_u32 m0, s58, 32768
    s_nop 0
    buffer_load_dwordx4 v14, s[12:15], s49 offen lds
    v_mfma_f32_16x16x32_bf16 v[44:47], v[196:199], v[24:27], v[44:47]
    v_mfma_f32_16x16x32_bf16 v[224:227], a[128:131], v[24:27], v[224:227]
    v_mfma_f32_16x16x32_bf16 v[228:231], a[132:135], v[24:27], v[228:231]
    v_mfma_f32_16x16x32_bf16 v[48:51], v[192:195], v[28:31], v[48:51]
    v_mfma_f32_16x16x32_bf16 v[52:55], v[196:199], v[28:31], v[52:55]
    v_mfma_f32_16x16x32_bf16 v[232:235], a[128:131], v[28:31], v[232:235]
    v_mfma_f32_16x16x32_bf16 v[236:239], a[132:135], v[28:31], v[236:239]
    s_waitcnt lgkmcnt(0)
    v_mfma_f32_16x16x32_bf16 v[40:43], v[200:203], v[32:35], v[40:43]
    v_mfma_f32_16x16x32_bf16 v[44:47], v[204:207], v[32:35], v[44:47]
    v_mfma_f32_16x16x32_bf16 v[224:227], a[136:139], v[32:35], v[224:227]
    v_mfma_f32_16x16x32_bf16 v[228:231], a[140:143], v[32:35], v[228:231]
    v_mfma_f32_16x16x32_bf16 v[48:51], v[200:203], v[36:39], v[48:51]
    v_mfma_f32_16x16x32_bf16 v[52:55], v[204:207], v[36:39], v[52:55]
    v_mfma_f32_16x16x32_bf16 v[232:235], a[136:139], v[36:39], v[232:235]
    v_mfma_f32_16x16x32_bf16 v[236:239], a[140:143], v[36:39], v[236:239]
    s_add_u32 s49, s49, s43
    s_add_u32 s58, s58, 36864
    s_sub_u32 s35, s58, 110592
    s_cmp_ge_u32 s58, 110592
    s_cselect_b32 s58, s35, s58
    s_add_u32 s59, s59, 36864
    s_cmp_ge_u32 s59, 110592
    s_cselect_b32 s59, 0, s59
    s_lshr_b32 s35, s42, 6
    s_cmp_eq_u32 s35, s52
    s_cbranch_scc1 L_gQQ_same
    s_add_u32 s36, s52, s48
    s_lshl_b32 s36, s36, 10
    s_or_b32 s61, s36, s47
    s_cmp_eq_u32 s47, 0
    s_cselect_b32 s61, 0, s61
    s_mov_b32 s47, 0
    s_mov_b32 s52, s35
L_gQQ_same:
    s_add_u32 s47, s47, 1
    v_cvt_pk_bf16_f32 v208, v40, v44
    v_cvt_pk_bf16_f32 v209, v41, v45
    v_cvt_pk_bf16_f32 v210, v42, v46
    v_cvt_pk_bf16_f32 v211, v43, v47
    buffer_store_dwordx4 v[208:211], v0, s[8:11], s44 offen offset:0 sc1
    v_cvt_pk_bf16_f32 v212, v48, v52
    v_cvt_pk_bf16_f32 v213, v49, v53
    v_cvt_pk_bf16_f32 v214, v50, v54
    v_cvt_pk_bf16_f32 v215, v51, v55
    buffer_store_dwordx4 v[212:215], v0, s[8:11], s44 offen offset:1024 sc1
    v_cvt_pk_bf16_f32 v216, v224, v228
    v_cvt_pk_bf16_f32 v217, v225, v229
    v_cvt_pk_bf16_f32 v218, v226, v230
    v_cvt_pk_bf16_f32 v219, v227, v231
    buffer_store_dwordx4 v[216:219], v0, s[8:11], s60 offen offset:0 sc1
    v_cvt_pk_bf16_f32 v220, v232, v236
    v_cvt_pk_bf16_f32 v221, v233, v237
    v_cvt_pk_bf16_f32 v222, v234, v238
    v_cvt_pk_bf16_f32 v223, v235, v239
    buffer_store_dwordx4 v[220:223], v0, s[8:11], s60 offen offset:1024 sc1
    s_add_u32 s44, s44, s55
    s_add_u32 s60, s60, s55
    s_add_u32 s42, s42, s62
    s_waitcnt vmcnt(13)
    s_cmp_lt_u32 s42, 64
    s_cbranch_scc1 L_gQQ_top
    s_lshr_b32 s35, s61, 8
    s_and_b32 s36, s61, 0xff
    s_waitcnt vmcnt(0)
    s_barrier
    s_cmp_lg_u32 s33, 0
    s_cbranch_scc1 L_sigQQa
    v_mov_b32 v2, s35
    v_mov_b32 v3, s36
    s_mov_b64 exec, 1
    buffer_atomic_add v3, v2, s[20:23], 0 offen
    s_mov_b64 exec, -1
L_sigQQa:
    s_add_u32 s35, s52, s48
    s_lshl_b32 s35, s35, 2
    s_waitcnt vmcnt(0)
    s_barrier
    s_cmp_lg_u32 s33, 0
    s_cbranch_scc1 L_sigQQb
    v_mov_b32 v2, s35
    v_mov_b32 v3, s47
    s_mov_b64 exec, 1
    buffer_atomic_add v3, v2, s[20:23], 0 offen
    s_mov_b64 exec, -1
L_sigQQb:
    s_branch L_gemm_done
L_job_b:
    s_mov_b32 s45, 3456
    s_mov_b32 s16, s80
    s_mov_b32 s17, s81
    s_mov_b32 s18, 1990656
    v_mul_u32_u24 v56, 3456, v2
    v_lshl_add_u32 v56, v3, 4, v56
    s_mov_b32 s62, 4
    s_and_b32 s42, s34, 3
    s_cmp_ge_u32 s34, 192
    s_cbranch_scc1 L_bkv
    s_sub_u32 s36, s34, 176
    s_lshr_b32 s32, s36, 2
    s_lshl_b32 s32, s32, 2
    s_add_u32 s32, s32, s33
    s_lshl_b32 s32, s32, 1
    s_mul_i32 s46, s32, 36
    s_add_u32 s46, s46, 36
    s_lshl_b32 s44, s42, 16
    s_lshl_b32 s35, s32, 11
    s_add_u32 s44, s44, s35
    s_add_u32 s44, s44, 62914560
    s_add_u32 s60, s44, 2048
    s_mov_b32 s55, 262144
    s_mov_b32 s48, 25
    s_mov_b32 s35, s46
    s_lshl_b32 s36, s45, 4
    buffer_load_dwordx4 a[0:3], v56, s[16:19], s35 offen
    s_add_u32 s35, s35, s36
    buffer_load_dwordx4 a[4:7], v56, s[16:19], s35 offen
    s_add_u32 s35, s35, s36
    buffer_load_dwordx4 a[8:11], v56, s[16:19], s35 offen
    s_add_u32 s35, s35, s36
    buffer_load_dwordx4 a[12:15], v56, s[16:19], s35 offen
    s_add_u32 s35, s35, s36
    buffer_load_dwordx4 a[16:19], v56, s[16:19], s35 offen
    s_add_u32 s35, s35, s36
    buffer_load_dwordx4 a[20:23], v56, s[16:19], s35 offen
    s_add_u32 s35, s35, s36
    buffer_load_dwordx4 a[24:27], v56, s[16:19], s35 offen
    s_add_u32 s35, s35, s36
    buffer_load_dwordx4 a[28:31], v56, s[16:19], s35 offen
    s_add_u32 s35, s35, s36
    buffer_load_dwordx4 a[32:35], v56, s[16:19], s35 offen
    s_add_u32 s35, s35, s36
    buffer_load_dwordx4 a[36:39], v56, s[16:19], s35 offen
    s_add_u32 s35, s35, s36
    buffer_load_dwordx4 a[40:43], v56, s[16:19], s35 offen
    s_add_u32 s35, s35, s36
    buffer_load_dwordx4 a[44:47], v56, s[16:19], s35 offen
    s_add_u32 s35, s35, s36
    buffer_load_dwordx4 a[48:51], v56, s[16:19], s35 offen
    s_add_u32 s35, s35, s36
    buffer_load_dwordx4 a[52:55], v56, s[16:19], s35 offen
    s_add_u32 s35, s35, s36
    buffer_load_dwordx4 a[56:59], v56, s[16:19], s35 offen
    s_add_u32 s35, s35, s36
    buffer_load_dwordx4 a[60:63], v56, s[16:19], s35 offen
    s_add_u32 s35, s35, s36
    buffer_load_dwordx4 a[64:67], v56, s[16:19], s35 offen
    s_add_u32 s35, s35, s36
    buffer_load_dwordx4 a[68:71], v56, s[16:19], s35 offen
    s_add_u32 s35, s35, s36
    buffer_load_dwordx4 a[72:75], v56, s[16:19], s35 offen
    s_add_u32 s35, s35, s36
    buffer_load_dwordx4 a[76:79], v56, s[16:19], s35 offen
    s_add_u32 s35, s35, s36
    buffer_load_dwordx4 a[80:83], v56, s[16:19], s35 offen
    s_add_u32 s35, s35, s36
    buffer_load_dwordx4 a[84:87], v56, s[16:19], s35 offen
    s_add_u32 s35, s35, s36
    buffer_load_dwordx4 a[88:91], v56, s[16:19], s35 offen
    s_add_u32 s35, s35, s36
    buffer_load_dwordx4 a[92:95], v56, s[16:19], s35 offen
    s_add_u32 s35, s35, s36
    buffer_load_dwordx4 a[96:99], v56, s[16:19], s35 offen
    s_add_u32 s35, s35, s36
    buffer_load_dwordx4 a[100:103], v56, s[16:19], s35 offen
    s_add_u32 s35, s35, s36
    buffer_load_dwordx4 a[104:107], v56, s[16:19], s35 offen
    s_add_u32 s35, s35, s36
    buffer_load_dwordx4 a[108:111], v56, s[16:19], s35 offen
    s_add_u32 s35, s35, s36
    buffer_load_dwordx4 a[112:115], v56, s[16:19], s35 offen
    s_add_u32 s35, s35, s36
    buffer_load_dwordx4 a[116:119], v56, s[16:19], s35 offen
    s_add_u32 s35, s35, s36
    buffer_load_dwordx4 a[120:123], v56, s[16:19], s35 offen
    s_add_u32 s35, s35, s36
    buffer_load_dwordx4 a[124:127], v56, s[16:19], s35 offen
    s_add_u32 s35, s35, s36
    buffer_load_dwordx4 a[128:131], v56, s[16:19], s35 offen
    s_add_u32 s35, s35, s36
    buffer_load_dwordx4 a[132:135], v56, s[16:19], s35 offen
    s_add_u32 s35, s35, s36
    buffer_load_dwordx4 a[136:139], v56, s[16:19], s35 offen
    s_add_u32 s35, s35, s36
    buffer_load_dwordx4 a[140:143], v56, s[16:19], s35 offen
    s_sub_u32 s46, s46, 36
    s_mov_b32 s53, 2
    s_mov_b32 s35, s46
    s_lshl_b32 s36, s45, 4
    buffer_load_dwordx4 v[64:67], v56, s[16:19], s35 offen
    s_add_u32 s35, s35, s36
    buffer_load_dwordx4 v[68:71], v56, s[16:19], s35 offen
    s_add_u32 s35, s35, s36
    buffer_load_dwordx4 v[72:75], v56, s[16:19], s35 offen
    s_add_u32 s35, s35, s36
    buffer_load_dwordx4 v[76:79], v56, s[16:19], s35 offen
    s_add_u32 s35, s35, s36
    buffer_load_dwordx4 v[80:83], v56, s[16:19], s35 offen
    s_add_u32 s35, s35, s36
    buffer_load_dwordx4 v[84:87], v56, s[16:19], s35 offen
    s_add_u32 s35, s35, s36
    buffer_load_dwordx4 v[88:91], v56, s[16:19], s35 offen
    s_add_u32 s35, s35, s36
    buffer_load_dwordx4 v[92:95], v56, s[16:19], s35 offen
    s_add_u32 s35, s35, s36
    buffer_load_dwordx4 v[96:99], v56, s[16:19], s35 offen
    s_add_u32 s35, s35, s36
    buffer_load_dwordx4 v[100:103], v56, s[16:19], s35 offen
    s_add_u32 s35, s35, s36
    buffer_load_dwordx4 v[104:107], v56, s[16:19], s35 offen
    s_add_u32 s35, s35, s36
    buffer_load_dwordx4 v[108:111], v56, s[16:19], s35 offen
    s_add_u32 s35, s35, s36
    buffer_load_dwordx4 v[112:115], v56, s[16:19], s35 offen
    s_add_u32 s35, s35, s36
    buffer_load_dwordx4 v[116:119], v56, s[16:19], s35 offen
    s_add_u32 s35, s35, s36
    buffer_load_dwordx4 v[120:123], v56, s[16:19], s35 offen
    s_add_u32 s35, s35, s36
    buffer_load_dwordx4 v[124:127], v56, s[16:19], s35 offen
    s_add_u32 s35, s35, s36
    buffer_load_dwordx4 v[128:131], v56, s[16:19], s35 offen
    s_add_u32 s35, s35, s36
    buffer_load_dwordx4 v[132:135], v56, s[16:19], s35 offen
    s_add_u32 s35, s35, s36
    buffer_load_dwordx4 v[136:139], v56, s[16:19], s35 offen
    s_add_u32 s35, s35, s36
    buffer_load_dwordx4 v[140:143], v56, s[16:19], s35 offen
    s_add_u32 s35, s35, s36
    buffer_load_dwordx4 v[144:147], v56, s[16:19], s35 offen
    s_add_u32 s35, s35, s36
    buffer_load_dwordx4 v[148:151], v56, s[16:19], s35 offen
    s_add_u32 s35, s35, s36
    buffer_load_dwordx4 v[152:155], v56, s[16:19], s35 offen
    s_add_u32 s35, s35, s36
    buffer_load_dwordx4 v[156:159], v56, s[16:19], s35 offen
    s_add_u32 s35, s35, s36
    buffer_load_dwordx4 v[160:163], v56, s[16:19], s35 offen
    s_add_u32 s35, s35, s36
    buffer_load_dwordx4 v[164:167], v56, s[16:19], s35 offen
    s_add_u32 s35, s35, s36
    buffer_load_dwordx4 v[168:171], v56, s[16:19], s35 offen
    s_add_u32 s35, s35, s36
    buffer_load_dwordx4 v[172:175], v56, s[16:19], s35 offen
    s_add_u32 s35, s35, s36
    buffer_load_dwordx4 v[176:179], v56, s[16:19], s35 offen
    s_add_u32 s35, s35, s36
    buffer_load_dwordx4 v[180:183], v56, s[16:19], s35 offen
    s_add_u32 s35, s35, s36
    buffer_load_dwordx4 v[184:187], v56, s[16:19], s35 offen
    s_add_u32 s35, s35, s36
    buffer_load_dwordx4 v[188:191], v56, s[16:19], s35 offen
    s_add_u32 s35, s35, s36
    buffer_load_dwordx4 v[192:195], v56, s[16:19], s35 offen
    s_add_u32 s35, s35, s36
    buffer_load_dwordx4 v[196:199], v56, s[16:19], s35 offen
    s_add_u32 s35, s35, s36
    buffer_load_dwordx4 v[200:203], v56, s[16:19], s35 offen
    s_add_u32 s35, s35, s36
    buffer_load_dwordx4 v[204:207], v56, s[16:19], s35 offen
    s_branch L_lwf
L_run2:
    s_barrier
    s_mul_i32 s49, s42, 36864
    s_mul_i32 s43, s62, 36864
    s_lshl_b32 s58, s33, 10
    s_mov_b32 s59, 0
    s_mov_b32 s47, 0
    s_mov_b32 s61, 0
    s_mov_b32 s38, 1069066811
    s_mov_b32 s37, 0x358637bd
    s_add_u32 m0, s58, 0
    s_nop 0
    buffer_load_dwordx4 v6, s[12:15], s49 offen lds
    s_add_u32 m0, s58, 4096
    s_nop 0
    buffer_load_dwordx4 v7, s[12:15], s49 offen lds
    s_add_u32 m0, s58, 8192
    s_nop 0
    buffer_load_dwordx4 v8, s[12:15], s49 offen lds
    s_add_u32 m0, s58, 12288
    s_nop 0
    buffer_load_dwordx4 v9, s[12:15], s49 offen lds
    s_add_u32 m0, s58, 16384
    s_nop 0
    buffer_load_dwordx4 v10, s[12:15], s49 offen lds
    s_add_u32 m0, s58, 20480
    s_nop 0
    buffer_load_dwordx4 v11, s[12:15], s49 offen lds
    s_add_u32 m0, s58, 24576
    s_nop 0
    buffer_load_dwordx4 v12, s[12:15], s49 offen lds
    s_add_u32 m0, s58, 28672
    s_nop 0
    buffer_load_dwordx4 v13, s[12:15], s49 offen lds
    s_add_u32 m0, s58, 32768
    s_nop 0
    buffer_load_dwordx4 v14, s[12:15], s49 offen lds
    s_add_u32 s49, s49, s43
    s_add_u32 s58, s58, 36864
    s_add_u32 m0, s58, 0
    s_nop 0
    buffer_load_dwordx4 v6, s[12:15], s49 offen lds
    s_add_u32 m0, s58, 4096
    s_nop 0
    buffer_load_dwordx4 v7, s[12:15], s49 offen lds
    s_add_u32 m0, s58, 8192
    s_nop 0
    buffer_load_dwordx4 v8, s[12:15], s49 offen lds
    s_add_u32 m0, s58, 12288
    s_nop 0
    buffer_load_dwordx4 v9, s[12:15], s49 offen lds
    s_add_u32 m0, s58, 16384
    s_nop 0
    buffer_load_dwordx4 v10, s[12:15], s49 offen lds
    s_add_u32 m0, s58, 20480
    s_nop 0
    buffer_load_dwordx4 v11, s[12:15], s49 offen lds
    s_add_u32 m0, s58, 24576
    s_nop 0
    buffer_load_dwordx4 v12, s[12:15], s49 offen lds
    s_add_u32 m0, s58, 28672
    s_nop 0
    buffer_load_dwordx4 v13, s[12:15], s49 offen lds
    s_add_u32 m0, s58, 32768
    s_nop 0
    buffer_load_dwordx4 v14, s[12:15], s49 offen lds
    s_add_u32 s49, s49, s43
    s_add_u32 s58, s58, 36864
    s_waitcnt vmcnt(9)
L_gBQ_top:
    s_barrier
    v_add_u32 v20, s59, v16
    v_add_u32 v21, s59, v17
    v_add_u32 v22, s59, v18
    v_add_u32 v23, s59, v19
    ds_read_b128 v[24:27], v20 offset:0
    ds_read_b128 v[28:31], v22 offset:0
    ds_read_b128 v[32:35], v21 offset:0
    ds_read_b128 v[36:39], v23 offset:0
    s_cmp_eq_u32 s61, 0
    s_cbranch_scc1 L_gBQ_np
    s_cmp_lg_u32 s33, 0
    s_cbranch_scc1 L_gBQ_np
    s_lshr_b32 s35, s61, 8
    s_and_b32 s36, s61, 0xff
    v_mov_b32 v2, s35
    v_mov_b32 v3, s36
    s_mov_b64 exec, 1
    buffer_atomic_add v3, v2, s[20:23], 0 offen
    s_mov_b64 exec, -1
L_gBQ_np:
    s_mov_b32 s61, 0
    ds_read_b128 v[240:243], v20 offset:128
    ds_read_b128 v[244:247], v22 offset:128
    s_waitcnt lgkmcnt(4)
    v_mfma_f32_16x16x32_bf16 v[40:43], v[64:67], v[24:27], 0
    s_add_u32 m0, s58, 0
    s_nop 0
    buffer_load_dwordx4 v6, s[12:15], s49 offen lds
    v_mfma_f32_16x16x32_bf16 v[44:47], v[68:71], v[24:27], 0
    v_mfma_f32_16x16x32_bf16 v[224:227], a[0:3], v[24:27], 0
    v_mfma_f32_16x16x32_bf16 v[228:231], a[4:7], v[24:27], 0
    v_mfma_f32_16x16x32_bf16 v[48:51], v[64:67], v[28:31], 0
    v_mfma_f32_16x16x32_bf16 v[52:55], v[68:71], v[28:31], 0
    v_mfma_f32_16x16x32_bf16 v[232:235], a[0:3], v[28:31], 0
    v_mfma_f32_16x16x32_bf16 v[236:239], a[4:7], v[28:31], 0
    ds_read_b128 v[248:251], v21 offset:128
    ds_read_b128 v[252:255], v23 offset:128
    s_waitcnt lgkmcnt(4)
    v_mfma_f32_16x16x32_bf16 v[40:43], v[72:75], v[32:35], v[40:43]
    v_mfma_f32_16x16x32_bf16 v[44:47], v[76:79], v[32:35], v[44:47]
    v_mfma_f32_16x16x32_bf16 v[224:227], a[8:11], v[32:35], v[224:227]
    v_mfma_f32_16x16x32_bf16 v[228:231], a[12:15], v[32:35], v[228:231]
    v_mfma_f32_16x16x32_bf16 v[48:51], v[72:75], v[36:39], v[48:51]
    v_mfma_f32_16x16x32_bf16 v[52:55], v[76:79], v[36:39], v[52:55]
    v_mfma_f32_16x16x32_bf16 v[232:235], a[8:11], v[36:39], v[232:235]
    v_mfma_f32_16x16x32_bf16 v[236:239], a[12:15], v[36:39], v[236:239]
    ds_read_b128 v[24:27], v20 offset:256
    ds_read_b128 v[28:31], v22 offset:256
    s_waitcnt lgkmcnt(4)
    v_mfma_f32_16x16x32_bf16 v[40:43], v[80:83], v[240:243], v[40:43]
    s_add_u32 m0, s58, 4096
    s_nop 0
    buffer_load_dwordx4 v7, s[12:15], s49 offen lds
    v_mfma_f32_16x16x32_bf16 v[44:47], v[84:87], v[240:243], v[44:47]
    v_mfma_f32_16x16x32_bf16 v[224:227], a[16:19], v[240:243], v[224:227]
    v_mfma_f32_16x16x32_bf16 v[228:231], a[20:23], v[240:243], v[228:231]
    v_mfma_f32_16x16x32_bf16 v[48:51], v[80:83], v[244:247], v[48:51]
    v_mfma_f32_16x16x32_bf16 v[52:55], v[84:87], v[244:247], v[52:55]
    v_mfma_f32_16x16x32_bf16 v[232:235], a[16:19], v[244:247], v[232:235]
    v_mfma_f32_16x16x32_bf16 v[236:239], a[20:23], v[244:247], v[236:239]
    ds_read_b128 v[32:35], v21 offset:256
    ds_read_b128 v[36:39], v23 offset:256
    s_waitcnt lgkmcnt(4)
    v_mfma_f32_16x16x32_bf16 v[40:43], v[88:91], v[248:251], v[40:43]
    v_mfma_f32_16x16x32_bf16 v[44:47], v[92:95], v[248:251], v[44:47]
    v_mfma_f32_16x16x32_bf16 v[224:227], a[24:27], v[248:251], v[224:227]
    v_mfma_f32_16x16x32_bf16 v[228:231], a[28:31], v[248:251], v[228:231]
    v_mfma_f32_16x16x32_bf16 v[48:51], v[88:91], v[252:255], v[48:51]
    v_mfma_f32_16x16x32_bf16 v[52:55], v[92:95], v[252:255], v[52:55]
    v_mfma_f32_16x16x32_bf16 v[232:235], a[24:27], v[252:255], v[232:235]
    v_mfma_f32_16x16x32_bf16 v[236:239], a[28:31], v[252:255], v[236:239]
    ds_read_b128 v[240:243], v20 offset:384
    ds_read_b128 v[244:247], v22 offset:384
    s_waitcnt lgkmcnt(4)
    v_mfma_f32_16x16x32_bf16 v[40:43], v[96:99], v[24:27], v[40:43]
    s_add_u32 m0, s58, 8192
    s_nop 0
    buffer_load_dwordx4 v8, s[12:15], s49 offen lds
    v_mfma_f32_16x16x32_bf16 v[44:47], v[100:103], v[24:27], v[44:47]
    v_mfma_f32_16x16x32_bf16 v[224:227], a[32:35], v[24:27], v[224:227]
    v_mfma_f32_16x16x32_bf16 v[228:231], a[36:39], v[24:27], v[228:231]
    v_mfma_f32_16x16x32_bf16 v[48:51], v[96:99], v[28:31], v[48:51]
    v_mfma_f32_16x16x32_bf16 v[52:55], v[100:103], v[28:31], v[52:55]
    v_mfma_f32_16x16x32_bf16 v[232:235], a[32:35], v[28:31], v[232:235]
    v_mfma_f32_16x16x32_bf16 v[236:239], a[36:39], v[28:31], v[236:239]
    ds_read_b128 v[248:251], v21 offset:384
    ds_read_b128 v[252:255], v23 offset:384
    s_waitcnt lgkmcnt(4)
    v_mfma_f32_16x16x32_bf16 v[40:43], v[104:107], v[32:35], v[40:43]
    v_mfma_f32_16x16x32_bf16 v[44:47], v[108:111], v[32:35], v[44:47]
    v_mfma_f32_16x16x32_bf16 v[224:227], a[40:43], v[32:35], v[224:227]
    v_mfma_f32_16x16x32_bf16 v[228:231], a[44:47], v[32:35], v[228:231]
    v_mfma_f32_16x16x32_bf16 v[48:51], v[104:107], v[36:39], v[48:51]
    v_mfma_f32_16x16x32_bf16 v[52:55], v[108:111], v[36:39], v[52:55]
    v_mfma_f32_16x16x32_bf16 v[232:235], a[40:43], v[36:39], v[232:235]
    v_mfma_f32_16x16x32_bf16 v[236:239], a[44:47], v[36:39], v[236:239]
    ds_read_b128 v[24:27], v20 offset:512
    ds_read_b128 v[28:31], v22 offset:512
    s_waitcnt lgkmcnt(4)
    v_mfma_f32_16x16x32_bf16 v[40:43], v[112:115], v[240:243], v[40:43]
    s_add_u32 m0, s58, 12288
    s_nop 0
    buffer_load_dwordx4 v9, s[12:15], s49 offen lds
    v_mfma_f32_16x16x32_bf16 v[44:47], v[116:119], v[240:243], v[44:47]
    v_mfma_f32_16x16x32_bf16 v[224:227], a[48:51], v[240:243], v[224:227]
    v_mfma_f32_16x16x32_bf16 v[228:231], a[52:55], v[240:243], v[228:231]
    v_mfma_f32_16x16x32_bf16 v[48:51], v[112:115], v[244:247], v[48:51]
    v_mfma_f32_16x16x32_bf16 v[52:55], v[116:119], v[244:247], v[52:55]
    v_mfma_f32_16x16x32_bf16 v[232:235], a[48:51], v[244:247], v[232:235]
    v_mfma_f32_16x16x32_bf16 v[236:239], a[52:55], v[244:247], v[236:239]
    ds_read_b128 v[32:35], v21 offset:512
    ds_read_b128 v[36:39], v23 offset:512
    s_waitcnt lgkmcnt(4)
    v_mfma_f32_16x16x32_bf16 v[40:43], v[120:123], v[248:251], v[40:43]
    v_mfma_f32_16x16x32_bf16 v[44:47], v[124:127], v[248:251], v[44:47]
    v_mfma_f32_16x16x32_bf16 v[224:227], a[56:59], v[248:251], v[224:227]
    v_mfma_f32_16x16x32_bf16 v[228:231], a[60:63], v[248:251], v[228:231]
    v_mfma_f32_16x16x32_bf16 v[48:51], v[120:123], v[252:255], v[48:51]
    v_mfma_f32_16x16x32_bf16 v[52:55], v[124:127], v[252:255], v[52:55]
    v_mfma_f32_16x16x32_bf16 v[232:235], a[56:59], v[252:255], v[232:235]
    v_mfma_f32_16x16x32_bf16 v[236:239], a[60:63], v[252:255], v[236:239]
    ds_read_b128 v[240:243], v20 offset:640
    ds_read_b128 v[244:247], v22 offset:640
    s_waitcnt lgkmcnt(4)
    v_mfma_f32_16x16x32_bf16 v[40:43], v[128:131], v[24:27], v[40:43]
    s_add_u32 m0, s58, 16384
    s_nop 0
    buffer_load_dwordx4 v10, s[12:15], s49 offen lds
    v_mfma_f32_16x16x32_bf16 v[44:47], v[132:135], v[24:27], v[44:47]
    v_mfma_f32_16x16x32_bf16 v[224:227], a[64:67], v[24:27], v[224:227]
    v_mfma_f32_16x16x32_bf16 v[228:231], a[68:71], v[24:27], v[228:231]
    v_mfma_f32_16x16x32_bf16 v[48:51], v[128:131], v[28:31], v[48:51]
    v_mfma_f32_16x16x32_bf16 v[52:55], v[132:135], v[28:31], v[52:55]
    v_mfma_f32_16x16x32_bf16 v[232:235], a[64:67], v[28:31], v[232:235]
    v_mfma_f32_16x16x32_bf16 v[236:239], a[68:71], v[28:31], v[236:239]
    ds_read_b128 v[248:251], v21 offset:640
    ds_read_b128 v[252:255], v23 offset:640
    s_waitcnt lgkmcnt(4)
    v_mfma_f32_16x16x32_bf16 v[40:43], v[136:139], v[32:35], v[40:43]
    v_mfma_f32_16x16x32_bf16 v[44:47], v[140:143], v[32:35], v[44:47]
    v_mfma_f32_16x16x32_bf16 v[224:227], a[72:75], v[32:35], v[224:227]
    v_mfma_f32_16x16x32_bf16 v[228:231], a[76:79], v[32:35], v[228:231]
    v_mfma_f32_16x16x32_bf16 v[48:51], v[136:139], v[36:39], v[48:51]
    v_mfma_f32_16x16x32_bf16 v[52:55], v[140:143], v[36:39], v[52:55]
    v_mfma_f32_16x16x32_bf16 v[232:235], a[72:75], v[36:39], v[232:235]
    v_mfma_f32_16x16x32_bf16 v[236:239], a[76:79], v[36:39], v[236:239]
    ds_read_b128 v[24:27], v20 offset:768
    ds_read_b128 v[28:31], v22 offset:768
    s_waitcnt lgkmcnt(4)
    v_mfma_f32_16x16x32_bf16 v[40:43], v[144:147], v[240:243], v[40:43]
    s_add_u32 m0, s58, 20480
    s_nop 0
    buffer_load_dwordx4 v11, s[12:15], s49 offen lds
    v_mfma_f32_16x16x32_bf16 v[44:47], v[148:151], v[240:243], v[44:47]
    v_mfma_f32_16x16x32_bf16 v[224:227], a[80:83], v[240:243], v[224:227]
    v_mfma_f32_16x16x32_bf16 v[228:231], a[84:87], v[240:243], v[228:231]
    v_mfma_f32_16x16x32_bf16 v[48:51], v[144:147], v[244:247], v[48:51]
    v_mfma_f32_16x16x32_bf16 v[52:55], v[148:151], v[244:247], v[52:55]
    v_mfma_f32_16x16x32_bf16 v[232:235], a[80:83], v[244:247], v[232:235]
    v_mfma_f32_16x16x32_bf16 v[236:239], a[84:87], v[244:247], v[236:239]
    ds_read_b128 v[32:35], v21 offset:768
    ds_read_b128 v[36:39], v23 offset:768
    s_waitcnt lgkmcnt(4)
    v_mfma_f32_16x16x32_bf16 v[40:43], v[152:155], v[248:251], v[40:43]
    v_mfma_f32_16x16x32_bf16 v[44:47], v[156:159], v[248:251], v[44:47]
    v_mfma_f32_16x16x32_bf16 v[224:227], a[88:91], v[248:251], v[224:227]
    v_mfma_f32_16x16x32_bf16 v[228:231], a[92:95], v[248:251], v[228:231]
    v_mfma_f32_16x16x32_bf16 v[48:51], v[152:155], v[252:255], v[48:51]
    v_mfma_f32_16x16x32_bf16 v[52:55], v[156:159], v[252:255], v[52:55]
    v_mfma_f32_16x16x32_bf16 v[232:235], a[88:91], v[252:255], v[232:235]
    v_mfma_f32_16x16x32_bf16 v[236:239], a[92:95], v[252:255], v[236:239]
    ds_read_b128 v[240:243], v20 offset:896
    ds_read_b128 v[244:247], v22 offset:896
    s_waitcnt lgkmcnt(4)
    v_mfma_f32_16x16x32_bf16 v[40:43], v[160:163], v[24:27], v[40:43]
    s_add_u32 m0, s58, 24576
    s_nop 0
    buffer_load_dwordx4 v12, s[12:15], s49 offen lds
    v_mfma_f32_16x16x32_bf16 v[44:47], v[164:167], v[24:27], v[44:47]
    v_mfma_f32_16x16x32_bf16 v[224:227], a[96:99], v[24:27], v[224:227]
    v_mfma_f32_16x16x32_bf16 v[228:231], a[100:103], v[24:27], v[228:231]
    v_mfma_f32_16x16x32_bf16 v[48:51], v[160:163], v[28:31], v[48:51]
    v_mfma_f32_16x16x32_bf16 v[52:55], v[164:167], v[28:31], v[52:55]
    v_mfma_f32_16x16x32_bf16 v[232:235], a[96:99], v[28:31], v[232:235]
    v_mfma_f32_16x16x32_bf16 v[236:239], a[100:103], v[28:31], v[236:239]
    ds_read_b128 v[248:251], v21 offset:896
    ds_read_b128 v[252:255], v23 offset:896
    s_waitcnt lgkmcnt(4)
    v_mfma_f32_16x16x32_bf16 v[40:43], v[168:171], v[32:35], v[40:43]
    v_mfma_f32_16x16x32_bf16 v[44:47], v[172:175], v[32:35], v[44:47]
    v_mfma_f32_16x16x32_bf16 v[224:227], a[104:107], v[32:35], v[224:227]
    v_mfma_f32_16x16x32_bf16 v[228:231], a[108:111], v[32:35], v[228:231]
    v_mfma_f32_16x16x32_bf16 v[48:51], v[168:171], v[36:39], v[48:51]
    v_mfma_f32_16x16x32_bf16 v[52:55], v[172:175], v[36:39], v[52:55]
    v_mfma_f32_16x16x32_bf16 v[232:235], a[104:107], v[36:39], v[232:235]
    v_mfma_f32_16x16x32_bf16 v[236:239], a[108:111], v[36:39], v[236:239]
    ds_read_b128 v[24:27], v20 offset:1024
    ds_read_b128 v[28:31], v22 offset:1024
    s_waitcnt lgkmcnt(4)
    v_mfma_f32_16x16x32_bf16 v[40:43], v[176:179], v[240:243], v[40:43]
    s_add_u32 m0, s58, 28672
    s_nop 0
    buffer_load_dwordx4 v13, s[12:15], s49 offen lds
    v_mfma_f32_16x16x32_bf16 v[44:47], v[180:183], v[240:243], v[44:47]
    v_mfma_f32_16x16x32_bf16 v[224:227], a[112:115], v[240:243], v[224:227]
    v_mfma_f32_16x16x32_bf16 v[228:231], a[116:119], v[240:243], v[228:231]
    v_mfma_f32_16x16x32_bf16 v[48:51], v[176:179], v[244:247], v[48:51]
    v_mfma_f32_16x16x32_bf16 v[52:55], v[180:183], v[244:247], v[52:55]
    v_mfma_f32_16x16x32_bf16 v[232:235], a[112:115], v[244:247], v[232:235]
    v_mfma_f32_16x16x32_bf16 v[236:239], a[116:119], v[244:247], v[236:239]
    ds_read_b128 v[32:35], v21 offset:1024
    ds_read_b128 v[36:39], v23 offset:1024
    s_waitcnt lgkmcnt(4)
    v_mfma_f32_16x16x32_bf16 v[40:43], v[184:187], v[248:251], v[40:43]
    v_mfma_f32_16x16x32_bf16 v[44:47], v[188:191], v[248:251], v[44:47]
    v_mfma_f32_16x16x32_bf16 v[224:227], a[120:123], v[248:251], v[224:227]
    v_mfma_f32_16x16x32_bf16 v[228:231], a[124:127], v[248:251], v[228:231]
    v_mfma_f32_16x16x32_bf16 v[48:51], v[184:187], v[252:255], v[48:51]
    v_mfma_f32_16x16x32_bf16 v[52:55], v[188:191], v[252:255], v[52:55]
    v_mfma_f32_16x16x32_bf16 v[232:235], a[120:123], v[252:255], v[232:235]
    v_mfma_f32_16x16x32_bf16 v[236:239], a[124:127], v[252:255], v[236:239]
    s_waitcnt lgkmcnt(2)
    v_mfma_f32_16x16x32_bf16 v[40:43], v[192:195], v[24:27], v[40:43]
    s_add_u32 m0, s58, 32768
    s_nop 0
    buffer_load_dwordx4 v14, s[12:15], s49 offen lds
    v_mfma_f32_16x16x32_bf16 v[44:47], v[196:199], v[24:27], v[44:47]
    v_mfma_f32_16x16x32_bf16 v[224:227], a[128:131], v[24:27], v[224:227]
    v_mfma_f32_16x16x32_bf16 v[228:231], a[132:135], v[24:27], v[228:231]
    v_mfma_f32_16x16x32_bf16 v[48:51], v[192:195], v[28:31], v[48:51]
    v_mfma_f32_16x16x32_bf16 v[52:55], v[196:199], v[28:31], v[52:55]
    v_mfma_f32_16x16x32_bf16 v[232:235], a[128:131], v[28:31], v[232:235]
    v_mfma_f32_16x16x32_bf16 v[236:239], a[132:135], v[28:31], v[236:239]
    s_waitcnt lgkmcnt(0)
    v_mfma_f32_16x16x32_bf16 v[40:43], v[200:203], v[32:35], v[40:43]
    v_mfma_f32_16x16x32_bf16 v[44:47], v[204:207], v[32:35], v[44:47]
    v_mfma_f32_16x16x32_bf16 v[224:227], a[136:139], v[32:35], v[224:227]
    v_mfma_f32_16x16x32_bf16 v[228:231], a[140:143], v[32:35], v[228:231]
    v_mfma_f32_16x16x32_bf16 v[48:51], v[200:203], v[36:39], v[48:51]
    v_mfma_f32_16x16x32_bf16 v[52:55], v[204:207], v[36:39], v[52:55]
    v_mfma_f32_16x16x32_bf16 v[232:235], a[136:139], v[36:39], v[232:235]
    v_mfma_f32_16x16x32_bf16 v[236:239], a[140:143], v[36:39], v[236:239]
    s_add_u32 s49, s49, s43
    s_add_u32 s58, s58, 36864
    s_sub_u32 s35, s58, 110592
    s_cmp_ge_u32 s58, 110592
    s_cselect_b32 s58, s35, s58
    s_add_u32 s59, s59, 36864
    s_cmp_ge_u32 s59, 110592
    s_cselect_b32 s59, 0, s59
    s_lshr_b32 s35, s42, 6
    s_cmp_eq_u32 s35, s52
    s_cbranch_scc1 L_gBQ_same
    s_add_u32 s36, s52, s48
    s_lshl_b32 s36, s36, 10
    s_or_b32 s61, s36, s47
    s_cmp_eq_u32 s47, 0
    s_cselect_b32 s61, 0, s61
    s_mov_b32 s47, 0
    s_mov_b32 s52, s35
L_gBQ_same:
    s_add_u32 s47, s47, 1
    v_cvt_pk_bf16_f32 v2, v40, v44
    v_lshlrev_b32 v40, 16, v2
    v_and_b32 v44, 0xffff0000, v2
    v_mul_f32 v2, s38, v40
    v_mul_f32 v3, s38, v44
    v_exp_f32 v2, v2
    v_exp_f32 v3, v3
    v_cmp_lt_f32 vcc, 0, v40
    v_add_f32 v40, 1.0, v40
    s_nop 0
    v_cndmask_b32 v40, v2, v40, vcc
    v_cmp_lt_f32 vcc, 0, v44
    v_add_f32 v44, 1.0, v44
    s_nop 0
    v_cndmask_b32 v44, v3, v44, vcc
    v_add_f32 v40, s37, v40
    v_add_f32 v44, s37, v44
    v_cvt_pk_bf16_f32 v208, v40, v44
    v_cvt_pk_bf16_f32 v2, v41, v45
    v_lshlrev_b32 v41, 16, v2
    v_and_b32 v45, 0xffff0000, v2
    v_mul_f32 v2, s38, v41
    v_mul_f32 v3, s38, v45
    v_exp_f32 v2, v2
    v_exp_f32 v3, v3
    v_cmp_lt_f32 vcc, 0, v41
    v_add_f32 v41, 1.0, v41
    s_nop 0
    v_cndmask_b32 v41, v2, v41, vcc
    v_cmp_lt_f32 vcc, 0, v45
    v_add_f32 v45, 1.0, v45
    s_nop 0
    v_cndmask_b32 v45, v3, v45, vcc
    v_add_f32 v41, s37, v41
    v_add_f32 v45, s37, v45
    v_cvt_pk_bf16_f32 v209, v41, v45
    v_cvt_pk_bf16_f32 v2, v42, v46
    v_lshlrev_b32 v42, 16, v2
    v_and_b32 v46, 0xffff0000, v2
    v_mul_f32 v2, s38, v42
    v_mul_f32 v3, s38, v46
    v_exp_f32 v2, v2
    v_exp_f32 v3, v3
    v_cmp_lt_f32 vcc, 0, v42
    v_add_f32 v42, 1.0, v42
    s_nop 0
    v_cndmask_b32 v42, v2, v42, vcc
    v_cmp_lt_f32 vcc, 0, v46
    v_add_f32 v46, 1.0, v46
    s_nop 0
    v_cndmask_b32 v46, v3, v46, vcc
    v_add_f32 v42, s37, v42
    v_add_f32 v46, s37, v46
    v_cvt_pk_bf16_f32 v210, v42, v46
    v_cvt_pk_bf16_f32 v2, v43, v47
    v_lshlrev_b32 v43, 16, v2
    v_and_b32 v47, 0xffff0000, v2
    v_mul_f32 v2, s38, v43
    v_mul_f32 v3, s38, v47
    v_exp_f32 v2, v2
    v_exp_f32 v3, v3
    v_cmp_lt_f32 vcc, 0, v43
    v_add_f32 v43, 1.0, v43
    s_nop 0
    v_cndmask_b32 v43, v2, v43, vcc
    v_cmp_lt_f32 vcc, 0, v47
    v_add_f32 v47, 1.0, v47
    s_nop 0
    v_cndmask_b32 v47, v3, v47, vcc
    v_add_f32 v43, s37, v43
    v_add_f32 v47, s37, v47
    v_cvt_pk_bf16_f32 v211, v43, v47
    buffer_store_dwordx4 v[208:211], v0, s[8:11], s44 offen offset:0 sc1
    v_cvt_pk_bf16_f32 v2, v48, v52
    v_lshlrev_b32 v48, 16, v2
    v_and_b32 v52, 0xffff0000, v2
    v_mul_f32 v2, s38, v48
    v_mul_f32 v3, s38, v52
    v_exp_f32 v2, v2
    v_exp_f32 v3, v3
    v_cmp_lt_f32 vcc, 0, v48
    v_add_f32 v48, 1.0, v48
    s_nop 0
    v_cndmask_b32 v48, v2, v48, vcc
    v_cmp_lt_f32 vcc, 0, v52
    v_add_f32 v52, 1.0, v52
    s_nop 0
    v_cndmask_b32 v52, v3, v52, vcc
    v_add_f32 v48, s37, v48
    v_add_f32 v52, s37, v52
    v_cvt_pk_bf16_f32 v212, v48, v52
    v_cvt_pk_bf16_f32 v2, v49, v53
    v_lshlrev_b32 v49, 16, v2
    v_and_b32 v53, 0xffff0000, v2
    v_mul_f32 v2, s38, v49
    v_mul_f32 v3, s38, v53
    v_exp_f32 v2, v2
    v_exp_f32 v3, v3
    v_cmp_lt_f32 vcc, 0, v49
    v_add_f32 v49, 1.0, v49
    s_nop 0
    v_cndmask_b32 v49, v2, v49, vcc
    v_cmp_lt_f32 vcc, 0, v53
    v_add_f32 v53, 1.0, v53
    s_nop 0
    v_cndmask_b32 v53, v3, v53, vcc
    v_add_f32 v49, s37, v49
    v_add_f32 v53, s37, v53
    v_cvt_pk_bf16_f32 v213, v49, v53
    v_cvt_pk_bf16_f32 v2, v50, v54
    v_lshlrev_b32 v50, 16, v2
    v_and_b32 v54, 0xffff0000, v2
    v_mul_f32 v2, s38, v50
    v_mul_f32 v3, s38, v54
    v_exp_f32 v2, v2
    v_exp_f32 v3, v3
    v_cmp_lt_f32 vcc, 0, v50
    v_add_f32 v50, 1.0, v50
    s_nop 0
    v_cndmask_b32 v50, v2, v50, vcc
    v_cmp_lt_f32 vcc, 0, v54
    v_add_f32 v54, 1.0, v54
    s_nop 0
    v_cndmask_b32 v54, v3, v54, vcc
    v_add_f32 v50, s37, v50
    v_add_f32 v54, s37, v54
    v_cvt_pk_bf16_f32 v214, v50, v54
    v_cvt_pk_bf16_f32 v2, v51, v55
    v_lshlrev_b32 v51, 16, v2
    v_and_b32 v55, 0xffff0000, v2
    v_mul_f32 v2, s38, v51
    v_mul_f32 v3, s38, v55
    v_exp_f32 v2, v2
    v_exp_f32 v3, v3
    v_cmp_lt_f32 vcc, 0, v51
    v_add_f32 v51, 1.0, v51
    s_nop 0
    v_cndmask_b32 v51, v2, v51, vcc
    v_cmp_lt_f32 vcc, 0, v55
    v_add_f32 v55, 1.0, v55
    s_nop 0
    v_cndmask_b32 v55, v3, v55, vcc
    v_add_f32 v51, s37, v51
    v_add_f32 v55, s37, v55
    v_cvt_pk_bf16_f32 v215, v51, v55
    buffer_store_dwordx4 v[212:215], v0, s[8:11], s44 offen offset:1024 sc1
    v_cvt_pk_bf16_f32 v2, v224, v228
    v_lshlrev_b32 v224, 16, v2
    v_and_b32 v228, 0xffff0000, v2
    v_mul_f32 v2, s38, v224
    v_mul_f32 v3, s38, v228
    v_exp_f32 v2, v2
    v_exp_f32 v3, v3
    v_cmp_lt_f32 vcc, 0, v224
    v_add_f32 v224, 1.0, v224
    s_nop 0
    v_cndmask_b32 v224, v2, v224, vcc
    v_cmp_lt_f32 vcc, 0, v228
    v_add_f32 v228, 1.0, v228
    s_nop 0
    v_cndmask_b32 v228, v3, v228, vcc
    v_add_f32 v224, s37, v224
    v_add_f32 v228, s37, v228
    v_cvt_pk_bf16_f32 v216, v224, v228
    v_cvt_pk_bf16_f32 v2, v225, v229
    v_lshlrev_b32 v225, 16, v2
    v_and_b32 v229, 0xffff0000, v2
    v_mul_f32 v2, s38, v225
    v_mul_f32 v3, s38, v229
    v_exp_f32 v2, v2
    v_exp_f32 v3, v3
    v_cmp_lt_f32 vcc, 0, v225
    v_add_f32 v225, 1.0, v225
    s_nop 0
    v_cndmask_b32 v225, v2, v225, vcc
    v_cmp_lt_f32 vcc, 0, v229
    v_add_f32 v229, 1.0, v229
    s_nop 0
    v_cndmask_b32 v229, v3, v229, vcc
    v_add_f32 v225, s37, v225
    v_add_f32 v229, s37, v229
    v_cvt_pk_bf16_f32 v217, v225, v229
    v_cvt_pk_bf16_f32 v2, v226, v230
    v_lshlrev_b32 v226, 16, v2
    v_and_b32 v230, 0xffff0000, v2
    v_mul_f32 v2, s38, v226
    v_mul_f32 v3, s38, v230
    v_exp_f32 v2, v2
    v_exp_f32 v3, v3
    v_cmp_lt_f32 vcc, 0, v226
    v_add_f32 v226, 1.0, v226
    s_nop 0
    v_cndmask_b32 v226, v2, v226, vcc
    v_cmp_lt_f32 vcc, 0, v230
    v_add_f32 v230, 1.0, v230
    s_nop 0
    v_cndmask_b32 v230, v3, v230, vcc
    v_add_f32 v226, s37, v226
    v_add_f32 v230, s37, v230
    v_cvt_pk_bf16_f32 v218, v226, v230
    v_cvt_pk_bf16_f32 v2, v227, v231
    v_lshlrev_b32 v227, 16, v2
    v_and_b32 v231, 0xffff0000, v2
    v_mul_f32 v2, s38, v227
    v_mul_f32 v3, s38, v231
    v_exp_f32 v2, v2
    v_exp_f32 v3, v3
    v_cmp_lt_f32 vcc, 0, v227
    v_add_f32 v227, 1.0, v227
    s_nop 0
    v_cndmask_b32 v227, v2, v227, vcc
    v_cmp_lt_f32 vcc, 0, v231
    v_add_f32 v231, 1.0, v231
    s_nop 0
    v_cndmask_b32 v231, v3, v231, vcc
    v_add_f32 v227, s37, v227
    v_add_f32 v231, s37, v231
    v_cvt_pk_bf16_f32 v219, v227, v231
    buffer_store_dwordx4 v[216:219], v0, s[8:11], s60 offen offset:0 sc1
    v_cvt_pk_bf16_f32 v2, v232, v236
    v_lshlrev_b32 v232, 16, v2
    v_and_b32 v236, 0xffff0000, v2
    v_mul_f32 v2, s38, v232
    v_mul_f32 v3, s38, v236
    v_exp_f32 v2, v2
    v_exp_f32 v3, v3
    v_cmp_lt_f32 vcc, 0, v232
    v_add_f32 v232, 1.0, v232
    s_nop 0
    v_cndmask_b32 v232, v2, v232, vcc
    v_cmp_lt_f32 vcc, 0, v236
    v_add_f32 v236, 1.0, v236
    s_nop 0
    v_cndmask_b32 v236, v3, v236, vcc
    v_add_f32 v232, s37, v232
    v_add_f32 v236, s37, v236
    v_cvt_pk_bf16_f32 v220, v232, v236
    v_cvt_pk_bf16_f32 v2, v233, v237
    v_lshlrev_b32 v233, 16, v2
    v_and_b32 v237, 0xffff0000, v2
    v_mul_f32 v2, s38, v233
    v_mul_f32 v3, s38, v237
    v_exp_f32 v2, v2
    v_exp_f32 v3, v3
    v_cmp_lt_f32 vcc, 0, v233
    v_add_f32 v233, 1.0, v233
    s_nop 0
    v_cndmask_b32 v233, v2, v233, vcc
    v_cmp_lt_f32 vcc, 0, v237
    v_add_f32 v237, 1.0, v237
    s_nop 0
    v_cndmask_b32 v237, v3, v237, vcc
    v_add_f32 v233, s37, v233
    v_add_f32 v237, s37, v237
    v_cvt_pk_bf16_f32 v221, v233, v237
    v_cvt_pk_bf16_f32 v2, v234, v238
    v_lshlrev_b32 v234, 16, v2
    v_and_b32 v238, 0xffff0000, v2
    v_mul_f32 v2, s38, v234
    v_mul_f32 v3, s38, v238
    v_exp_f32 v2, v2
    v_exp_f32 v3, v3
    v_cmp_lt_f32 vcc, 0, v234
    v_add_f32 v234, 1.0, v234
    s_nop 0
    v_cndmask_b32 v234, v2, v234, vcc
    v_cmp_lt_f32 vcc, 0, v238
    v_add_f32 v238, 1.0, v238
    s_nop 0
    v_cndmask_b32 v238, v3, v238, vcc
    v_add_f32 v234, s37, v234
    v_add_f32 v238, s37, v238
    v_cvt_pk_bf16_f32 v222, v234, v238
    v_cvt_pk_bf16_f32 v2, v235, v239
    v_lshlrev_b32 v235, 16, v2
    v_and_b32 v239, 0xffff0000, v2
    v_mul_f32 v2, s38, v235
    v_mul_f32 v3, s38, v239
    v_exp_f32 v2, v2
    v_exp_f32 v3, v3
    v_cmp_lt_f32 vcc, 0, v235
    v_add_f32 v235, 1.0, v235
    s_nop 0
    v_cndmask_b32 v235, v2, v235, vcc
    v_cmp_lt_f32 vcc, 0, v239
    v_add_f32 v239, 1.0, v239
    s_nop 0
    v_cndmask_b32 v239, v3, v239, vcc
    v_add_f32 v235, s37, v235
    v_add_f32 v239, s37, v239
    v_cvt_pk_bf16_f32 v223, v235, v239
    buffer_store_dwordx4 v[220:223], v0, s[8:11], s60 offen offset:1024 sc1
    s_add_u32 s44, s44, s55
    s_add_u32 s60, s60, s55
    s_add_u32 s42, s42, s62
    s_waitcnt vmcnt(13)
    s_cmp_lt_u32 s42, 64
    s_cbranch_scc1 L_gBQ_top
    s_lshr_b32 s35, s61, 8
    s_and_b32 s36, s61, 0xff
    s_waitcnt vmcnt(0)
    s_barrier
    s_cmp_lg_u32 s33, 0
    s_cbranch_scc1 L_sigBQa
    v_mov_b32 v2, s35
    v_mov_b32 v3, s36
    s_mov_b64 exec, 1
    buffer_atomic_add v3, v2, s[20:23], 0 offen
    s_mov_b64 exec, -1
L_sigBQa:
    s_add_u32 s35, s52, s48
    s_lshl_b32 s35, s35, 2
    s_waitcnt vmcnt(0)
    s_barrier
    s_cmp_lg_u32 s33, 0
    s_cbranch_scc1 L_sigBQb
    v_mov_b32 v2, s35
    v_mov_b32 v3, s47
    s_mov_b64 exec, 1
    buffer_atomic_add v3, v2, s[20:23], 0 offen
    s_mov_b64 exec, -1
L_sigBQb:
    s_branch L_gemm_done
L_bkv:
    s_sub_u32 s36, s34, 192
    s_lshr_b32 s32, s36, 2
    s_lshl_b32 s32, s32, 2
    s_add_u32 s32, s32, s33
    s_lshl_b32 s44, s42, 17
    s_lshl_b32 s35, s32, 12
    s_add_u32 s44, s44, s35
    s_add_u32 s44, s44, 68157440
    s_mul_i32 s46, s32, 36
    s_add_u32 s46, s46, 2304
    s_mov_b32 s35, s46
    s_lshl_b32 s36, s45, 4
    buffer_load_dwordx4 a[0:3], v56, s[16:19], s35 offen
    s_add_u32 s35, s35, s36
    buffer_load_dwordx4 a[4:7], v56, s[16:19], s35 offen
    s_add_u32 s35, s35, s36
    buffer_load_dwordx4 a[8:11], v56, s[16:19], s35 offen
    s_add_u32 s35, s35, s36
    buffer_load_dwordx4 a[12:15], v56, s[16:19], s35 offen
    s_add_u32 s35, s35, s36
    buffer_load_dwordx4 a[16:19], v56, s[16:19], s35 offen
    s_add_u32 s35, s35, s36
    buffer_load_dwordx4 a[20:23], v56, s[16:19], s35 offen
    s_add_u32 s35, s35, s36
    buffer_load_dwordx4 a[24:27], v56, s[16:19], s35 offen
    s_add_u32 s35, s35, s36
    buffer_load_dwordx4 a[28:31], v56, s[16:19], s35 offen
    s_add_u32 s35, s35, s36
    buffer_load_dwordx4 a[32:35], v56, s[16:19], s35 offen
    s_add_u32 s35, s35, s36
    buffer_load_dwordx4 a[36:39], v56, s[16:19], s35 offen
    s_add_u32 s35, s35, s36
    buffer_load_dwordx4 a[40:43], v56, s[16:19], s35 offen
    s_add_u32 s35, s35, s36
    buffer_load_dwordx4 a[44:47], v56, s[16:19], s35 offen
    s_add_u32 s35, s35, s36
    buffer_load_dwordx4 a[48:51], v56, s[16:19], s35 offen
    s_add_u32 s35, s35, s36
    buffer_load_dwordx4 a[52:55], v56, s[16:19], s35 offen
    s_add_u32 s35, s35, s36
    buffer_load_dwordx4 a[56:59], v56, s[16:19], s35 offen
    s_add_u32 s35, s35, s36
    buffer_load_dwordx4 a[60:63], v56, s[16:19], s35 offen
    s_add_u32 s35, s35, s36
    buffer_load_dwordx4 a[64:67], v56, s[16:19], s35 offen
    s_add_u32 s35, s35, s36
    buffer_load_dwordx4 a[68:71], v56, s[16:19], s35 offen
    s_add_u32 s35, s35, s36
    buffer_load_dwordx4 a[72:75], v56, s[16:19], s35 offen
    s_add_u32 s35, s35, s36
    buffer_load_dwordx4 a[76:79], v56, s[16:19], s35 offen
    s_add_u32 s35, s35, s36
    buffer_load_dwordx4 a[80:83], v56, s[16:19], s35 offen
    s_add_u32 s35, s35, s36
    buffer_load_dwordx4 a[84:87], v56, s[16:19], s35 offen
    s_add_u32 s35, s35, s36
    buffer_load_dwordx4 a[88:91], v56, s[16:19], s35 offen
    s_add_u32 s35, s35, s36
    buffer_load_dwordx4 a[92:95], v56, s[16:19], s35 offen
    s_add_u32 s35, s35, s36
    buffer_load_dwordx4 a[96:99], v56, s[16:19], s35 offen
    s_add_u32 s35, s35, s36
    buffer_load_dwordx4 a[100:103], v56, s[16:19], s35 offen
    s_add_u32 s35, s35, s36
    buffer_load_dwordx4 a[104:107], v56, s[16:19], s35 offen
    s_add_u32 s35, s35, s36
    buffer_load_dwordx4 a[108:111], v56, s[16:19], s35 offen
    s_add_u32 s35, s35, s36
    buffer_load_dwordx4 a[112:115], v56, s[16:19], s35 offen
    s_add_u32 s35, s35, s36
    buffer_load_dwordx4 a[116:119], v56, s[16:19], s35 offen
    s_add_u32 s35, s35, s36
    buffer_load_dwordx4 a[120:123], v56, s[16:19], s35 offen
    s_add_u32 s35, s35, s36
    buffer_load_dwordx4 a[124:127], v56, s[16:19], s35 offen
    s_add_u32 s35, s35, s36
    buffer_load_dwordx4 a[128:131], v56, s[16:19], s35 offen
    s_add_u32 s35, s35, s36
    buffer_load_dwordx4 a[132:135], v56, s[16:19], s35 offen
    s_add_u32 s35, s35, s36
    buffer_load_dwordx4 a[136:139], v56, s[16:19], s35 offen
    s_add_u32 s35, s35, s36
    buffer_load_dwordx4 a[140:143], v56, s[16:19], s35 offen
    s_sub_u32 s46, s46, 1152
    s_mov_b32 s53, 3
    s_mov_b32 s35, s46
    s_lshl_b32 s36, s45, 4
    buffer_load_dwordx4 v[64:67], v56, s[16:19], s35 offen
    s_add_u32 s35, s35, s36
    buffer_load_dwordx4 v[68:71], v56, s[16:19], s35 offen
    s_add_u32 s35, s35, s36
    buffer_load_dwordx4 v[72:75], v56, s[16:19], s35 offen
    s_add_u32 s35, s35, s36
    buffer_load_dwordx4 v[76:79], v56, s[16:19], s35 offen
    s_add_u32 s35, s35, s36
    buffer_load_dwordx4 v[80:83], v56, s[16:19], s35 offen
    s_add_u32 s35, s35, s36
    buffer_load_dwordx4 v[84:87], v56, s[16:19], s35 offen
    s_add_u32 s35, s35, s36
    buffer_load_dwordx4 v[88:91], v56, s[16:19], s35 offen
    s_add_u32 s35, s35, s36
    buffer_load_dwordx4 v[92:95], v56, s[16:19], s35 offen
    s_add_u32 s35, s35, s36
    buffer_load_dwordx4 v[96:99], v56, s[16:19], s35 offen
    s_add_u32 s35, s35, s36
    buffer_load_dwordx4 v[100:103], v56, s[16:19], s35 offen
    s_add_u32 s35, s35, s36
    buffer_load_dwordx4 v[104:107], v56, s[16:19], s35 offen
    s_add_u32 s35, s35, s36
    buffer_load_dwordx4 v[108:111], v56, s[16:19], s35 offen
    s_add_u32 s35, s35, s36
    buffer_load_dwordx4 v[112:115], v56, s[16:19], s35 offen
    s_add_u32 s35, s35, s36
    buffer_load_dwordx4 v[116:119], v56, s[16:19], s35 offen
    s_add_u32 s35, s35, s36
    buffer_load_dwordx4 v[120:123], v56, s[16:19], s35 offen
    s_add_u32 s35, s35, s36
    buffer_load_dwordx4 v[124:127], v56, s[16:19], s35 offen
    s_add_u32 s35, s35, s36
    buffer_load_dwordx4 v[128:131], v56, s[16:19], s35 offen
    s_add_u32 s35, s35, s36
    buffer_load_dwordx4 v[132:135], v56, s[16:19], s35 offen
    s_add_u32 s35, s35, s36
    buffer_load_dwordx4 v[136:139], v56, s[16:19], s35 offen
    s_add_u32 s35, s35, s36
    buffer_load_dwordx4 v[140:143], v56, s[16:19], s35 offen
    s_add_u32 s35, s35, s36
    buffer_load_dwordx4 v[144:147], v56, s[16:19], s35 offen
    s_add_u32 s35, s35, s36
    buffer_load_dwordx4 v[148:151], v56, s[16:19], s35 offen
    s_add_u32 s35, s35, s36
    buffer_load_dwordx4 v[152:155], v56, s[16:19], s35 offen
    s_add_u32 s35, s35, s36
    buffer_load_dwordx4 v[156:159], v56, s[16:19], s35 offen
    s_add_u32 s35, s35, s36
    buffer_load_dwordx4 v[160:163], v56, s[16:19], s35 offen
    s_add_u32 s35, s35, s36
    buffer_load_dwordx4 v[164:167], v56, s[16:19], s35 offen
    s_add_u32 s35, s35, s36
    buffer_load_dwordx4 v[168:171], v56, s[16:19], s35 offen
    s_add_u32 s35, s35, s36
    buffer_load_dwordx4 v[172:175], v56, s[16:19], s35 offen
    s_add_u32 s35, s35, s36
    buffer_load_dwordx4 v[176:179], v56, s[16:19], s35 offen
    s_add_u32 s35, s35, s36
    buffer_load_dwordx4 v[180:183], v56, s[16:19], s35 offen
    s_add_u32 s35, s35, s36
    buffer_load_dwordx4 v[184:187], v56, s[16:19], s35 offen
    s_add_u32 s35, s35, s36
    buffer_load_dwordx4 v[188:191], v56, s[16:19], s35 offen
    s_add_u32 s35, s35, s36
    buffer_load_dwordx4 v[192:195], v56, s[16:19], s35 offen
    s_add_u32 s35, s35, s36
    buffer_load_dwordx4 v[196:199], v56, s[16:19], s35 offen
    s_add_u32 s35, s35, s36
    buffer_load_dwordx4 v[200:203], v56, s[16:19], s35 offen
    s_add_u32 s35, s35, s36
    buffer_load_dwordx4 v[204:207], v56, s[16:19], s35 offen
    s_nop 0
L_lwf:
    s_waitcnt vmcnt(63)
    ds_write_b128 v57, a[0:3] offset:0
    ds_write_b128 v57, a[4:7] offset:1024
    ds_write_b128 v57, a[8:11] offset:2048
    ds_write_b128 v57, a[12:15] offset:3072
    ds_read_b32 v208, v58 offset:0
    ds_read_b32 v209, v58 offset:64
    ds_read_b32 v210, v58 offset:128
    ds_read_b32 v211, v58 offset:192
    ds_read_b32 v212, v58 offset:256
    ds_read_b32 v213, v58 offset:320
    ds_read_b32 v214, v58 offset:384
    ds_read_b32 v215, v58 offset:448
    ds_read_b32 v216, v58 offset:2048
    ds_read_b32 v217, v58 offset:2112
    ds_read_b32 v218, v58 offset:2176
    ds_read_b32 v219, v58 offset:2240
    ds_read_b32 v220, v58 offset:2304
    ds_read_b32 v221, v58 offset:2368
    ds_read_b32 v222, v58 offset:2432
    ds_read_b32 v223, v58 offset:2496
    s_waitcnt lgkmcnt(0)
    v_perm_b32 v24, v209, v208, s40
    v_accvgpr_write_b32 a0, v24
    v_perm_b32 v25, v211, v210, s40
    v_accvgpr_write_b32 a1, v25
    v_perm_b32 v26, v213, v212, s40
    v_accvgpr_write_b32 a2, v26
    v_perm_b32 v27, v215, v214, s40
    v_accvgpr_write_b32 a3, v27
    v_perm_b32 v28, v209, v208, s41
    v_accvgpr_write_b32 a4, v28
    v_perm_b32 v29, v211, v210, s41
    v_accvgpr_write_b32 a5, v29
    v_perm_b32 v30, v213, v212, s41
    v_accvgpr_write_b32 a6, v30
    v_perm_b32 v31, v215, v214, s41
    v_accvgpr_write_b32 a7, v31
    v_perm_b32 v24, v217, v216, s40
    v_accvgpr_write_b32 a8, v24
    v_perm_b32 v25, v219, v218, s40
    v_accvgpr_write_b32 a9, v25
    v_perm_b32 v26, v221, v220, s40
    v_accvgpr_write_b32 a10, v26
    v_perm_b32 v27, v223, v222, s40
    v_accvgpr_write_b32 a11, v27
    v_perm_b32 v28, v217, v216, s41
    v_accvgpr_write_b32 a12, v28
    v_perm_b32 v29, v219, v218, s41
    v_accvgpr_write_b32 a13, v29
    v_perm_b32 v30, v221, v220, s41
    v_accvgpr_write_b32 a14, v30
    v_perm_b32 v31, v223, v222, s41
    v_accvgpr_write_b32 a15, v31
    s_waitcnt vmcnt(63)
    ds_write_b128 v57, a[16:19] offset:0
    ds_write_b128 v57, a[20:23] offset:1024
    ds_write_b128 v57, a[24:27] offset:2048
    ds_write_b128 v57, a[28:31] offset:3072
    ds_read_b32 v208, v58 offset:0
    ds_read_b32 v209, v58 offset:64
    ds_read_b32 v210, v58 offset:128
    ds_read_b32 v211, v58 offset:192
    ds_read_b32 v212, v58 offset:256
    ds_read_b32 v213, v58 offset:320
    ds_read_b32 v214, v58 offset:384
    ds_read_b32 v215, v58 offset:448
    ds_read_b32 v216, v58 offset:2048
    ds_read_b32 v217, v58 offset:2112
    ds_read_b32 v218, v58 offset:2176
    ds_read_b32 v219, v58 offset:2240
    ds_read_b32 v220, v58 offset:2304
    ds_read_b32 v221, v58 offset:2368
    ds_read_b32 v222, v58 offset:2432
    ds_read_b32 v223, v58 offset:2496
    s_waitcnt lgkmcnt(0)
    v_perm_b32 v24, v209, v208, s40
    v_accvgpr_write_b32 a16, v24
    v_perm_b32 v25, v211, v210, s40
    v_accvgpr_write_b32 a17, v25
    v_perm_b32 v26, v213, v212, s40
    v_accvgpr_write_b32 a18, v26
    v_perm_b32 v27, v215, v214, s40
    v_accvgpr_write_b32 a19, v27
    v_perm_b32 v28, v209, v208, s41
    v_accvgpr_write_b32 a20, v28
    v_perm_b32 v29, v211, v210, s41
    v_accvgpr_write_b32 a21, v29
    v_perm_b32 v30, v213, v212, s41
    v_accvgpr_write_b32 a22, v30
    v_perm_b32 v31, v215, v214, s41
    v_accvgpr_write_b32 a23, v31
    v_perm_b32 v24, v217, v216, s40
    v_accvgpr_write_b32 a24, v24
    v_perm_b32 v25, v219, v218, s40
    v_accvgpr_write_b32 a25, v25
    v_perm_b32 v26, v221, v220, s40
    v_accvgpr_write_b32 a26, v26
    v_perm_b32 v27, v223, v222, s40
    v_accvgpr_write_b32 a27, v27
    v_perm_b32 v28, v217, v216, s41
    v_accvgpr_write_b32 a28, v28
    v_perm_b32 v29, v219, v218, s41
    v_accvgpr_write_b32 a29, v29
    v_perm_b32 v30, v221, v220, s41
    v_accvgpr_write_b32 a30, v30
    v_perm_b32 v31, v223, v222, s41
    v_accvgpr_write_b32 a31, v31
    s_waitcnt vmcnt(60)
    ds_write_b128 v57, a[32:35] offset:0
    ds_write_b128 v57, a[36:39] offset:1024
    ds_write_b128 v57, a[40:43] offset:2048
    ds_write_b128 v57, a[44:47] offset:3072
    ds_read_b32 v208, v58 offset:0
    ds_read_b32 v209, v58 offset:64
    ds_read_b32 v210, v58 offset:128
    ds_read_b32 v211, v58 offset:192
    ds_read_b32 v212, v58 offset:256
    ds_read_b32 v213, v58 offset:320
    ds_read_b32 v214, v58 offset:384
    ds_read_b32 v215, v58 offset:448
    ds_read_b32 v216, v58 offset:2048
    ds_read_b32 v217, v58 offset:2112
    ds_read_b32 v218, v58 offset:2176
    ds_read_b32 v219, v58 offset:2240
    ds_read_b32 v220, v58 offset:2304
    ds_read_b32 v221, v58 offset:2368
    ds_read_b32 v222, v58 offset:2432
    ds_read_b32 v223, v58 offset:2496
    s_waitcnt lgkmcnt(0)
    v_perm_b32 v24, v209, v208, s40
    v_accvgpr_write_b32 a32, v24
    v_perm_b32 v25, v211, v210, s40
    v_accvgpr_write_b32 a33, v25
    v_perm_b32 v26, v213, v212, s40
    v_accvgpr_write_b32 a34, v26
    v_perm_b32 v27, v215, v214, s40
    v_accvgpr_write_b32 a35, v27
    v_perm_b32 v28, v209, v208, s41
    v_accvgpr_write_b32 a36, v28
    v_perm_b32 v29, v211, v210, s41
    v_accvgpr_write_b32 a37, v29
    v_perm_b32 v30, v213, v212, s41
    v_accvgpr_write_b32 a38, v30
    v_perm_b32 v31, v215, v214, s41
    v_accvgpr_write_b32 a39, v31
    v_perm_b32 v24, v217, v216, s40
    v_accvgpr_write_b32 a40, v24
    v_perm_b32 v25, v219, v218, s40
    v_accvgpr_write_b32 a41, v25
    v_perm_b32 v26, v221, v220, s40
    v_accvgpr_write_b32 a42, v26
    v_perm_b32 v27, v223, v222, s40
    v_accvgpr_write_b32 a43, v27
    v_perm_b32 v28, v217, v216, s41
    v_accvgpr_write_b32 a44, v28
    v_perm_b32 v29, v219, v218, s41
    v_accvgpr_write_b32 a45, v29
    v_perm_b32 v30, v221, v220, s41
    v_accvgpr_write_b32 a46, v30
    v_perm_b32 v31, v223, v222, s41
    v_accvgpr_write_b32 a47, v31
    s_waitcnt vmcnt(56)
    ds_write_b128 v57, a[48:51] offset:0
    ds_write_b128 v57, a[52:55] offset:1024
    ds_write_b128 v57, a[56:59] offset:2048
    ds_write_b128 v57, a[60:63] offset:3072
    ds_read_b32 v208, v58 offset:0
    ds_read_b32 v209, v58 offset:64
    ds_read_b32 v210, v58 offset:128
    ds_read_b32 v211, v58 offset:192
    ds_read_b32 v212, v58 offset:256
    ds_read_b32 v213, v58 offset:320
    ds_read_b32 v214, v58 offset:384
    ds_read_b32 v215, v58 offset:448
    ds_read_b32 v216, v58 offset:2048
    ds_read_b32 v217, v58 offset:2112
    ds_read_b32 v218, v58 offset:2176
    ds_read_b32 v219, v58 offset:2240
    ds_read_b32 v220, v58 offset:2304
    ds_read_b32 v221, v58 offset:2368
    ds_read_b32 v222, v58 offset:2432
    ds_read_b32 v223, v58 offset:2496
    s_waitcnt lgkmcnt(0)
    v_perm_b32 v24, v209, v208, s40
    v_accvgpr_write_b32 a48, v24
    v_perm_b32 v25, v211, v210, s40
    v_accvgpr_write_b32 a49, v25
    v_perm_b32 v26, v213, v212, s40
    v_accvgpr_write_b32 a50, v26
    v_perm_b32 v27, v215, v214, s40
    v_accvgpr_write_b32 a51, v27
    v_perm_b32 v28, v209, v208, s41
    v_accvgpr_write_b32 a52, v28
    v_perm_b32 v29, v211, v210, s41
    v_accvgpr_write_b32 a53, v29
    v_perm_b32 v30, v213, v212, s41
    v_accvgpr_write_b32 a54, v30
    v_perm_b32 v31, v215, v214, s41
    v_accvgpr_write_b32 a55, v31
    v_perm_b32 v24, v217, v216, s40
    v_accvgpr_write_b32 a56, v24
    v_perm_b32 v25, v219, v218, s40
    v_accvgpr_write_b32 a57, v25
    v_perm_b32 v26, v221, v220, s40
    v_accvgpr_write_b32 a58, v26
    v_perm_b32 v27, v223, v222, s40
    v_accvgpr_write_b32 a59, v27
    v_perm_b32 v28, v217, v216, s41
    v_accvgpr_write_b32 a60, v28
    v_perm_b32 v29, v219, v218, s41
    v_accvgpr_write_b32 a61, v29
    v_perm_b32 v30, v221, v220, s41
    v_accvgpr_write_b32 a62, v30
    v_perm_b32 v31, v223, v222, s41
    v_accvgpr_write_b32 a63, v31
    s_waitcnt vmcnt(52)
    ds_write_b128 v57, a[64:67] offset:0
    ds_write_b128 v57, a[68:71] offset:1024
    ds_write_b128 v57, a[72:75] offset:2048
    ds_write_b128 v57, a[76:79] offset:3072
    ds_read_b32 v208, v58 offset:0
    ds_read_b32 v209, v58 offset:64
    ds_read_b32 v210, v58 offset:128
    ds_read_b32 v211, v58 offset:192
    ds_read_b32 v212, v58 offset:256
    ds_read_b32 v213, v58 offset:320
    ds_read_b32 v214, v58 offset:384
    ds_read_b32 v215, v58 offset:448
    ds_read_b32 v216, v58 offset:2048
    ds_read_b32 v217, v58 offset:2112
    ds_read_b32 v218, v58 offset:2176
    ds_read_b32 v219, v58 offset:2240
    ds_read_b32 v220, v58 offset:2304
    ds_read_b32 v221, v58 offset:2368
    ds_read_b32 v222, v58 offset:2432
    ds_read_b32 v223, v58 offset:2496
    s_waitcnt lgkmcnt(0)
    v_perm_b32 v24, v209, v208, s40
    v_accvgpr_write_b32 a64, v24
    v_perm_b32 v25, v211, v210, s40
    v_accvgpr_write_b32 a65, v25
    v_perm_b32 v26, v213, v212, s40
    v_accvgpr_write_b32 a66, v26
    v_perm_b32 v27, v215, v214, s40
    v_accvgpr_write_b32 a67, v27
    v_perm_b32 v28, v209, v208, s41
    v_accvgpr_write_b32 a68, v28
    v_perm_b32 v29, v211, v210, s41
    v_accvgpr_write_b32 a69, v29
    v_perm_b32 v30, v213, v212, s41
    v_accvgpr_write_b32 a70, v30
    v_perm_b32 v31, v215, v214, s41
    v_accvgpr_write_b32 a71, v31
    v_perm_b32 v24, v217, v216, s40
    v_accvgpr_write_b32 a72, v24
    v_perm_b32 v25, v219, v218, s40
    v_accvgpr_write_b32 a73, v25
    v_perm_b32 v26, v221, v220, s40
    v_accvgpr_write_b32 a74, v26
    v_perm_b32 v27, v223, v222, s40
    v_accvgpr_write_b32 a75, v27
    v_perm_b32 v28, v217, v216, s41
    v_accvgpr_write_b32 a76, v28
    v_perm_b32 v29, v219, v218, s41
    v_accvgpr_write_b32 a77, v29
    v_perm_b32 v30, v221, v220, s41
    v_accvgpr_write_b32 a78, v30
    v_perm_b32 v31, v223, v222, s41
    v_accvgpr_write_b32 a79, v31
    s_waitcnt vmcnt(48)
    ds_write_b128 v57, a[80:83] offset:0
    ds_write_b128 v57, a[84:87] offset:1024
    ds_write_b128 v57, a[88:91] offset:2048
    ds_write_b128 v57, a[92:95] offset:3072
    ds_read_b32 v208, v58 offset:0
    ds_read_b32 v209, v58 offset:64
    ds_read_b32 v210, v58 offset:128
    ds_read_b32 v211, v58 offset:192
    ds_read_b32 v212, v58 offset:256
    ds_read_b32 v213, v58 offset:320
    ds_read_b32 v214, v58 offset:384
    ds_read_b32 v215, v58 offset:448
    ds_read_b32 v216, v58 offset:2048
    ds_read_b32 v217, v58 offset:2112
    ds_read_b32 v218, v58 offset:2176
    ds_read_b32 v219, v58 offset:2240
    ds_read_b32 v220, v58 offset:2304
    ds_read_b32 v221, v58 offset:2368
    ds_read_b32 v222, v58 offset:2432
    ds_read_b32 v223, v58 offset:2496
    s_waitcnt lgkmcnt(0)
    v_perm_b32 v24, v209, v208, s40
    v_accvgpr_write_b32 a80, v24
    v_perm_b32 v25, v211, v210, s40
    v_accvgpr_write_b32 a81, v25
    v_perm_b32 v26, v213, v212, s40
    v_accvgpr_write_b32 a82, v26
    v_perm_b32 v27, v215, v214, s40
    v_accvgpr_write_b32 a83, v27
    v_perm_b32 v28, v209, v208, s41
    v_accvgpr_write_b32 a84, v28
    v_perm_b32 v29, v211, v210, s41
    v_accvgpr_write_b32 a85, v29
    v_perm_b32 v30, v213, v212, s41
    v_accvgpr_write_b32 a86, v30
    v_perm_b32 v31, v215, v214, s41
    v_accvgpr_write_b32 a87, v31
    v_perm_b32 v24, v217, v216, s40
    v_accvgpr_write_b32 a88, v24
    v_perm_b32 v25, v219, v218, s40
    v_accvgpr_write_b32 a89, v25
    v_perm_b32 v26, v221, v220, s40
    v_accvgpr_write_b32 a90, v26
    v_perm_b32 v27, v223, v222, s40
    v_accvgpr_write_b32 a91, v27
    v_perm_b32 v28, v217, v216, s41
    v_accvgpr_write_b32 a92, v28
    v_perm_b32 v29, v219, v218, s41
    v_accvgpr_write_b32 a93, v29
    v_perm_b32 v30, v221, v220, s41
    v_accvgpr_write_b32 a94, v30
    v_perm_b32 v31, v223, v222, s41
    v_accvgpr_write_b32 a95, v31
    s_waitcnt vmcnt(44)
    ds_write_b128 v57, a[96:99] offset:0
    ds_write_b128 v57, a[100:103] offset:1024
    ds_write_b128 v57, a[104:107] offset:2048
    ds_write_b128 v57, a[108:111] offset:3072
    ds_read_b32 v208, v58 offset:0
    ds_read_b32 v209, v58 offset:64
    ds_read_b32 v210, v58 offset:128
    ds_read_b32 v211, v58 offset:192
    ds_read_b32 v212, v58 offset:256
    ds_read_b32 v213, v58 offset:320
    ds_read_b32 v214, v58 offset:384
    ds_read_b32 v215, v58 offset:448
    ds_read_b32 v216, v58 offset:2048
    ds_read_b32 v217, v58 offset:2112
    ds_read_b32 v218, v58 offset:2176
    ds_read_b32 v219, v58 offset:2240
    ds_read_b32 v220, v58 offset:2304
    ds_read_b32 v221, v58 offset:2368
    ds_read_b32 v222, v58 offset:2432
    ds_read_b32 v223, v58 offset:2496
    s_waitcnt lgkmcnt(0)
    v_perm_b32 v24, v209, v208, s40
    v_accvgpr_write_b32 a96, v24
    v_perm_b32 v25, v211, v210, s40
    v_accvgpr_write_b32 a97, v25
    v_perm_b32 v26, v213, v212, s40
    v_accvgpr_write_b32 a98, v26
    v_perm_b32 v27, v215, v214, s40
    v_accvgpr_write_b32 a99, v27
    v_perm_b32 v28, v209, v208, s41
    v_accvgpr_write_b32 a100, v28
    v_perm_b32 v29, v211, v210, s41
    v_accvgpr_write_b32 a101, v29
    v_perm_b32 v30, v213, v212, s41
    v_accvgpr_write_b32 a102, v30
    v_perm_b32 v31, v215, v214, s41
    v_accvgpr_write_b32 a103, v31
    v_perm_b32 v24, v217, v216, s40
    v_accvgpr_write_b32 a104, v24
    v_perm_b32 v25, v219, v218, s40
    v_accvgpr_write_b32 a105, v25
    v_perm_b32 v26, v221, v220, s40
    v_accvgpr_write_b32 a106, v26
    v_perm_b32 v27, v223, v222, s40
    v_accvgpr_write_b32 a107, v27
    v_perm_b32 v28, v217, v216, s41
    v_accvgpr_write_b32 a108, v28
    v_perm_b32 v29, v219, v218, s41
    v_accvgpr_write_b32 a109, v29
    v_perm_b32 v30, v221, v220, s41
    v_accvgpr_write_b32 a110, v30
    v_perm_b32 v31, v223, v222, s41
    v_accvgpr_write_b32 a111, v31
    s_waitcnt vmcnt(40)
    ds_write_b128 v57, a[112:115] offset:0
    ds_write_b128 v57, a[116:119] offset:1024
    ds_write_b128 v57, a[120:123] offset:2048
    ds_write_b128 v57, a[124:127] offset:3072
    ds_read_b32 v208, v58 offset:0
    ds_read_b32 v209, v58 offset:64
    ds_read_b32 v210, v58 offset:128
    ds_read_b32 v211, v58 offset:192
    ds_read_b32 v212, v58 offset:256
    ds_read_b32 v213, v58 offset:320
    ds_read_b32 v214, v58 offset:384
    ds_read_b32 v215, v58 offset:448
    ds_read_b32 v216, v58 offset:2048
    ds_read_b32 v217, v58 offset:2112
    ds_read_b32 v218, v58 offset:2176
    ds_read_b32 v219, v58 offset:2240
    ds_read_b32 v220, v58 offset:2304
    ds_read_b32 v221, v58 offset:2368
    ds_read_b32 v222, v58 offset:2432
    ds_read_b32 v223, v58 offset:2496
    s_waitcnt lgkmcnt(0)
    v_perm_b32 v24, v209, v208, s40
    v_accvgpr_write_b32 a112, v24
    v_perm_b32 v25, v211, v210, s40
    v_accvgpr_write_b32 a113, v25
    v_perm_b32 v26, v213, v212, s40
    v_accvgpr_write_b32 a114, v26
    v_perm_b32 v27, v215, v214, s40
    v_accvgpr_write_b32 a115, v27
    v_perm_b32 v28, v209, v208, s41
    v_accvgpr_write_b32 a116, v28
    v_perm_b32 v29, v211, v210, s41
    v_accvgpr_write_b32 a117, v29
    v_perm_b32 v30, v213, v212, s41
    v_accvgpr_write_b32 a118, v30
    v_perm_b32 v31, v215, v214, s41
    v_accvgpr_write_b32 a119, v31
    v_perm_b32 v24, v217, v216, s40
    v_accvgpr_write_b32 a120, v24
    v_perm_b32 v25, v219, v218, s40
    v_accvgpr_write_b32 a121, v25
    v_perm_b32 v26, v221, v220, s40
    v_accvgpr_write_b32 a122, v26
    v_perm_b32 v27, v223, v222, s40
    v_accvgpr_write_b32 a123, v27
    v_perm_b32 v28, v217, v216, s41
    v_accvgpr_write_b32 a124, v28
    v_perm_b32 v29, v219, v218, s41
    v_accvgpr_write_b32 a125, v29
    v_perm_b32 v30, v221, v220, s41
    v_accvgpr_write_b32 a126, v30
    v_perm_b32 v31, v223, v222, s41
    v_accvgpr_write_b32 a127, v31
    s_waitcnt vmcnt(36)
    ds_write_b128 v57, a[128:131] offset:0
    ds_write_b128 v57, a[132:135] offset:1024
    ds_write_b128 v57, a[136:139] offset:2048
    ds_write_b128 v57, a[140:143] offset:3072
    ds_read_b32 v208, v58 offset:0
    ds_read_b32 v209, v58 offset:64
    ds_read_b32 v210, v58 offset:128
    ds_read_b32 v211, v58 offset:192
    ds_read_b32 v212, v58 offset:256
    ds_read_b32 v213, v58 offset:320
    ds_read_b32 v214, v58 offset:384
    ds_read_b32 v215, v58 offset:448
    ds_read_b32 v216, v58 offset:2048
    ds_read_b32 v217, v58 offset:2112
    ds_read_b32 v218, v58 offset:2176
    ds_read_b32 v219, v58 offset:2240
    ds_read_b32 v220, v58 offset:2304
    ds_read_b32 v221, v58 offset:2368
    ds_read_b32 v222, v58 offset:2432
    ds_read_b32 v223, v58 offset:2496
    s_waitcnt lgkmcnt(0)
    v_perm_b32 v24, v209, v208, s40
    v_accvgpr_write_b32 a128, v24
    v_perm_b32 v25, v211, v210, s40
    v_accvgpr_write_b32 a129, v25
    v_perm_b32 v26, v213, v212, s40
    v_accvgpr_write_b32 a130, v26
    v_perm_b32 v27, v215, v214, s40
    v_accvgpr_write_b32 a131, v27
    v_perm_b32 v28, v209, v208, s41
    v_accvgpr_write_b32 a132, v28
    v_perm_b32 v29, v211, v210, s41
    v_accvgpr_write_b32 a133, v29
    v_perm_b32 v30, v213, v212, s41
    v_accvgpr_write_b32 a134, v30
    v_perm_b32 v31, v215, v214, s41
    v_accvgpr_write_b32 a135, v31
    v_perm_b32 v24, v217, v216, s40
    v_accvgpr_write_b32 a136, v24
    v_perm_b32 v25, v219, v218, s40
    v_accvgpr_write_b32 a137, v25
    v_perm_b32 v26, v221, v220, s40
    v_accvgpr_write_b32 a138, v26
    v_perm_b32 v27, v223, v222, s40
    v_accvgpr_write_b32 a139, v27
    v_perm_b32 v28, v217, v216, s41
    v_accvgpr_write_b32 a140, v28
    v_perm_b32 v29, v219, v218, s41
    v_accvgpr_write_b32 a141, v29
    v_perm_b32 v30, v221, v220, s41
    v_accvgpr_write_b32 a142, v30
    v_perm_b32 v31, v223, v222, s41
    v_accvgpr_write_b32 a143, v31
    s_waitcnt vmcnt(32)
    ds_write_b128 v57, v[64:67] offset:0
    ds_write_b128 v57, v[68:71] offset:1024
    ds_write_b128 v57, v[72:75] offset:2048
    ds_write_b128 v57, v[76:79] offset:3072
    ds_read_b32 v208, v58 offset:0
    ds_read_b32 v209, v58 offset:64
    ds_read_b32 v210, v58 offset:128
    ds_read_b32 v211, v58 offset:192
    ds_read_b32 v212, v58 offset:256
    ds_read_b32 v213, v58 offset:320
    ds_read_b32 v214, v58 offset:384
    ds_read_b32 v215, v58 offset:448
    ds_read_b32 v216, v58 offset:2048
    ds_read_b32 v217, v58 offset:2112
    ds_read_b32 v218, v58 offset:2176
    ds_read_b32 v219, v58 offset:2240
    ds_read_b32 v220, v58 offset:2304
    ds_read_b32 v221, v58 offset:2368
    ds_read_b32 v222, v58 offset:2432
    ds_read_b32 v223, v58 offset:2496
    s_waitcnt lgkmcnt(0)
    v_perm_b32 v64, v209, v208, s40
    v_perm_b32 v65, v211, v210, s40
    v_perm_b32 v66, v213, v212, s40
    v_perm_b32 v67, v215, v214, s40
    v_perm_b32 v68, v209, v208, s41
    v_perm_b32 v69, v211, v210, s41
    v_perm_b32 v70, v213, v212, s41
    v_perm_b32 v71, v215, v214, s41
    v_perm_b32 v72, v217, v216, s40
    v_perm_b32 v73, v219, v218, s40
    v_perm_b32 v74, v221, v220, s40
    v_perm_b32 v75, v223, v222, s40
    v_perm_b32 v76, v217, v216, s41
    v_perm_b32 v77, v219, v218, s41
    v_perm_b32 v78, v221, v220, s41
    v_perm_b32 v79, v223, v222, s41
    s_waitcnt vmcnt(28)
    ds_write_b128 v57, v[80:83] offset:0
    ds_write_b128 v57, v[84:87] offset:1024
    ds_write_b128 v57, v[88:91] offset:2048
    ds_write_b128 v57, v[92:95] offset:3072
    ds_read_b32 v208, v58 offset:0
    ds_read_b32 v209, v58 offset:64
    ds_read_b32 v210, v58 offset:128
    ds_read_b32 v211, v58 offset:192
    ds_read_b32 v212, v58 offset:256
    ds_read_b32 v213, v58 offset:320
    ds_read_b32 v214, v58 offset:384
    ds_read_b32 v215, v58 offset:448
    ds_read_b32 v216, v58 offset:2048
    ds_read_b32 v217, v58 offset:2112
    ds_read_b32 v218, v58 offset:2176
    ds_read_b32 v219, v58 offset:2240
    ds_read_b32 v220, v58 offset:2304
    ds_read_b32 v221, v58 offset:2368
    ds_read_b32 v222, v58 offset:2432
    ds_read_b32 v223, v58 offset:2496
    s_waitcnt lgkmcnt(0)
    v_perm_b32 v80, v209, v208, s40
    v_perm_b32 v81, v211, v210, s40
    v_perm_b32 v82, v213, v212, s40
    v_perm_b32 v83, v215, v214, s40
    v_perm_b32 v84, v209, v208, s41
    v_perm_b32 v85, v211, v210, s41
    v_perm_b32 v86, v213, v212, s41
    v_perm_b32 v87, v215, v214, s41
    v_perm_b32 v88, v217, v216, s40
    v_perm_b32 v89, v219, v218, s40
    v_perm_b32 v90, v221, v220, s40
    v_perm_b32 v91, v223, v222, s40
    v_perm_b32 v92, v217, v216, s41
    v_perm_b32 v93, v219, v218, s41
    v_perm_b32 v94, v221, v220, s41
    v_perm_b32 v95, v223, v222, s41
    s_waitcnt vmcnt(24)
    ds_write_b128 v57, v[96:99] offset:0
    ds_write_b128 v57, v[100:103] offset:1024
    ds_write_b128 v57, v[104:107] offset:2048
    ds_write_b128 v57, v[108:111] offset:3072
    ds_read_b32 v208, v58 offset:0
    ds_read_b32 v209, v58 offset:64
    ds_read_b32 v210, v58 offset:128
    ds_read_b32 v211, v58 offset:192
    ds_read_b32 v212, v58 offset:256
    ds_read_b32 v213, v58 offset:320
    ds_read_b32 v214, v58 offset:384
    ds_read_b32 v215, v58 offset:448
    ds_read_b32 v216, v58 offset:2048
    ds_read_b32 v217, v58 offset:2112
    ds_read_b32 v218, v58 offset:2176
    ds_read_b32 v219, v58 offset:2240
    ds_read_b32 v220, v58 offset:2304
    ds_read_b32 v221, v58 offset:2368
    ds_read_b32 v222, v58 offset:2432
    ds_read_b32 v223, v58 offset:2496
    s_waitcnt lgkmcnt(0)
    v_perm_b32 v96, v209, v208, s40
    v_perm_b32 v97, v211, v210, s40
    v_perm_b32 v98, v213, v212, s40
    v_perm_b32 v99, v215, v214, s40
    v_perm_b32 v100, v209, v208, s41
    v_perm_b32 v101, v211, v210, s41
    v_perm_b32 v102, v213, v212, s41
    v_perm_b32 v103, v215, v214, s41
    v_perm_b32 v104, v217, v216, s40
    v_perm_b32 v105, v219, v218, s40
    v_perm_b32 v106, v221, v220, s40
    v_perm_b32 v107, v223, v222, s40
    v_perm_b32 v108, v217, v216, s41
    v_perm_b32 v109, v219, v218, s41
    v_perm_b32 v110, v221, v220, s41
    v_perm_b32 v111, v223, v222, s41
    s_waitcnt vmcnt(20)
    ds_write_b128 v57, v[112:115] offset:0
    ds_write_b128 v57, v[116:119] offset:1024
    ds_write_b128 v57, v[120:123] offset:2048
    ds_write_b128 v57, v[124:127] offset:3072
    ds_read_b32 v208, v58 offset:0
    ds_read_b32 v209, v58 offset:64
    ds_read_b32 v210, v58 offset:128
    ds_read_b32 v211, v58 offset:192
    ds_read_b32 v212, v58 offset:256
    ds_read_b32 v213, v58 offset:320
    ds_read_b32 v214, v58 offset:384
    ds_read_b32 v215, v58 offset:448
    ds_read_b32 v216, v58 offset:2048
    ds_read_b32 v217, v58 offset:2112
    ds_read_b32 v218, v58 offset:2176
    ds_read_b32 v219, v58 offset:2240
    ds_read_b32 v220, v58 offset:2304
    ds_read_b32 v221, v58 offset:2368
    ds_read_b32 v222, v58 offset:2432
    ds_read_b32 v223, v58 offset:2496
    s_waitcnt lgkmcnt(0)
    v_perm_b32 v112, v209, v208, s40
    v_perm_b32 v113, v211, v210, s40
    v_perm_b32 v114, v213, v212, s40
    v_perm_b32 v115, v215, v214, s40
    v_perm_b32 v116, v209, v208, s41
    v_perm_b32 v117, v211, v210, s41
    v_perm_b32 v118, v213, v212, s41
    v_perm_b32 v119, v215, v214, s41
    v_perm_b32 v120, v217, v216, s40
    v_perm_b32 v121, v219, v218, s40
    v_perm_b32 v122, v221, v220, s40
    v_perm_b32 v123, v223, v222, s40
    v_perm_b32 v124, v217, v216, s41
    v_perm_b32 v125, v219, v218, s41
    v_perm_b32 v126, v221, v220, s41
    v_perm_b32 v127, v223, v222, s41
    s_waitcnt vmcnt(16)
    ds_write_b128 v57, v[128:131] offset:0
    ds_write_b128 v57, v[132:135] offset:1024
    ds_write_b128 v57, v[136:139] offset:2048
    ds_write_b128 v57, v[140:143] offset:3072
    ds_read_b32 v208, v58 offset:0
    ds_read_b32 v209, v58 offset:64
    ds_read_b32 v210, v58 offset:128
    ds_read_b32 v211, v58 offset:192
    ds_read_b32 v212, v58 offset:256
    ds_read_b32 v213, v58 offset:320
    ds_read_b32 v214, v58 offset:384
    ds_read_b32 v215, v58 offset:448
    ds_read_b32 v216, v58 offset:2048
    ds_read_b32 v217, v58 offset:2112
    ds_read_b32 v218, v58 offset:2176
    ds_read_b32 v219, v58 offset:2240
    ds_read_b32 v220, v58 offset:2304
    ds_read_b32 v221, v58 offset:2368
    ds_read_b32 v222, v58 offset:2432
    ds_read_b32 v223, v58 offset:2496
    s_waitcnt lgkmcnt(0)
    v_perm_b32 v128, v209, v208, s40
    v_perm_b32 v129, v211, v210, s40
    v_perm_b32 v130, v213, v212, s40
    v_perm_b32 v131, v215, v214, s40
    v_perm_b32 v132, v209, v208, s41
    v_perm_b32 v133, v211, v210, s41
    v_perm_b32 v134, v213, v212, s41
    v_perm_b32 v135, v215, v214, s41
    v_perm_b32 v136, v217, v216, s40
    v_perm_b32 v137, v219, v218, s40
    v_perm_b32 v138, v221, v220, s40
    v_perm_b32 v139, v223, v222, s40
    v_perm_b32 v140, v217, v216, s41
    v_perm_b32 v141, v219, v218, s41
    v_perm_b32 v142, v221, v220, s41
    v_perm_b32 v143, v223, v222, s41
    s_waitcnt vmcnt(12)
    ds_write_b128 v57, v[144:147] offset:0
    ds_write_b128 v57, v[148:151] offset:1024
    ds_write_b128 v57, v[152:155] offset:2048
    ds_write_b128 v57, v[156:159] offset:3072
    ds_read_b32 v208, v58 offset:0
    ds_read_b32 v209, v58 offset:64
    ds_read_b32 v210, v58 offset:128
    ds_read_b32 v211, v58 offset:192
    ds_read_b32 v212, v58 offset:256
    ds_read_b32 v213, v58 offset:320
    ds_read_b32 v214, v58 offset:384
    ds_read_b32 v215, v58 offset:448
    ds_read_b32 v216, v58 offset:2048
    ds_read_b32 v217, v58 offset:2112
    ds_read_b32 v218, v58 offset:2176
    ds_read_b32 v219, v58 offset:2240
    ds_read_b32 v220, v58 offset:2304
    ds_read_b32 v221, v58 offset:2368
    ds_read_b32 v222, v58 offset:2432
    ds_read_b32 v223, v58 offset:2496
    s_waitcnt lgkmcnt(0)
    v_perm_b32 v144, v209, v208, s40
    v_perm_b32 v145, v211, v210, s40
    v_perm_b32 v146, v213, v212, s40
    v_perm_b32 v147, v215, v214, s40
    v_perm_b32 v148, v209, v208, s41
    v_perm_b32 v149, v211, v210, s41
    v_perm_b32 v150, v213, v212, s41
    v_perm_b32 v151, v215, v214, s41
    v_perm_b32 v152, v217, v216, s40
    v_perm_b32 v153, v219, v218, s40
    v_perm_b32 v154, v221, v220, s40
    v_perm_b32 v155, v223, v222, s40
    v_perm_b32 v156, v217, v216, s41
    v_perm_b32 v157, v219, v218, s41
    v_perm_b32 v158, v221, v220, s41
    v_perm_b32 v159, v223, v222, s41
    s_waitcnt vmcnt(8)
    ds_write_b128 v57, v[160:163] offset:0
    ds_write_b128 v57, v[164:167] offset:1024
    ds_write_b128 v57, v[168:171] offset:2048
    ds_write_b128 v57, v[172:175] offset:3072
    ds_read_b32 v208, v58 offset:0
    ds_read_b32 v209, v58 offset:64
    ds_read_b32 v210, v58 offset:128
    ds_read_b32 v211, v58 offset:192
    ds_read_b32 v212, v58 offset:256
    ds_read_b32 v213, v58 offset:320
    ds_read_b32 v214, v58 offset:384
    ds_read_b32 v215, v58 offset:448
    ds_read_b32 v216, v58 offset:2048
    ds_read_b32 v217, v58 offset:2112
    ds_read_b32 v218, v58 offset:2176
    ds_read_b32 v219, v58 offset:2240
    ds_read_b32 v220, v58 offset:2304
    ds_read_b32 v221, v58 offset:2368
    ds_read_b32 v222, v58 offset:2432
    ds_read_b32 v223, v58 offset:2496
    s_waitcnt lgkmcnt(0)
    v_perm_b32 v160, v209, v208, s40
    v_perm_b32 v161, v211, v210, s40
    v_perm_b32 v162, v213, v212, s40
    v_perm_b32 v163, v215, v214, s40
    v_perm_b32 v164, v209, v208, s41
    v_perm_b32 v165, v211, v210, s41
    v_perm_b32 v166, v213, v212, s41
    v_perm_b32 v167, v215, v214, s41
    v_perm_b32 v168, v217, v216, s40
    v_perm_b32 v169, v219, v218, s40
    v_perm_b32 v170, v221, v220, s40
    v_perm_b32 v171, v223, v222, s40
    v_perm_b32 v172, v217, v216, s41
    v_perm_b32 v173, v219, v218, s41
    v_perm_b32 v174, v221, v220, s41
    v_perm_b32 v175, v223, v222, s41
    s_waitcnt vmcnt(4)
    ds_write_b128 v57, v[176:179] offset:0
    ds_write_b128 v57, v[180:183] offset:1024
    ds_write_b128 v57, v[184:187] offset:2048
    ds_write_b128 v57, v[188:191] offset:3072
    ds_read_b32 v208, v58 offset:0
    ds_read_b32 v209, v58 offset:64
    ds_read_b32 v210, v58 offset:128
    ds_read_b32 v211, v58 offset:192
    ds_read_b32 v212, v58 offset:256
    ds_read_b32 v213, v58 offset:320
    ds_read_b32 v214, v58 offset:384
    ds_read_b32 v215, v58 offset:448
    ds_read_b32 v216, v58 offset:2048
    ds_read_b32 v217, v58 offset:2112
    ds_read_b32 v218, v58 offset:2176
    ds_read_b32 v219, v58 offset:2240
    ds_read_b32 v220, v58 offset:2304
    ds_read_b32 v221, v58 offset:2368
    ds_read_b32 v222, v58 offset:2432
    ds_read_b32 v223, v58 offset:2496
    s_waitcnt lgkmcnt(0)
    v_perm_b32 v176, v209, v208, s40
    v_perm_b32 v177, v211, v210, s40
    v_perm_b32 v178, v213, v212, s40
    v_perm_b32 v179, v215, v214, s40
    v_perm_b32 v180, v209, v208, s41
    v_perm_b32 v181, v211, v210, s41
    v_perm_b32 v182, v213, v212, s41
    v_perm_b32 v183, v215, v214, s41
    v_perm_b32 v184, v217, v216, s40
    v_perm_b32 v185, v219, v218, s40
    v_perm_b32 v186, v221, v220, s40
    v_perm_b32 v187, v223, v222, s40
    v_perm_b32 v188, v217, v216, s41
    v_perm_b32 v189, v219, v218, s41
    v_perm_b32 v190, v221, v220, s41
    v_perm_b32 v191, v223, v222, s41
    s_waitcnt vmcnt(0)
    ds_write_b128 v57, v[192:195] offset:0
    ds_write_b128 v57, v[196:199] offset:1024
    ds_write_b128 v57, v[200:203] offset:2048
    ds_write_b128 v57, v[204:207] offset:3072
    ds_read_b32 v208, v58 offset:0
    ds_read_b32 v209, v58 offset:64
    ds_read_b32 v210, v58 offset:128
    ds_read_b32 v211, v58 offset:192
    ds_read_b32 v212, v58 offset:256
    ds_read_b32 v213, v58 offset:320
    ds_read_b32 v214, v58 offset:384
    ds_read_b32 v215, v58 offset:448
    ds_read_b32 v216, v58 offset:2048
    ds_read_b32 v217, v58 offset:2112
    ds_read_b32 v218, v58 offset:2176
    ds_read_b32 v219, v58 offset:2240
    ds_read_b32 v220, v58 offset:2304
    ds_read_b32 v221, v58 offset:2368
    ds_read_b32 v222, v58 offset:2432
    ds_read_b32 v223, v58 offset:2496
    s_waitcnt lgkmcnt(0)
    v_perm_b32 v192, v209, v208, s40
    v_perm_b32 v193, v211, v210, s40
    v_perm_b32 v194, v213, v212, s40
    v_perm_b32 v195, v215, v214, s40
    v_perm_b32 v196, v209, v208, s41
    v_perm_b32 v197, v211, v210, s41
    v_perm_b32 v198, v213, v212, s41
    v_perm_b32 v199, v215, v214, s41
    v_perm_b32 v200, v217, v216, s40
    v_perm_b32 v201, v219, v218, s40
    v_perm_b32 v202, v221, v220, s40
    v_perm_b32 v203, v223, v222, s40
    v_perm_b32 v204, v217, v216, s41
    v_perm_b32 v205, v219, v218, s41
    v_perm_b32 v206, v221, v220, s41
    v_perm_b32 v207, v223, v222, s41
    s_cmp_eq_u32 s53, 2
    s_cbranch_scc1 L_run2
    v_accvgpr_write_b32 a160, 0
    v_accvgpr_write_b32 a161, 0
    v_accvgpr_write_b32 a162, 0
    v_accvgpr_write_b32 a163, 0
    v_accvgpr_write_b32 a164, 0
    v_accvgpr_write_b32 a165, 0
    v_accvgpr_write_b32 a166, 0
    v_accvgpr_write_b32 a167, 0
    v_accvgpr_write_b32 a168, 0
    v_accvgpr_write_b32 a169, 0
    v_accvgpr_write_b32 a170, 0
    v_accvgpr_write_b32 a171, 0
    v_accvgpr_write_b32 a172, 0
    v_accvgpr_write_b32 a173, 0
    v_accvgpr_write_b32 a174, 0
    v_accvgpr_write_b32 a175, 0
    v_cmp_eq_u32 s[56:57], 9, v4
    s_barrier
    s_mul_i32 s49, s42, 36864
    s_mul_i32 s43, s62, 36864
    s_lshl_b32 s58, s33, 10
    s_mov_b32 s59, 0
    s_mov_b32 s47, 0
    s_mov_b32 s61, 0
    s_mov_b32 s38, 1069066811
    s_mov_b32 s37, 0x358637bd
    s_add_u32 m0, s58, 0
    s_nop 0
    buffer_load_dwordx4 v6, s[12:15], s49 offen lds
    s_add_u32 m0, s58, 4096
    s_nop 0
    buffer_load_dwordx4 v7, s[12:15], s49 offen lds
    s_add_u32 m0, s58, 8192
    s_nop 0
    buffer_load_dwordx4 v8, s[12:15], s49 offen lds
    s_add_u32 m0, s58, 12288
    s_nop 0
    buffer_load_dwordx4 v9, s[12:15], s49 offen lds
    s_add_u32 m0, s58, 16384
    s_nop 0
    buffer_load_dwordx4 v10, s[12:15], s49 offen lds
    s_add_u32 m0, s58, 20480
    s_nop 0
    buffer_load_dwordx4 v11, s[12:15], s49 offen lds
    s_add_u32 m0, s58, 24576
    s_nop 0
    buffer_load_dwordx4 v12, s[12:15], s49 offen lds
    s_add_u32 m0, s58, 28672
    s_nop 0
    buffer_load_dwordx4 v13, s[12:15], s49 offen lds
    s_add_u32 m0, s58, 32768
    s_nop 0
    buffer_load_dwordx4 v14, s[12:15], s49 offen lds
    s_add_u32 s49, s49, s43
    s_add_u32 s58, s58, 36864
    s_add_u32 m0, s58, 0
    s_nop 0
    buffer_load_dwordx4 v6, s[12:15], s49 offen lds
    s_add_u32 m0, s58, 4096
    s_nop 0
    buffer_load_dwordx4 v7, s[12:15], s49 offen lds
    s_add_u32 m0, s58, 8192
    s_nop 0
    buffer_load_dwordx4 v8, s[12:15], s49 offen lds
    s_add_u32 m0, s58, 12288
    s_nop 0
    buffer_load_dwordx4 v9, s[12:15], s49 offen lds
    s_add_u32 m0, s58, 16384
    s_nop 0
    buffer_load_dwordx4 v10, s[12:15], s49 offen lds
    s_add_u32 m0, s58, 20480
    s_nop 0
    buffer_load_dwordx4 v11, s[12:15], s49 offen lds
    s_add_u32 m0, s58, 24576
    s_nop 0
    buffer_load_dwordx4 v12, s[12:15], s49 offen lds
    s_add_u32 m0, s58, 28672
    s_nop 0
    buffer_load_dwordx4 v13, s[12:15], s49 offen lds
    s_add_u32 m0, s58, 32768
    s_nop 0
    buffer_load_dwordx4 v14, s[12:15], s49 offen lds
    s_add_u32 s49, s49, s43
    s_add_u32 s58, s58, 36864
    s_waitcnt vmcnt(9)
L_gBKV_top:
    s_barrier
    v_add_u32 v20, s59, v16
    v_add_u32 v21, s59, v17
    v_add_u32 v22, s59, v18
    v_add_u32 v23, s59, v19
    ds_read_b128 v[24:27], v20 offset:0
    ds_read_b128 v[28:31], v22 offset:0
    ds_read_b128 v[32:35], v21 offset:0
    ds_read_b128 v[36:39], v23 offset:0
    ds_read_b128 v[240:243], v20 offset:128
    ds_read_b128 v[244:247], v22 offset:128
    s_waitcnt lgkmcnt(4)
    v_mfma_f32_16x16x32_bf16 v[40:43], v[24:27], v[64:67], 0
    s_add_u32 m0, s58, 0
    s_nop 0
    buffer_load_dwordx4 v6, s[12:15], s49 offen lds
    v_mfma_f32_16x16x32_bf16 v[44:47], v[24:27], v[68:71], 0
    v_mfma_f32_16x16x32_bf16 v[224:227], v[24:27], a[0:3], 0
    v_mfma_f32_16x16x32_bf16 v[228:231], v[24:27], a[4:7], 0
    v_mfma_f32_16x16x32_bf16 v[48:51], v[28:31], v[64:67], 0
    v_mfma_f32_16x16x32_bf16 v[52:55], v[28:31], v[68:71], 0
    v_mfma_f32_16x16x32_bf16 v[232:235], v[28:31], a[0:3], 0
    v_mfma_f32_16x16x32_bf16 v[236:239], v[28:31], a[4:7], 0
    ds_read_b128 v[248:251], v21 offset:128
    ds_read_b128 v[252:255], v23 offset:128
    s_waitcnt lgkmcnt(4)
    v_mfma_f32_16x16x32_bf16 v[40:43], v[32:35], v[72:75], v[40:43]
    v_mfma_f32_16x16x32_bf16 v[44:47], v[32:35], v[76:79], v[44:47]
    v_mfma_f32_16x16x32_bf16 v[224:227], v[32:35], a[8:11], v[224:227]
    v_mfma_f32_16x16x32_bf16 v[228:231], v[32:35], a[12:15], v[228:231]
    v_mfma_f32_16x16x32_bf16 v[48:51], v[36:39], v[72:75], v[48:51]
    v_mfma_f32_16x16x32_bf16 v[52:55], v[36:39], v[76:79], v[52:55]
    v_mfma_f32_16x16x32_bf16 v[232:235], v[36:39], a[8:11], v[232:235]
    v_mfma_f32_16x16x32_bf16 v[236:239], v[36:39], a[12:15], v[236:239]
    ds_read_b128 v[24:27], v20 offset:256
    ds_read_b128 v[28:31], v22 offset:256
    s_waitcnt lgkmcnt(4)
    v_mfma_f32_16x16x32_bf16 v[40:43], v[240:243], v[80:83], v[40:43]
    s_add_u32 m0, s58, 4096
    s_nop 0
    buffer_load_dwordx4 v7, s[12:15], s49 offen lds
    v_mfma_f32_16x16x32_bf16 v[44:47], v[240:243], v[84:87], v[44:47]
    v_mfma_f32_16x16x32_bf16 v[224:227], v[240:243], a[16:19], v[224:227]
    v_mfma_f32_16x16x32_bf16 v[228:231], v[240:243], a[20:23], v[228:231]
    v_mfma_f32_16x16x32_bf16 v[48:51], v[244:247], v[80:83], v[48:51]
    v_mfma_f32_16x16x32_bf16 v[52:55], v[244:247], v[84:87], v[52:55]
    v_mfma_f32_16x16x32_bf16 v[232:235], v[244:247], a[16:19], v[232:235]
    v_mfma_f32_16x16x32_bf16 v[236:239], v[244:247], a[20:23], v[236:239]
    ds_read_b128 v[32:35], v21 offset:256
    ds_read_b128 v[36:39], v23 offset:256
    s_waitcnt lgkmcnt(4)
    v_mfma_f32_16x16x32_bf16 v[40:43], v[248:251], v[88:91], v[40:43]
    v_mfma_f32_16x16x32_bf16 v[44:47], v[248:251], v[92:95], v[44:47]
    v_mfma_f32_16x16x32_bf16 v[224:227], v[248:251], a[24:27], v[224:227]
    v_mfma_f32_16x16x32_bf16 v[228:231], v[248:251], a[28:31], v[228:231]
    v_mfma_f32_16x16x32_bf16 v[48:51], v[252:255], v[88:91], v[48:51]
    v_mfma_f32_16x16x32_bf16 v[52:55], v[252:255], v[92:95], v[52:55]
    v_mfma_f32_16x16x32_bf16 v[232:235], v[252:255], a[24:27], v[232:235]
    v_mfma_f32_16x16x32_bf16 v[236:239], v[252:255], a[28:31], v[236:239]
    ds_read_b128 v[240:243], v20 offset:384
    ds_read_b128 v[244:247], v22 offset:384
    s_waitcnt lgkmcnt(4)
    v_mfma_f32_16x16x32_bf16 v[40:43], v[24:27], v[96:99], v[40:43]
    s_add_u32 m0, s58, 8192
    s_nop 0
    buffer_load_dwordx4 v8, s[12:15], s49 offen lds
    v_mfma_f32_16x16x32_bf16 v[44:47], v[24:27], v[100:103], v[44:47]
    v_mfma_f32_16x16x32_bf16 v[224:227], v[24:27], a[32:35], v[224:227]
    v_mfma_f32_16x16x32_bf16 v[228:231], v[24:27], a[36:39], v[228:231]
    v_mfma_f32_16x16x32_bf16 v[48:51], v[28:31], v[96:99], v[48:51]
    v_mfma_f32_16x16x32_bf16 v[52:55], v[28:31], v[100:103], v[52:55]
    v_mfma_f32_16x16x32_bf16 v[232:235], v[28:31], a[32:35], v[232:235]
    v_mfma_f32_16x16x32_bf16 v[236:239], v[28:31], a[36:39], v[236:239]
    ds_read_b128 v[248:251], v21 offset:384
    ds_read_b128 v[252:255], v23 offset:384
    s_waitcnt lgkmcnt(4)
    v_mfma_f32_16x16x32_bf16 v[40:43], v[32:35], v[104:107], v[40:43]
    v_mfma_f32_16x16x32_bf16 v[44:47], v[32:35], v[108:111], v[44:47]
    v_mfma_f32_16x16x32_bf16 v[224:227], v[32:35], a[40:43], v[224:227]
    v_mfma_f32_16x16x32_bf16 v[228:231], v[32:35], a[44:47], v[228:231]
    v_mfma_f32_16x16x32_bf16 v[48:51], v[36:39], v[104:107], v[48:51]
    v_mfma_f32_16x16x32_bf16 v[52:55], v[36:39], v[108:111], v[52:55]
    v_mfma_f32_16x16x32_bf16 v[232:235], v[36:39], a[40:43], v[232:235]
    v_mfma_f32_16x16x32_bf16 v[236:239], v[36:39], a[44:47], v[236:239]
    ds_read_b128 v[24:27], v20 offset:512
    ds_read_b128 v[28:31], v22 offset:512
    s_waitcnt lgkmcnt(4)
    v_mfma_f32_16x16x32_bf16 v[40:43], v[240:243], v[112:115], v[40:43]
    s_add_u32 m0, s58, 12288
    s_nop 0
    buffer_load_dwordx4 v9, s[12:15], s49 offen lds
    v_mfma_f32_16x16x32_bf16 v[44:47], v[240:243], v[116:119], v[44:47]
    v_mfma_f32_16x16x32_bf16 v[224:227], v[240:243], a[48:51], v[224:227]
    v_mfma_f32_16x16x32_bf16 v[228:231], v[240:243], a[52:55], v[228:231]
    v_mfma_f32_16x16x32_bf16 v[48:51], v[244:247], v[112:115], v[48:51]
    v_mfma_f32_16x16x32_bf16 v[52:55], v[244:247], v[116:119], v[52:55]
    v_mfma_f32_16x16x32_bf16 v[232:235], v[244:247], a[48:51], v[232:235]
    v_mfma_f32_16x16x32_bf16 v[236:239], v[244:247], a[52:55], v[236:239]
    ds_read_b128 v[32:35], v21 offset:512
    ds_read_b128 v[36:39], v23 offset:512
    s_waitcnt lgkmcnt(4)
    v_mfma_f32_16x16x32_bf16 v[40:43], v[248:251], v[120:123], v[40:43]
    v_mfma_f32_16x16x32_bf16 v[44:47], v[248:251], v[124:127], v[44:47]
    v_mfma_f32_16x16x32_bf16 v[224:227], v[248:251], a[56:59], v[224:227]
    v_mfma_f32_16x16x32_bf16 v[228:231], v[248:251], a[60:63], v[228:231]
    v_mfma_f32_16x16x32_bf16 v[48:51], v[252:255], v[120:123], v[48:51]
    v_mfma_f32_16x16x32_bf16 v[52:55], v[252:255], v[124:127], v[52:55]
    v_mfma_f32_16x16x32_bf16 v[232:235], v[252:255], a[56:59], v[232:235]
    v_mfma_f32_16x16x32_bf16 v[236:239], v[252:255], a[60:63], v[236:239]
    ds_read_b128 v[240:243], v20 offset:640
    ds_read_b128 v[244:247], v22 offset:640
    s_waitcnt lgkmcnt(4)
    v_mfma_f32_16x16x32_bf16 v[40:43], v[24:27], v[128:131], v[40:43]
    s_add_u32 m0, s58, 16384
    s_nop 0
    buffer_load_dwordx4 v10, s[12:15], s49 offen lds
    v_mfma_f32_16x16x32_bf16 v[44:47], v[24:27], v[132:135], v[44:47]
    v_mfma_f32_16x16x32_bf16 v[224:227], v[24:27], a[64:67], v[224:227]
    v_mfma_f32_16x16x32_bf16 v[228:231], v[24:27], a[68:71], v[228:231]
    v_mfma_f32_16x16x32_bf16 v[48:51], v[28:31], v[128:131], v[48:51]
    v_mfma_f32_16x16x32_bf16 v[52:55], v[28:31], v[132:135], v[52:55]
    v_mfma_f32_16x16x32_bf16 v[232:235], v[28:31], a[64:67], v[232:235]
    v_mfma_f32_16x16x32_bf16 v[236:239], v[28:31], a[68:71], v[236:239]
    ds_read_b128 v[248:251], v21 offset:640
    ds_read_b128 v[252:255], v23 offset:640
    s_waitcnt lgkmcnt(4)
    v_mfma_f32_16x16x32_bf16 v[40:43], v[32:35], v[136:139], v[40:43]
    v_mfma_f32_16x16x32_bf16 v[44:47], v[32:35], v[140:143], v[44:47]
    v_mfma_f32_16x16x32_bf16 v[224:227], v[32:35], a[72:75], v[224:227]
    v_mfma_f32_16x16x32_bf16 v[228:231], v[32:35], a[76:79], v[228:231]
    v_mfma_f32_16x16x32_bf16 v[48:51], v[36:39], v[136:139], v[48:51]
    v_mfma_f32_16x16x32_bf16 v[52:55], v[36:39], v[140:143], v[52:55]
    v_mfma_f32_16x16x32_bf16 v[232:235], v[36:39], a[72:75], v[232:235]
    v_mfma_f32_16x16x32_bf16 v[236:239], v[36:39], a[76:79], v[236:239]
    ds_read_b128 v[24:27], v20 offset:768
    ds_read_b128 v[28:31], v22 offset:768
    s_waitcnt lgkmcnt(4)
    v_mfma_f32_16x16x32_bf16 v[40:43], v[240:243], v[144:147], v[40:43]
    s_add_u32 m0, s58, 20480
    s_nop 0
    buffer_load_dwordx4 v11, s[12:15], s49 offen lds
    v_mfma_f32_16x16x32_bf16 v[44:47], v[240:243], v[148:151], v[44:47]
    v_mfma_f32_16x16x32_bf16 v[224:227], v[240:243], a[80:83], v[224:227]
    v_mfma_f32_16x16x32_bf16 v[228:231], v[240:243], a[84:87], v[228:231]
    v_mfma_f32_16x16x32_bf16 v[48:51], v[244:247], v[144:147], v[48:51]
    v_mfma_f32_16x16x32_bf16 v[52:55], v[244:247], v[148:151], v[52:55]
    v_mfma_f32_16x16x32_bf16 v[232:235], v[244:247], a[80:83], v[232:235]
    v_mfma_f32_16x16x32_bf16 v[236:239], v[244:247], a[84:87], v[236:239]
    ds_read_b128 v[32:35], v21 offset:768
    ds_read_b128 v[36:39], v23 offset:768
    s_waitcnt lgkmcnt(4)
    v_mfma_f32_16x16x32_bf16 v[40:43], v[248:251], v[152:155], v[40:43]
    v_mfma_f32_16x16x32_bf16 v[44:47], v[248:251], v[156:159], v[44:47]
    v_mfma_f32_16x16x32_bf16 v[224:227], v[248:251], a[88:91], v[224:227]
    v_mfma_f32_16x16x32_bf16 v[228:231], v[248:251], a[92:95], v[228:231]
    v_mfma_f32_16x16x32_bf16 v[48:51], v[252:255], v[152:155], v[48:51]
    v_mfma_f32_16x16x32_bf16 v[52:55], v[252:255], v[156:159], v[52:55]
    v_mfma_f32_16x16x32_bf16 v[232:235], v[252:255], a[88:91], v[232:235]
    v_mfma_f32_16x16x32_bf16 v[236:239], v[252:255], a[92:95], v[236:239]
    ds_read_b128 v[240:243], v20 offset:896
    ds_read_b128 v[244:247], v22 offset:896
    s_waitcnt lgkmcnt(4)
    v_mfma_f32_16x16x32_bf16 v[40:43], v[24:27], v[160:163], v[40:43]
    s_add_u32 m0, s58, 24576
    s_nop 0
    buffer_load_dwordx4 v12, s[12:15], s49 offen lds
    v_mfma_f32_16x16x32_bf16 v[44:47], v[24:27], v[164:167], v[44:47]
    v_mfma_f32_16x16x32_bf16 v[224:227], v[24:27], a[96:99], v[224:227]
    v_mfma_f32_16x16x32_bf16 v[228:231], v[24:27], a[100:103], v[228:231]
    v_mfma_f32_16x16x32_bf16 v[48:51], v[28:31], v[160:163], v[48:51]
    v_mfma_f32_16x16x32_bf16 v[52:55], v[28:31], v[164:167], v[52:55]
    v_mfma_f32_16x16x32_bf16 v[232:235], v[28:31], a[96:99], v[232:235]
    v_mfma_f32_16x16x32_bf16 v[236:239], v[28:31], a[100:103], v[236:239]
    ds_read_b128 v[248:251], v21 offset:896
    ds_read_b128 v[252:255], v23 offset:896
    s_waitcnt lgkmcnt(4)
    v_mfma_f32_16x16x32_bf16 v[40:43], v[32:35], v[168:171], v[40:43]
    v_mfma_f32_16x16x32_bf16 v[44:47], v[32:35], v[172:175], v[44:47]
    v_mfma_f32_16x16x32_bf16 v[224:227], v[32:35], a[104:107], v[224:227]
    v_mfma_f32_16x16x32_bf16 v[228:231], v[32:35], a[108:111], v[228:231]
    v_mfma_f32_16x16x32_bf16 v[48:51], v[36:39], v[168:171], v[48:51]
    v_mfma_f32_16x16x32_bf16 v[52:55], v[36:39], v[172:175], v[52:55]
    v_mfma_f32_16x16x32_bf16 v[232:235], v[36:39], a[104:107], v[232:235]
    v_mfma_f32_16x16x32_bf16 v[236:239], v[36:39], a[108:111], v[236:239]
    ds_read_b128 v[24:27], v20 offset:1024
    ds_read_b128 v[28:31], v22 offset:1024
    s_waitcnt lgkmcnt(4)
    v_mfma_f32_16x16x32_bf16 v[40:43], v[240:243], v[176:179], v[40:43]
    s_add_u32 m0, s58, 28672
    s_nop 0
    buffer_load_dwordx4 v13, s[12:15], s49 offen lds
    v_mfma_f32_16x16x32_bf16 v[44:47], v[240:243], v[180:183], v[44:47]
    v_mfma_f32_16x16x32_bf16 v[224:227], v[240:243], a[112:115], v[224:227]
    v_mfma_f32_16x16x32_bf16 v[228:231], v[240:243], a[116:119], v[228:231]
    v_mfma_f32_16x16x32_bf16 v[48:51], v[244:247], v[176:179], v[48:51]
    v_mfma_f32_16x16x32_bf16 v[52:55], v[244:247], v[180:183], v[52:55]
    v_mfma_f32_16x16x32_bf16 v[232:235], v[244:247], a[112:115], v[232:235]
    v_mfma_f32_16x16x32_bf16 v[236:239], v[244:247], a[116:119], v[236:239]
    ds_read_b128 v[32:35], v21 offset:1024
    ds_read_b128 v[36:39], v23 offset:1024
    s_waitcnt lgkmcnt(4)
    v_mfma_f32_16x16x32_bf16 v[40:43], v[248:251], v[184:187], v[40:43]
    v_mfma_f32_16x16x32_bf16 v[44:47], v[248:251], v[188:191], v[44:47]
    v_mfma_f32_16x16x32_bf16 v[224:227], v[248:251], a[120:123], v[224:227]
    v_mfma_f32_16x16x32_bf16 v[228:231], v[248:251], a[124:127], v[228:231]
    v_mfma_f32_16x16x32_bf16 v[48:51], v[252:255], v[184:187], v[48:51]
    v_mfma_f32_16x16x32_bf16 v[52:55], v[252:255], v[188:191], v[52:55]
    v_mfma_f32_16x16x32_bf16 v[232:235], v[252:255], a[120:123], v[232:235]
    v_mfma_f32_16x16x32_bf16 v[236:239], v[252:255], a[124:127], v[236:239]
    s_waitcnt lgkmcnt(2)
    v_mfma_f32_16x16x32_bf16 v[40:43], v[24:27], v[192:195], v[40:43]
    s_add_u32 m0, s58, 32768
    s_nop 0
    buffer_load_dwordx4 v14, s[12:15], s49 offen lds
    v_mfma_f32_16x16x32_bf16 v[44:47], v[24:27], v[196:199], v[44:47]
    v_mfma_f32_16x16x32_bf16 v[224:227], v[24:27], a[128:131], v[224:227]
    v_mfma_f32_16x16x32_bf16 v[228:231], v[24:27], a[132:135], v[228:231]
    v_mfma_f32_16x16x32_bf16 v[48:51], v[28:31], v[192:195], v[48:51]
    v_mfma_f32_16x16x32_bf16 v[52:55], v[28:31], v[196:199], v[52:55]
    v_mfma_f32_16x16x32_bf16 v[232:235], v[28:31], a[128:131], v[232:235]
    v_mfma_f32_16x16x32_bf16 v[236:239], v[28:31], a[132:135], v[236:239]
    s_waitcnt lgkmcnt(0)
    v_mfma_f32_16x16x32_bf16 v[40:43], v[32:35], v[200:203], v[40:43]
    v_mfma_f32_16x16x32_bf16 v[44:47], v[32:35], v[204:207], v[44:47]
    v_mfma_f32_16x16x32_bf16 v[224:227], v[32:35], a[136:139], v[224:227]
    v_mfma_f32_16x16x32_bf16 v[228:231], v[32:35], a[140:143], v[228:231]
    v_mfma_f32_16x16x32_bf16 v[48:51], v[36:39], v[200:203], v[48:51]
    v_mfma_f32_16x16x32_bf16 v[52:55], v[36:39], v[204:207], v[52:55]
    v_mfma_f32_16x16x32_bf16 v[232:235], v[36:39], a[136:139], v[232:235]
    v_mfma_f32_16x16x32_bf16 v[236:239], v[36:39], a[140:143], v[236:239]
    s_add_u32 s49, s49, s43
    s_add_u32 s58, s58, 36864
    s_sub_u32 s35, s58, 110592
    s_cmp_ge_u32 s58, 110592
    s_cselect_b32 s58, s35, s58
    s_add_u32 s59, s59, 36864
    s_cmp_ge_u32 s59, 110592
    s_cselect_b32 s59, 0, s59
    v_cvt_pk_bf16_f32 v2, v40, v41
    v_lshlrev_b32 v40, 16, v2
    v_and_b32 v41, 0xffff0000, v2
    v_mul_f32 v2, s38, v40
    v_mul_f32 v3, s38, v41
    v_exp_f32 v2, v2
    v_exp_f32 v3, v3
    v_cmp_lt_f32 vcc, 0, v40
    v_add_f32 v40, 1.0, v40
    s_nop 0
    v_cndmask_b32 v40, v2, v40, vcc
    v_cmp_lt_f32 vcc, 0, v41
    v_add_f32 v41, 1.0, v41
    s_nop 0
    v_cndmask_b32 v41, v3, v41, vcc
    v_add_f32 v40, s37, v40
    v_add_f32 v41, s37, v41
    v_cvt_pk_bf16_f32 v208, v40, v41
    v_cvt_pk_bf16_f32 v2, v42, v43
    v_lshlrev_b32 v42, 16, v2
    v_and_b32 v43, 0xffff0000, v2
    v_mul_f32 v2, s38, v42
    v_mul_f32 v3, s38, v43
    v_exp_f32 v2, v2
    v_exp_f32 v3, v3
    v_cmp_lt_f32 vcc, 0, v42
    v_add_f32 v42, 1.0, v42
    s_nop 0
    v_cndmask_b32 v42, v2, v42, vcc
    v_cmp_lt_f32 vcc, 0, v43
    v_add_f32 v43, 1.0, v43
    s_nop 0
    v_cndmask_b32 v43, v3, v43, vcc
    v_add_f32 v42, s37, v42
    v_add_f32 v43, s37, v43
    v_cvt_pk_bf16_f32 v209, v42, v43
    v_cvt_pk_bf16_f32 v2, v48, v49
    v_lshlrev_b32 v48, 16, v2
    v_and_b32 v49, 0xffff0000, v2
    v_mul_f32 v2, s38, v48
    v_mul_f32 v3, s38, v49
    v_exp_f32 v2, v2
    v_exp_f32 v3, v3
    v_cmp_lt_f32 vcc, 0, v48
    v_add_f32 v48, 1.0, v48
    s_nop 0
    v_cndmask_b32 v48, v2, v48, vcc
    v_cmp_lt_f32 vcc, 0, v49
    v_add_f32 v49, 1.0, v49
    s_nop 0
    v_cndmask_b32 v49, v3, v49, vcc
    v_add_f32 v48, s37, v48
    v_add_f32 v49, s37, v49
    v_cvt_pk_bf16_f32 v210, v48, v49
    v_cvt_pk_bf16_f32 v2, v50, v51
    v_lshlrev_b32 v50, 16, v2
    v_and_b32 v51, 0xffff0000, v2
    v_mul_f32 v2, s38, v50
    v_mul_f32 v3, s38, v51
    v_exp_f32 v2, v2
    v_exp_f32 v3, v3
    v_cmp_lt_f32 vcc, 0, v50
    v_add_f32 v50, 1.0, v50
    s_nop 0
    v_cndmask_b32 v50, v2, v50, vcc
    v_cmp_lt_f32 vcc, 0, v51
    v_add_f32 v51, 1.0, v51
    s_nop 0
    v_cndmask_b32 v51, v3, v51, vcc
    v_add_f32 v50, s37, v50
    v_add_f32 v51, s37, v51
    v_cvt_pk_bf16_f32 v211, v50, v51
    v_cvt_pk_bf16_f32 v2, v44, v45
    v_lshlrev_b32 v44, 16, v2
    v_and_b32 v45, 0xffff0000, v2
    v_mul_f32 v2, s38, v44
    v_mul_f32 v3, s38, v45
    v_exp_f32 v2, v2
    v_exp_f32 v3, v3
    v_cmp_lt_f32 vcc, 0, v44
    v_add_f32 v44, 1.0, v44
    s_nop 0
    v_cndmask_b32 v44, v2, v44, vcc
    v_cmp_lt_f32 vcc, 0, v45
    v_add_f32 v45, 1.0, v45
    s_nop 0
    v_cndmask_b32 v45, v3, v45, vcc
    v_add_f32 v44, s37, v44
    v_add_f32 v45, s37, v45
    v_cvt_pk_bf16_f32 v212, v44, v45
    v_cvt_pk_bf16_f32 v2, v46, v47
    v_lshlrev_b32 v46, 16, v2
    v_and_b32 v47, 0xffff0000, v2
    v_mul_f32 v2, s38, v46
    v_mul_f32 v3, s38, v47
    v_exp_f32 v2, v2
    v_exp_f32 v3, v3
    v_cmp_lt_f32 vcc, 0, v46
    v_add_f32 v46, 1.0, v46
    s_nop 0
    v_cndmask_b32 v46, v2, v46, vcc
    v_cmp_lt_f32 vcc, 0, v47
    v_add_f32 v47, 1.0, v47
    s_nop 0
    v_cndmask_b32 v47, v3, v47, vcc
    v_add_f32 v46, s37, v46
    v_add_f32 v47, s37, v47
    v_cvt_pk_bf16_f32 v213, v46, v47
    v_cvt_pk_bf16_f32 v2, v52, v53
    v_lshlrev_b32 v52, 16, v2
    v_and_b32 v53, 0xffff0000, v2
    v_mul_f32 v2, s38, v52
    v_mul_f32 v3, s38, v53
    v_exp_f32 v2, v2
    v_exp_f32 v3, v3
    v_cmp_lt_f32 vcc, 0, v52
    v_add_f32 v52, 1.0, v52
    s_nop 0
    v_cndmask_b32 v52, v2, v52, vcc
    v_cmp_lt_f32 vcc, 0, v53
    v_add_f32 v53, 1.0, v53
    s_nop 0
    v_cndmask_b32 v53, v3, v53, vcc
    v_add_f32 v52, s37, v52
    v_add_f32 v53, s37, v53
    v_cvt_pk_bf16_f32 v214, v52, v53
    v_cvt_pk_bf16_f32 v2, v54, v55
    v_lshlrev_b32 v54, 16, v2
    v_and_b32 v55, 0xffff0000, v2
    v_mul_f32 v2, s38, v54
    v_mul_f32 v3, s38, v55
    v_exp_f32 v2, v2
    v_exp_f32 v3, v3
    v_cmp_lt_f32 vcc, 0, v54
    v_add_f32 v54, 1.0, v54
    s_nop 0
    v_cndmask_b32 v54, v2, v54, vcc
    v_cmp_lt_f32 vcc, 0, v55
    v_add_f32 v55, 1.0, v55
    s_nop 0
    v_cndmask_b32 v55, v3, v55, vcc
    v_add_f32 v54, s37, v54
    v_add_f32 v55, s37, v55
    v_cvt_pk_bf16_f32 v215, v54, v55
    v_cvt_pk_bf16_f32 v216, v224, v225
    v_cvt_pk_bf16_f32 v217, v226, v227
    v_cvt_pk_bf16_f32 v218, v232, v233
    v_cvt_pk_bf16_f32 v219, v234, v235
    v_cvt_pk_bf16_f32 v220, v228, v229
    v_cvt_pk_bf16_f32 v221, v230, v231
    v_cvt_pk_bf16_f32 v222, v236, v237
    v_cvt_pk_bf16_f32 v223, v238, v239
    v_mov_b32 v2, 0x3f803f80
    v_cndmask_b32 v216, v216, v2, s[56:57]
    v_cndmask_b32 v217, v217, v2, s[56:57]
    v_cndmask_b32 v218, v218, v2, s[56:57]
    v_cndmask_b32 v219, v219, v2, s[56:57]
    s_nop 1
    v_mfma_f32_16x16x32_bf16 a[160:163], v[208:211], v[216:219], a[160:163]
    v_mfma_f32_16x16x32_bf16 a[164:167], v[208:211], v[220:223], a[164:167]
    v_mfma_f32_16x16x32_bf16 a[168:171], v[212:215], v[216:219], a[168:171]
    v_mfma_f32_16x16x32_bf16 a[172:175], v[212:215], v[220:223], a[172:175]
    s_add_u32 s42, s42, s62
    s_waitcnt vmcnt(9)
    s_cmp_lt_u32 s42, 64
    s_cbranch_scc1 L_gBKV_top
    s_nop 7
    buffer_store_dwordx4 a[160:163], v0, s[8:11], s44 offen offset:0 sc1
    buffer_store_dwordx4 a[164:167], v0, s[8:11], s44 offen offset:1024 sc1
    buffer_store_dwordx4 a[168:171], v0, s[8:11], s44 offen offset:2048 sc1
    buffer_store_dwordx4 a[172:175], v0, s[8:11], s44 offen offset:3072 sc1
    s_waitcnt vmcnt(0)
    s_barrier
    s_cmp_lg_u32 s33, 0
    s_cbranch_scc1 L_sigbkvf
    v_mov_b32 v2, 12
    v_mov_b32 v3, 1
    s_mov_b64 exec, 1
    buffer_atomic_add v3, v2, s[20:23], 0 offen
    s_mov_b64 exec, -1
L_sigbkvf:
L_gemm_done:
    s_mov_b32 s32, s92
    s_mov_b32 s54, 0
    s_mov_b32 s24, s86
    s_mov_b32 s25, s87
    s_mov_b32 s26, 2359296
    s_mov_b32 s27, 0x00020000
    s_mov_b32 s16, s74
    s_mov_b32 s17, s75
    s_mov_b32 s18, 4718592
    s_mov_b32 s19, 0x00020000
    s_mov_b32 s28, s82
    s_mov_b32 s29, s83
    s_mov_b32 s30, 663552
    s_mov_b32 s31, 0x00020000
    v_mul_u32_u24 v42, 4608, v5
    v_lshl_add_u32 v44, v4, 4, v42
    s_lshl_b32 s35, s33, 8
    v_add_u32 v44, s35, v44
    v_lshl_add_u32 v45, v4, 1, v42
    s_lshl_b32 s35, s33, 5
    s_add_u32 s35, s35, 1024
    v_add_u32 v45, s35, v45
    s_mul_i32 s36, s32, 147456
    v_mov_b32 v2, 1073741824
    v_cmp_eq_u32 vcc, 0, v5
    s_nop 1
    v_cndmask_b32 v46, v2, v44, vcc
    v_cndmask_b32 v47, v2, v45, vcc
    s_mul_i32 s38, s32, 20736
    s_add_u32 s37, s36, 0
    buffer_load_dwordx4 v[64:67], v44, s[16:19], s37 offen
    buffer_load_dwordx4 v[68:71], v44, s[16:19], s37 offen offset:1152
    s_add_u32 s37, s36, 2304
    buffer_load_dwordx4 v[72:75], v44, s[16:19], s37 offen
    buffer_load_dwordx4 v[76:79], v44, s[16:19], s37 offen offset:1152
    s_add_u32 s37, s36, 18432
    buffer_load_dwordx4 v[80:83], v44, s[16:19], s37 offen
    buffer_load_dwordx4 v[84:87], v44, s[16:19], s37 offen offset:1152
    s_add_u32 s37, s36, 20736
    buffer_load_dwordx4 v[88:91], v44, s[16:19], s37 offen
    buffer_load_dwordx4 v[92:95], v44, s[16:19], s37 offen offset:1152
    s_add_u32 s37, s36, 36864
    buffer_load_dwordx4 v[96:99], v44, s[16:19], s37 offen
    buffer_load_dwordx4 v[100:103], v44, s[16:19], s37 offen offset:1152
    s_add_u32 s37, s36, 39168
    buffer_load_dwordx4 v[104:107], v44, s[16:19], s37 offen
    buffer_load_dwordx4 v[108:111], v44, s[16:19], s37 offen offset:1152
    s_add_u32 s37, s36, 55296
    buffer_load_dwordx4 v[112:115], v44, s[16:19], s37 offen
    buffer_load_dwordx4 v[116:119], v44, s[16:19], s37 offen offset:1152
    s_add_u32 s37, s36, 57600
    buffer_load_dwordx4 v[120:123], v44, s[16:19], s37 offen
    buffer_load_dwordx4 v[124:127], v44, s[16:19], s37 offen offset:1152
    s_add_u32 s37, s36, 73728
    buffer_load_dwordx4 v[128:131], v44, s[16:19], s37 offen
    buffer_load_dwordx4 v[132:135], v44, s[16:19], s37 offen offset:1152
    s_add_u32 s37, s36, 76032
    buffer_load_dwordx4 v[136:139], v44, s[16:19], s37 offen
    buffer_load_dwordx4 v[140:143], v44, s[16:19], s37 offen offset:1152
    s_add_u32 s37, s36, 92160
    buffer_load_dwordx4 v[144:147], v44, s[16:19], s37 offen
    buffer_load_dwordx4 v[148:151], v44, s[16:19], s37 offen offset:1152
    s_add_u32 s37, s36, 94464
    buffer_load_dwordx4 v[152:155], v44, s[16:19], s37 offen
    buffer_load_dwordx4 v[156:159], v44, s[16:19], s37 offen offset:1152
    s_add_u32 s37, s36, 110592
    buffer_load_dwordx4 v[160:163], v44, s[16:19], s37 offen
    buffer_load_dwordx4 v[164:167], v44, s[16:19], s37 offen offset:1152
    s_add_u32 s37, s36, 112896
    buffer_load_dwordx4 v[168:171], v44, s[16:19], s37 offen
    buffer_load_dwordx4 v[172:175], v44, s[16:19], s37 offen offset:1152
    s_add_u32 s37, s36, 129024
    buffer_load_dwordx4 v[176:179], v44, s[16:19], s37 offen
    buffer_load_dwordx4 v[180:183], v44, s[16:19], s37 offen offset:1152
    s_add_u32 s37, s36, 131328
    buffer_load_dwordx4 v[184:187], v44, s[16:19], s37 offen
    buffer_load_dwordx4 v[188:191], v44, s[16:19], s37 offen offset:1152
    s_waitcnt vmcnt(0)
    s_add_u32 s37, s36, 0
    buffer_load_ushort v192, v45, s[16:19], s37 offen
    buffer_load_ushort v193, v45, s[16:19], s37 offen offset:1152
    s_add_u32 s37, s36, 73728
    buffer_load_ushort v194, v45, s[16:19], s37 offen
    buffer_load_ushort v195, v45, s[16:19], s37 offen offset:1152
    s_add_u32 s37, s36, 2304
    buffer_load_ushort v196, v45, s[16:19], s37 offen
    buffer_load_ushort v197, v45, s[16:19], s37 offen offset:1152
    s_add_u32 s37, s36, 76032
    buffer_load_ushort v198, v45, s[16:19], s37 offen
    buffer_load_ushort v199, v45, s[16:19], s37 offen offset:1152
    s_add_u32 s37, s36, 18432
    buffer_load_ushort v200, v45, s[16:19], s37 offen
    buffer_load_ushort v201, v45, s[16:19], s37 offen offset:1152
    s_add_u32 s37, s36, 92160
    buffer_load_ushort v202, v45, s[16:19], s37 offen
    buffer_load_ushort v203, v45, s[16:19], s37 offen offset:1152
    s_add_u32 s37, s36, 20736
    buffer_load_ushort v204, v45, s[16:19], s37 offen
    buffer_load_ushort v205, v45, s[16:19], s37 offen offset:1152
    s_add_u32 s37, s36, 94464
    buffer_load_ushort v206, v45, s[16:19], s37 offen
    buffer_load_ushort v207, v45, s[16:19], s37 offen offset:1152
    s_add_u32 s37, s36, 36864
    buffer_load_ushort v208, v45, s[16:19], s37 offen
    buffer_load_ushort v209, v45, s[16:19], s37 offen offset:1152
    s_add_u32 s37, s36, 110592
    buffer_load_ushort v210, v45, s[16:19], s37 offen
    buffer_load_ushort v211, v45, s[16:19], s37 offen offset:1152
    s_add_u32 s37, s36, 39168
    buffer_load_ushort v212, v45, s[16:19], s37 offen
    buffer_load_ushort v213, v45, s[16:19], s37 offen offset:1152
    s_add_u32 s37, s36, 112896
    buffer_load_ushort v214, v45, s[16:19], s37 offen
    buffer_load_ushort v215, v45, s[16:19], s37 offen offset:1152
    s_add_u32 s37, s36, 55296
    buffer_load_ushort v216, v45, s[16:19], s37 offen
    buffer_load_ushort v217, v45, s[16:19], s37 offen offset:1152
    s_add_u32 s37, s36, 129024
    buffer_load_ushort v218, v45, s[16:19], s37 offen
    buffer_load_ushort v219, v45, s[16:19], s37 offen offset:1152
    s_add_u32 s37, s36, 57600
    buffer_load_ushort v220, v45, s[16:19], s37 offen
    buffer_load_ushort v221, v45, s[16:19], s37 offen offset:1152
    s_add_u32 s37, s36, 131328
    buffer_load_ushort v222, v45, s[16:19], s37 offen
    buffer_load_ushort v223, v45, s[16:19], s37 offen offset:1152
    s_add_u32 s37, s38, 0
    buffer_load_dwordx4 v[224:227], v44, s[28:31], s37 offen
    buffer_load_dwordx4 v[228:231], v44, s[28:31], s37 offen offset:1152
    buffer_load_ushort v248, v45, s[28:31], s37 offen
    buffer_load_ushort v249, v45, s[28:31], s37 offen offset:1152
    s_add_u32 s37, s38, 2304
    buffer_load_dwordx4 v[232:235], v44, s[28:31], s37 offen
    buffer_load_dwordx4 v[236:239], v44, s[28:31], s37 offen offset:1152
    buffer_load_ushort v250, v45, s[28:31], s37 offen
    buffer_load_ushort v251, v45, s[28:31], s37 offen offset:1152
    s_add_u32 s37, s38, 18432
    buffer_load_dwordx4 v[240:243], v46, s[28:31], s37 offen
    buffer_load_dwordx4 v[244:247], v46, s[28:31], s37 offen offset:1152
    buffer_load_ushort v252, v47, s[28:31], s37 offen
    buffer_load_ushort v253, v47, s[28:31], s37 offen offset:1152
    v_perm_b32 v2, v68, v64, s40
    v_accvgpr_write_b32 a0, v2
    v_perm_b32 v2, v68, v64, s41
    v_accvgpr_write_b32 a1, v2
    v_perm_b32 v2, v76, v72, s40
    v_accvgpr_write_b32 a2, v2
    v_perm_b32 v2, v76, v72, s41
    v_accvgpr_write_b32 a3, v2
    v_perm_b32 v2, v84, v80, s40
    v_accvgpr_write_b32 a4, v2
    v_perm_b32 v2, v84, v80, s41
    v_accvgpr_write_b32 a5, v2
    v_perm_b32 v2, v92, v88, s40
    v_accvgpr_write_b32 a6, v2
    v_perm_b32 v2, v92, v88, s41
    v_accvgpr_write_b32 a7, v2
    v_perm_b32 v2, v69, v65, s40
    v_accvgpr_write_b32 a40, v2
    v_perm_b32 v2, v69, v65, s41
    v_accvgpr_write_b32 a41, v2
    v_perm_b32 v2, v77, v73, s40
    v_accvgpr_write_b32 a42, v2
    v_perm_b32 v2, v77, v73, s41
    v_accvgpr_write_b32 a43, v2
    v_perm_b32 v2, v85, v81, s40
    v_accvgpr_write_b32 a44, v2
    v_perm_b32 v2, v85, v81, s41
    v_accvgpr_write_b32 a45, v2
    v_perm_b32 v2, v93, v89, s40
    v_accvgpr_write_b32 a46, v2
    v_perm_b32 v2, v93, v89, s41
    v_accvgpr_write_b32 a47, v2
    v_perm_b32 v2, v70, v66, s40
    v_accvgpr_write_b32 a80, v2
    v_perm_b32 v2, v70, v66, s41
    v_accvgpr_write_b32 a81, v2
    v_perm_b32 v2, v78, v74, s40
    v_accvgpr_write_b32 a82, v2
    v_perm_b32 v2, v78, v74, s41
    v_accvgpr_write_b32 a83, v2
    v_perm_b32 v2, v86, v82, s40
    v_accvgpr_write_b32 a84, v2
    v_perm_b32 v2, v86, v82, s41
    v_accvgpr_write_b32 a85, v2
    v_perm_b32 v2, v94, v90, s40
    v_accvgpr_write_b32 a86, v2
    v_perm_b32 v2, v94, v90, s41
    v_accvgpr_write_b32 a87, v2
    v_perm_b32 v2, v71, v67, s40
    v_accvgpr_write_b32 a120, v2
    v_perm_b32 v2, v71, v67, s41
    v_accvgpr_write_b32 a121, v2
    v_perm_b32 v2, v79, v75, s40
    v_accvgpr_write_b32 a122, v2
    v_perm_b32 v2, v79, v75, s41
    v_accvgpr_write_b32 a123, v2
    v_perm_b32 v2, v87, v83, s40
    v_accvgpr_write_b32 a124, v2
    v_perm_b32 v2, v87, v83, s41
    v_accvgpr_write_b32 a125, v2
    v_perm_b32 v2, v95, v91, s40
    v_accvgpr_write_b32 a126, v2
    v_perm_b32 v2, v95, v91, s41
    v_accvgpr_write_b32 a127, v2
    v_perm_b32 v2, v100, v96, s40
    v_accvgpr_write_b32 a8, v2
    v_perm_b32 v2, v100, v96, s41
    v_accvgpr_write_b32 a9, v2
    v_perm_b32 v2, v108, v104, s40
    v_accvgpr_write_b32 a10, v2
    v_perm_b32 v2, v108, v104, s41
    v_accvgpr_write_b32 a11, v2
    v_perm_b32 v2, v116, v112, s40
    v_accvgpr_write_b32 a12, v2
    v_perm_b32 v2, v116, v112, s41
    v_accvgpr_write_b32 a13, v2
    v_perm_b32 v2, v124, v120, s40
    v_accvgpr_write_b32 a14, v2
    v_perm_b32 v2, v124, v120, s41
    v_accvgpr_write_b32 a15, v2
    v_perm_b32 v2, v101, v97, s40
    v_accvgpr_write_b32 a48, v2
    v_perm_b32 v2, v101, v97, s41
    v_accvgpr_write_b32 a49, v2
    v_perm_b32 v2, v109, v105, s40
    v_accvgpr_write_b32 a50, v2
    v_perm_b32 v2, v109, v105, s41
    v_accvgpr_write_b32 a51, v2
    v_perm_b32 v2, v117, v113, s40
    v_accvgpr_write_b32 a52, v2
    v_perm_b32 v2, v117, v113, s41
    v_accvgpr_write_b32 a53, v2
    v_perm_b32 v2, v125, v121, s40
    v_accvgpr_write_b32 a54, v2
    v_perm_b32 v2, v125, v121, s41
    v_accvgpr_write_b32 a55, v2
    v_perm_b32 v2, v102, v98, s40
    v_accvgpr_write_b32 a88, v2
    v_perm_b32 v2, v102, v98, s41
    v_accvgpr_write_b32 a89, v2
    v_perm_b32 v2, v110, v106, s40
    v_accvgpr_write_b32 a90, v2
    v_perm_b32 v2, v110, v106, s41
    v_accvgpr_write_b32 a91, v2
    v_perm_b32 v2, v118, v114, s40
    v_accvgpr_write_b32 a92, v2
    v_perm_b32 v2, v118, v114, s41
    v_accvgpr_write_b32 a93, v2
    v_perm_b32 v2, v126, v122, s40
    v_accvgpr_write_b32 a94, v2
    v_perm_b32 v2, v126, v122, s41
    v_accvgpr_write_b32 a95, v2
    v_perm_b32 v2, v103, v99, s40
    v_accvgpr_write_b32 a128, v2
    v_perm_b32 v2, v103, v99, s41
    v_accvgpr_write_b32 a129, v2
    v_perm_b32 v2, v111, v107, s40
    v_accvgpr_write_b32 a130, v2
    v_perm_b32 v2, v111, v107, s41
    v_accvgpr_write_b32 a131, v2
    v_perm_b32 v2, v119, v115, s40
    v_accvgpr_write_b32 a132, v2
    v_perm_b32 v2, v119, v115, s41
    v_accvgpr_write_b32 a133, v2
    v_perm_b32 v2, v127, v123, s40
    v_accvgpr_write_b32 a134, v2
    v_perm_b32 v2, v127, v123, s41
    v_accvgpr_write_b32 a135, v2
    v_perm_b32 v2, v132, v128, s40
    v_accvgpr_write_b32 a16, v2
    v_perm_b32 v2, v132, v128, s41
    v_accvgpr_write_b32 a17, v2
    v_perm_b32 v2, v140, v136, s40
    v_accvgpr_write_b32 a18, v2
    v_perm_b32 v2, v140, v136, s41
    v_accvgpr_write_b32 a19, v2
    v_perm_b32 v2, v148, v144, s40
    v_accvgpr_write_b32 a20, v2
    v_perm_b32 v2, v148, v144, s41
    v_accvgpr_write_b32 a21, v2
    v_perm_b32 v2, v156, v152, s40
    v_accvgpr_write_b32 a22, v2
    v_perm_b32 v2, v156, v152, s41
    v_accvgpr_write_b32 a23, v2
    v_perm_b32 v2, v133, v129, s40
    v_accvgpr_write_b32 a56, v2
    v_perm_b32 v2, v133, v129, s41
    v_accvgpr_write_b32 a57, v2
    v_perm_b32 v2, v141, v137, s40
    v_accvgpr_write_b32 a58, v2
    v_perm_b32 v2, v141, v137, s41
    v_accvgpr_write_b32 a59, v2
    v_perm_b32 v2, v149, v145, s40
    v_accvgpr_write_b32 a60, v2
    v_perm_b32 v2, v149, v145, s41
    v_accvgpr_write_b32 a61, v2
    v_perm_b32 v2, v157, v153, s40
    v_accvgpr_write_b32 a62, v2
    v_perm_b32 v2, v157, v153, s41
    v_accvgpr_write_b32 a63, v2
    v_perm_b32 v2, v134, v130, s40
    v_accvgpr_write_b32 a96, v2
    v_perm_b32 v2, v134, v130, s41
    v_accvgpr_write_b32 a97, v2
    v_perm_b32 v2, v142, v138, s40
    v_accvgpr_write_b32 a98, v2
    v_perm_b32 v2, v142, v138, s41
    v_accvgpr_write_b32 a99, v2
    v_perm_b32 v2, v150, v146, s40
    v_accvgpr_write_b32 a100, v2
    v_perm_b32 v2, v150, v146, s41
    v_accvgpr_write_b32 a101, v2
    v_perm_b32 v2, v158, v154, s40
    v_accvgpr_write_b32 a102, v2
    v_perm_b32 v2, v158, v154, s41
    v_accvgpr_write_b32 a103, v2
    v_perm_b32 v2, v135, v131, s40
    v_accvgpr_write_b32 a136, v2
    v_perm_b32 v2, v135, v131, s41
    v_accvgpr_write_b32 a137, v2
    v_perm_b32 v2, v143, v139, s40
    v_accvgpr_write_b32 a138, v2
    v_perm_b32 v2, v143, v139, s41
    v_accvgpr_write_b32 a139, v2
    v_perm_b32 v2, v151, v147, s40
    v_accvgpr_write_b32 a140, v2
    v_perm_b32 v2, v151, v147, s41
    v_accvgpr_write_b32 a141, v2
    v_perm_b32 v2, v159, v155, s40
    v_accvgpr_write_b32 a142, v2
    v_perm_b32 v2, v159, v155, s41
    v_accvgpr_write_b32 a143, v2
    v_perm_b32 v2, v164, v160, s40
    v_accvgpr_write_b32 a24, v2
    v_perm_b32 v2, v164, v160, s41
    v_accvgpr_write_b32 a25, v2
    v_perm_b32 v2, v172, v168, s40
    v_accvgpr_write_b32 a26, v2
    v_perm_b32 v2, v172, v168, s41
    v_accvgpr_write_b32 a27, v2
    v_perm_b32 v2, v180, v176, s40
    v_accvgpr_write_b32 a28, v2
    v_perm_b32 v2, v180, v176, s41
    v_accvgpr_write_b32 a29, v2
    v_perm_b32 v2, v188, v184, s40
    v_accvgpr_write_b32 a30, v2
    v_perm_b32 v2, v188, v184, s41
    v_accvgpr_write_b32 a31, v2
    v_perm_b32 v2, v165, v161, s40
    v_accvgpr_write_b32 a64, v2
    v_perm_b32 v2, v165, v161, s41
    v_accvgpr_write_b32 a65, v2
    v_perm_b32 v2, v173, v169, s40
    v_accvgpr_write_b32 a66, v2
    v_perm_b32 v2, v173, v169, s41
    v_accvgpr_write_b32 a67, v2
    v_perm_b32 v2, v181, v177, s40
    v_accvgpr_write_b32 a68, v2
    v_perm_b32 v2, v181, v177, s41
    v_accvgpr_write_b32 a69, v2
    v_perm_b32 v2, v189, v185, s40
    v_accvgpr_write_b32 a70, v2
    v_perm_b32 v2, v189, v185, s41
    v_accvgpr_write_b32 a71, v2
    v_perm_b32 v2, v166, v162, s40
    v_accvgpr_write_b32 a104, v2
    v_perm_b32 v2, v166, v162, s41
    v_accvgpr_write_b32 a105, v2
    v_perm_b32 v2, v174, v170, s40
    v_accvgpr_write_b32 a106, v2
    v_perm_b32 v2, v174, v170, s41
    v_accvgpr_write_b32 a107, v2
    v_perm_b32 v2, v182, v178, s40
    v_accvgpr_write_b32 a108, v2
    v_perm_b32 v2, v182, v178, s41
    v_accvgpr_write_b32 a109, v2
    v_perm_b32 v2, v190, v186, s40
    v_accvgpr_write_b32 a110, v2
    v_perm_b32 v2, v190, v186, s41
    v_accvgpr_write_b32 a111, v2
    v_perm_b32 v2, v167, v163, s40
    v_accvgpr_write_b32 a144, v2
    v_perm_b32 v2, v167, v163, s41
    v_accvgpr_write_b32 a145, v2
    v_perm_b32 v2, v175, v171, s40
    v_accvgpr_write_b32 a146, v2
    v_perm_b32 v2, v175, v171, s41
    v_accvgpr_write_b32 a147, v2
    v_perm_b32 v2, v183, v179, s40
    v_accvgpr_write_b32 a148, v2
    v_perm_b32 v2, v183, v179, s41
    v_accvgpr_write_b32 a149, v2
    v_perm_b32 v2, v191, v187, s40
    v_accvgpr_write_b32 a150, v2
    v_perm_b32 v2, v191, v187, s41
    v_accvgpr_write_b32 a151, v2
    s_waitcnt vmcnt(0)
    v_lshl_or_b32 v2, v193, 16, v192
    v_accvgpr_write_b32 a160, v2
    v_lshl_or_b32 v2, v195, 16, v194
    v_accvgpr_write_b32 a161, v2
    v_lshl_or_b32 v2, v197, 16, v196
    v_accvgpr_write_b32 a162, v2
    v_lshl_or_b32 v2, v199, 16, v198
    v_accvgpr_write_b32 a163, v2
    v_lshl_or_b32 v2, v201, 16, v200
    v_accvgpr_write_b32 a164, v2
    v_lshl_or_b32 v2, v203, 16, v202
    v_accvgpr_write_b32 a165, v2
    v_lshl_or_b32 v2, v205, 16, v204
    v_accvgpr_write_b32 a166, v2
    v_lshl_or_b32 v2, v207, 16, v206
    v_accvgpr_write_b32 a167, v2
    v_lshl_or_b32 v2, v209, 16, v208
    v_accvgpr_write_b32 a168, v2
    v_lshl_or_b32 v2, v211, 16, v210
    v_accvgpr_write_b32 a169, v2
    v_lshl_or_b32 v2, v213, 16, v212
    v_accvgpr_write_b32 a170, v2
    v_lshl_or_b32 v2, v215, 16, v214
    v_accvgpr_write_b32 a171, v2
    v_lshl_or_b32 v2, v217, 16, v216
    v_accvgpr_write_b32 a172, v2
    v_lshl_or_b32 v2, v219, 16, v218
    v_accvgpr_write_b32 a173, v2
    v_lshl_or_b32 v2, v221, 16, v220
    v_accvgpr_write_b32 a174, v2
    v_lshl_or_b32 v2, v223, 16, v222
    v_accvgpr_write_b32 a175, v2
    v_perm_b32 v2, v228, v224, s40
    v_accvgpr_write_b32 a32, v2
    v_perm_b32 v2, v228, v224, s41
    v_accvgpr_write_b32 a33, v2
    v_perm_b32 v2, v236, v232, s40
    v_accvgpr_write_b32 a34, v2
    v_perm_b32 v2, v236, v232, s41
    v_accvgpr_write_b32 a35, v2
    v_perm_b32 v2, v244, v240, s40
    v_accvgpr_write_b32 a36, v2
    v_perm_b32 v2, v244, v240, s41
    v_accvgpr_write_b32 a37, v2
    v_accvgpr_write_b32 a38, 0
    v_accvgpr_write_b32 a39, 0
    v_perm_b32 v2, v229, v225, s40
    v_accvgpr_write_b32 a72, v2
    v_perm_b32 v2, v229, v225, s41
    v_accvgpr_write_b32 a73, v2
    v_perm_b32 v2, v237, v233, s40
    v_accvgpr_write_b32 a74, v2
    v_perm_b32 v2, v237, v233, s41
    v_accvgpr_write_b32 a75, v2
    v_perm_b32 v2, v245, v241, s40
    v_accvgpr_write_b32 a76, v2
    v_perm_b32 v2, v245, v241, s41
    v_accvgpr_write_b32 a77, v2
    v_accvgpr_write_b32 a78, 0
    v_accvgpr_write_b32 a79, 0
    v_perm_b32 v2, v230, v226, s40
    v_accvgpr_write_b32 a112, v2
    v_perm_b32 v2, v230, v226, s41
    v_accvgpr_write_b32 a113, v2
    v_perm_b32 v2, v238, v234, s40
    v_accvgpr_write_b32 a114, v2
    v_perm_b32 v2, v238, v234, s41
    v_accvgpr_write_b32 a115, v2
    v_perm_b32 v2, v246, v242, s40
    v_accvgpr_write_b32 a116, v2
    v_perm_b32 v2, v246, v242, s41
    v_accvgpr_write_b32 a117, v2
    v_accvgpr_write_b32 a118, 0
    v_accvgpr_write_b32 a119, 0
    v_perm_b32 v2, v231, v227, s40
    v_accvgpr_write_b32 a152, v2
    v_perm_b32 v2, v231, v227, s41
    v_accvgpr_write_b32 a153, v2
    v_perm_b32 v2, v239, v235, s40
    v_accvgpr_write_b32 a154, v2
    v_perm_b32 v2, v239, v235, s41
    v_accvgpr_write_b32 a155, v2
    v_perm_b32 v2, v247, v243, s40
    v_accvgpr_write_b32 a156, v2
    v_perm_b32 v2, v247, v243, s41
    v_accvgpr_write_b32 a157, v2
    v_accvgpr_write_b32 a158, 0
    v_accvgpr_write_b32 a159, 0
    v_lshl_or_b32 v2, v249, 16, v248
    v_accvgpr_write_b32 a176, v2
    v_accvgpr_write_b32 a177, 0
    v_lshl_or_b32 v2, v251, 16, v250
    v_accvgpr_write_b32 a178, v2
    v_accvgpr_write_b32 a179, 0
    v_lshl_or_b32 v2, v253, 16, v252
    v_accvgpr_write_b32 a180, v2
    v_accvgpr_write_b32 a181, 0
    v_accvgpr_write_b32 a182, 0
    v_accvgpr_write_b32 a183, 0
    v_and_b32 v2, 2, v4
    v_mov_b32 v1, 0x00444444
    v_mov_b32 v3, 0x0049EEEE
    v_cmp_ne_u32 vcc, 0, v2
    s_nop 1
    v_cndmask_b32 v1, v1, v3, vcc
    s_mov_b64 s[62:63], vcc
    s_not_b64 s[60:61], vcc
    v_lshrrev_b32 v2, 2, v4
    v_and_b32 v3, 1, v4
    v_lshl_add_u32 v43, v2, 1, v3
    v_cmp_eq_u32 s[58:59], 0, v3
    s_mov_b32 s56, 0x3e0293ee
    s_lshl_b32 s46, s33, 5
    s_add_u32 s46, s46, s32
    v_lshrrev_b32 v2, 2, v43
    v_and_b32 v3, 1, v43
    v_lshl_add_u32 v2, v2, 1, v3
    s_lshl_b32 s35, s33, 2
    v_add_u32 v2, s35, v2
    v_lshl_add_u32 v2, v5, 4, v2
    v_lshlrev_b32 v2, 4, v2
    v_bfe_u32 v3, v43, 1, 1
    v_lshl_add_u32 v6, v3, 10, v2
    v_lshlrev_b32 v2, 7, v5
    v_lshl_add_u32 v2, v4, 2, v2
    s_lshl_b32 s35, s33, 9
    v_add_u32 v7, s35, v2
    v_lshrrev_b32 v2, 2, v4
    v_lshlrev_b32 v2, 7, v2
    v_lshl_add_u32 v8, v5, 4, v2
    v_lshl_add_u32 v2, v5, 3, v43
    v_lshlrev_b32 v2, 4, v2
    v_add_u32 v10, 2048, v2
    v_and_b32 v3, 2, v4
    v_lshl_add_u32 v11, v3, 9, v10
    v_lshrrev_b32 v2, 2, v4
    v_lshlrev_b32 v2, 3, v2
    v_lshl_add_u32 v2, v5, 1, v2
    v_lshlrev_b32 v2, 4, v2
    v_and_b32 v3, 3, v4
    v_lshl_add_u32 v2, v3, 2, v2
    s_mul_i32 s35, s33, 2560
    s_add_u32 s35, s35, 2048
    v_add_u32 v9, s35, v2
    v_lshrrev_b32 v2, 2, v4
    v_lshlrev_b32 v2, 1, v2
    v_lshl_add_u32 v2, v5, 3, v2
    v_and_b32 v3, 1, v4
    v_add_u32 v2, v2, v3
    v_lshlrev_b32 v2, 3, v2
    v_and_b32 v3, 2, v4
    v_lshl_add_u32 v2, v3, 1, v2
    s_mul_i32 s35, s33, 1792
    s_sub_u32 s35, 8192, s35
    v_add_u32 v12, s35, v2
    v_lshrrev_b32 v2, 3, v4
    v_lshl_add_u32 v2, v2, 2, v5
    v_mul_u32_u24 v2, 9344, v2
    v_and_b32 v3, 7, v4
    v_lshl_add_u32 v3, v3, 4, v2
    s_lshl_b32 s35, s46, 7
    v_add_u32 v13, s35, v3
    s_lshl_b32 s35, s33, 5
    v_lshlrev_b32 v2, 3, v5
    v_add_u32 v15, s35, v2
    v_lshlrev_b32 v2, 2, v43
    v_add_u32 v16, s35, v2
    v_lshlrev_b32 v2, 8, v5
    v_add_u32 v17, 144, v2
    v_mov_b32 v2, 0x3f80
    v_mov_b32 v3, 0x3f800000
    v_cndmask_b32 v2, v3, v2, s[58:59]
    v_lshrrev_b32 v3, 2, v4
    v_cmp_eq_u32 vcc, 0, v3
    s_nop 1
    v_cndmask_b32 v34, 0, v2, vcc
    v_cmp_eq_u32 vcc, 1, v3
    s_nop 1
    v_cndmask_b32 v35, 0, v2, vcc
    v_mov_b32 v36, v34
    v_mov_b32 v37, v35
    v_mov_b32 v38, 0x3f803f80
    v_mov_b32 v39, 0x3f803f80
    v_mov_b32 v40, 0x3f803f80
    v_mov_b32 v41, 0x3f803f80
    v_and_b32 v2, 2, v4
    v_lshl_add_u32 v2, v5, 3, v2
    s_lshl_b32 s35, s33, 3
    v_add_u32 v3, s35, v43
    v_mov_b32 v46, 0xf149f2ca
    v_add_u32 v47, 0, v2
    v_cmp_le_u32 vcc, v47, v3
    s_nop 1
    v_cndmask_b32 v18, v46, 0, vcc
    v_add_u32 v47, 1, v2
    v_cmp_le_u32 vcc, v47, v3
    s_nop 1
    v_cndmask_b32 v19, v46, 0, vcc
    v_add_u32 v47, 4, v2
    v_cmp_le_u32 vcc, v47, v3
    s_nop 1
    v_cndmask_b32 v20, v46, 0, vcc
    v_add_u32 v47, 5, v2
    v_cmp_le_u32 vcc, v47, v3
    s_nop 1
    v_cndmask_b32 v21, v46, 0, vcc
    s_lshl_b32 s35, s46, 7
    v_and_b32 v2, 7, v4
    v_lshlrev_b32 v2, 4, v2
    v_and_b32 v3, 1, v5
    v_lshl_add_u32 v2, v3, 3, v2
    v_add_u32 v46, s35, v2
    v_bfe_u32 v2, v46, 8, 2
    v_bfe_u32 v3, v46, 3, 1
    v_lshl_add_u32 v52, v2, 1, v3
    v_lshrrev_b32 v47, 11, v46
    v_lshlrev_b32 v47, 4, v47
    v_bfe_u32 v2, v46, 4, 4
    v_add_u32 v47, v47, v2
    v_bfe_u32 v48, v46, 10, 1
    v_bfe_u32 v2, v46, 8, 2
    v_bfe_u32 v3, v46, 5, 1
    v_lshl_add_u32 v49, v2, 1, v3
    v_add_u32 v49, 64, v49
    v_bfe_u32 v2, v46, 6, 2
    v_bfe_u32 v3, v46, 3, 1
    v_lshl_add_u32 v50, v2, 1, v3
    v_bfe_u32 v51, v46, 4, 1
    v_cmp_le_u32 vcc, 0x2000, v46
    s_nop 1
    v_cndmask_b32 v47, v47, v49, vcc
    v_cndmask_b32 v52, v52, v50, vcc
    v_cndmask_b32 v48, v48, v51, vcc
    v_mul_u32_u24 v14, 1152, v52
    v_lshl_add_u32 v14, v47, 4, v14
    v_lshl_add_u32 v14, v48, 3, v14
    v_cmp_gt_u32 s[96:97], 8, v4
    v_cmp_gt_u32 s[98:99], 2, v5
    s_nop 0
    s_and_b64 vcc, s[96:97], s[98:99]
    v_mov_b32 v2, 1073741824
    v_cndmask_b32 v14, v2, v14, vcc
    v_mov_b64 v[192:193], 0
    v_mov_b64 v[128:129], 0
    v_mov_b64 v[194:195], 0
    v_mov_b64 v[130:131], 0
    v_mov_b64 v[196:197], 0
    v_mov_b64 v[132:133], 0
    v_mov_b64 v[198:199], 0
    v_mov_b64 v[134:135], 0
    v_mov_b64 v[200:201], 0
    v_mov_b64 v[136:137], 0
    v_mov_b64 v[202:203], 0
    v_mov_b64 v[138:139], 0
    v_mov_b64 v[204:205], 0
    v_mov_b64 v[140:141], 0
    v_mov_b64 v[206:207], 0
    v_mov_b64 v[142:143], 0
    v_mov_b64 v[208:209], 0
    v_mov_b64 v[144:145], 0
    v_mov_b64 v[210:211], 0
    v_mov_b64 v[146:147], 0
    v_mov_b64 v[212:213], 0
    v_mov_b64 v[148:149], 0
    v_mov_b64 v[214:215], 0
    v_mov_b64 v[150:151], 0
    v_mov_b64 v[216:217], 0
    v_mov_b64 v[152:153], 0
    v_mov_b64 v[218:219], 0
    v_mov_b64 v[154:155], 0
    v_mov_b64 v[220:221], 0
    v_mov_b64 v[156:157], 0
    v_mov_b64 v[222:223], 0
    v_mov_b64 v[158:159], 0
    s_mul_i32 s93, s39, 2392064
    s_add_u32 s93, s93, 75497472
    s_cmp_ge_u32 s46, 64
    s_cselect_b32 s94, 1, 0
    v_mov_b64 v[42:43], -1
    v_mov_b64 v[44:45], -1
    s_cmp_ge_u32 s46, 72
    s_cbranch_scc1 L_xinv
    s_mov_b32 s36, s93
    buffer_store_dwordx4 v[42:45], v13, s[8:11], s36 offen sc1
    s_add_u32 s36, s36, 74752
    buffer_store_dwordx4 v[42:45], v13, s[8:11], s36 offen sc1
    s_add_u32 s36, s36, 74752
    buffer_store_dwordx4 v[42:45], v13, s[8:11], s36 offen sc1
    s_add_u32 s36, s36, 74752
    buffer_store_dwordx4 v[42:45], v13, s[8:11], s36 offen sc1
    s_add_u32 s36, s36, 74752
    buffer_store_dwordx4 v[42:45], v13, s[8:11], s36 offen sc1
    s_add_u32 s36, s36, 74752
    buffer_store_dwordx4 v[42:45], v13, s[8:11], s36 offen sc1
    s_add_u32 s36, s36, 74752
    buffer_store_dwordx4 v[42:45], v13, s[8:11], s36 offen sc1
    s_add_u32 s36, s36, 74752
    buffer_store_dwordx4 v[42:45], v13, s[8:11], s36 offen sc1
    s_add_u32 s36, s36, 74752
    buffer_store_dwordx4 v[42:45], v13, s[8:11], s36 offen sc1
    s_add_u32 s36, s36, 74752
    buffer_store_dwordx4 v[42:45], v13, s[8:11], s36 offen sc1
    s_add_u32 s36, s36, 74752
    buffer_store_dwordx4 v[42:45], v13, s[8:11], s36 offen sc1
    s_add_u32 s36, s36, 74752
    buffer_store_dwordx4 v[42:45], v13, s[8:11], s36 offen sc1
    s_add_u32 s36, s36, 74752
    buffer_store_dwordx4 v[42:45], v13, s[8:11], s36 offen sc1
    s_add_u32 s36, s36, 74752
    buffer_store_dwordx4 v[42:45], v13, s[8:11], s36 offen sc1
    s_add_u32 s36, s36, 74752
    buffer_store_dwordx4 v[42:45], v13, s[8:11], s36 offen sc1
    s_add_u32 s36, s36, 74752
    buffer_store_dwordx4 v[42:45], v13, s[8:11], s36 offen sc1
    s_add_u32 s36, s36, 74752
    buffer_store_dwordx4 v[42:45], v13, s[8:11], s36 offen sc1
    s_add_u32 s36, s36, 74752
    buffer_store_dwordx4 v[42:45], v13, s[8:11], s36 offen sc1
    s_add_u32 s36, s36, 74752
    buffer_store_dwordx4 v[42:45], v13, s[8:11], s36 offen sc1
    s_add_u32 s36, s36, 74752
    buffer_store_dwordx4 v[42:45], v13, s[8:11], s36 offen sc1
    s_add_u32 s36, s36, 74752
    buffer_store_dwordx4 v[42:45], v13, s[8:11], s36 offen sc1
    s_add_u32 s36, s36, 74752
    buffer_store_dwordx4 v[42:45], v13, s[8:11], s36 offen sc1
    s_add_u32 s36, s36, 74752
    buffer_store_dwordx4 v[42:45], v13, s[8:11], s36 offen sc1
    s_add_u32 s36, s36, 74752
    buffer_store_dwordx4 v[42:45], v13, s[8:11], s36 offen sc1
    s_add_u32 s36, s36, 74752
    buffer_store_dwordx4 v[42:45], v13, s[8:11], s36 offen sc1
    s_add_u32 s36, s36, 74752
    buffer_store_dwordx4 v[42:45], v13, s[8:11], s36 offen sc1
    s_add_u32 s36, s36, 74752
    buffer_store_dwordx4 v[42:45], v13, s[8:11], s36 offen sc1
    s_add_u32 s36, s36, 74752
    buffer_store_dwordx4 v[42:45], v13, s[8:11], s36 offen sc1
    s_add_u32 s36, s36, 74752
    buffer_store_dwordx4 v[42:45], v13, s[8:11], s36 offen sc1
    s_add_u32 s36, s36, 74752
    buffer_store_dwordx4 v[42:45], v13, s[8:11], s36 offen sc1
    s_add_u32 s36, s36, 74752
    buffer_store_dwordx4 v[42:45], v13, s[8:11], s36 offen sc1
    s_add_u32 s36, s36, 74752
    buffer_store_dwordx4 v[42:45], v13, s[8:11], s36 offen sc1
    s_add_u32 s36, s36, 74752
L_xinv:
    s_lshl_b32 s37, s39, 2
    s_add_u32 s37, s37, 32
    s_waitcnt vmcnt(0)
    s_barrier
    s_cmp_lg_u32 s33, 0
    s_cbranch_scc1 L_sigxt
    v_mov_b32 v2, s37
    v_mov_b32 v3, 1
    s_mov_b64 exec, 1
    buffer_atomic_add v3, v2, s[20:23], 0 offen
    s_mov_b64 exec, -1
L_sigxt:
    v_lshrrev_b32 v2, 4, v0
    v_mov_b32 v42, 0
    v_lshrrev_b32 v3, 3, v2
    v_mov_b32 v43, 128
    v_cmp_eq_u32 vcc, 5, v3
    s_nop 1
    v_cndmask_b32 v42, v42, v43, vcc
    v_cmp_eq_u32 vcc, 6, v3
    s_nop 1
    v_cndmask_b32 v42, v42, v43, vcc
    v_mov_b32 v43, 1280
    v_cmp_eq_u32 vcc, 25, v2
    s_nop 1
    v_cndmask_b32 v42, v42, v43, vcc
    v_mov_b32 v43, 96
    v_cmp_eq_u32 vcc, 2, v2
    s_nop 1
    v_cndmask_b32 v42, v42, v43, vcc
    v_mov_b32 v43, 32
    v_cmp_eq_u32 vcc, 3, v2
    s_nop 1
    v_cndmask_b32 v42, v42, v43, vcc
    s_add_u32 s37, s39, 8
    v_cmp_eq_u32 vcc, s37, v2
    s_nop 1
    v_cndmask_b32 v42, v42, v43, vcc
    v_lshlrev_b32 v2, 2, v2
    s_cmp_lg_u32 s33, 0
    s_cbranch_scc1 L_xw_done
L_xw:
    buffer_load_dword v3, v2, s[20:23], 0 offen sc1
    s_add_u32 s54, s54, 1
    s_waitcnt vmcnt(0)
    v_cmp_lt_u32 vcc, v3, v42
    s_cbranch_vccz L_xw_done
    s_cmp_gt_u32 s54, 300000
    s_cbranch_scc1 L_xw_done
    s_sleep 32
    s_branch L_xw
L_xw_done:
    s_barrier
    s_lshl_b32 s36, s32, 12
    s_add_u32 s36, s36, 68157440
    buffer_load_dwordx4 v[64:67], v0, s[8:11], s36 offen offset:0 sc1
    buffer_load_dwordx4 v[68:71], v0, s[8:11], s36 offen offset:1024 sc1
    buffer_load_dwordx4 v[72:75], v0, s[8:11], s36 offen offset:2048 sc1
    buffer_load_dwordx4 v[76:79], v0, s[8:11], s36 offen offset:3072 sc1
    buffer_load_dwordx4 v[160:163], v17, s[8:11], s36 offen offset:0 sc1
    buffer_load_dwordx4 v[164:167], v17, s[8:11], s36 offen offset:2048 sc1
    s_add_u32 s36, s36, 131072
    buffer_load_dwordx4 v[80:83], v0, s[8:11], s36 offen offset:0 sc1
    buffer_load_dwordx4 v[84:87], v0, s[8:11], s36 offen offset:1024 sc1
    buffer_load_dwordx4 v[88:91], v0, s[8:11], s36 offen offset:2048 sc1
    buffer_load_dwordx4 v[92:95], v0, s[8:11], s36 offen offset:3072 sc1
    buffer_load_dwordx4 v[168:171], v17, s[8:11], s36 offen offset:0 sc1
    buffer_load_dwordx4 v[172:175], v17, s[8:11], s36 offen offset:2048 sc1
    s_add_u32 s36, s36, 131072
    buffer_load_dwordx4 v[96:99], v0, s[8:11], s36 offen offset:0 sc1
    buffer_load_dwordx4 v[100:103], v0, s[8:11], s36 offen offset:1024 sc1
    buffer_load_dwordx4 v[104:107], v0, s[8:11], s36 offen offset:2048 sc1
    buffer_load_dwordx4 v[108:111], v0, s[8:11], s36 offen offset:3072 sc1
    buffer_load_dwordx4 v[176:179], v17, s[8:11], s36 offen offset:0 sc1
    buffer_load_dwordx4 v[180:183], v17, s[8:11], s36 offen offset:2048 sc1
    s_add_u32 s36, s36, 131072
    buffer_load_dwordx4 v[112:115], v0, s[8:11], s36 offen offset:0 sc1
    buffer_load_dwordx4 v[116:119], v0, s[8:11], s36 offen offset:1024 sc1
    buffer_load_dwordx4 v[120:123], v0, s[8:11], s36 offen offset:2048 sc1
    buffer_load_dwordx4 v[124:127], v0, s[8:11], s36 offen offset:3072 sc1
    buffer_load_dwordx4 v[184:187], v17, s[8:11], s36 offen offset:0 sc1
    buffer_load_dwordx4 v[188:191], v17, s[8:11], s36 offen offset:2048 sc1
    s_add_u32 s36, s36, 131072
    s_waitcnt vmcnt(0)
    v_add_f32 v64, v64, v80
    v_add_f32 v65, v65, v81
    v_add_f32 v66, v66, v82
    v_add_f32 v67, v67, v83
    v_add_f32 v68, v68, v84
    v_add_f32 v69, v69, v85
    v_add_f32 v70, v70, v86
    v_add_f32 v71, v71, v87
    v_add_f32 v72, v72, v88
    v_add_f32 v73, v73, v89
    v_add_f32 v74, v74, v90
    v_add_f32 v75, v75, v91
    v_add_f32 v76, v76, v92
    v_add_f32 v77, v77, v93
    v_add_f32 v78, v78, v94
    v_add_f32 v79, v79, v95
    v_add_f32 v160, v160, v168
    v_add_f32 v161, v161, v169
    v_add_f32 v162, v162, v170
    v_add_f32 v163, v163, v171
    v_add_f32 v164, v164, v172
    v_add_f32 v165, v165, v173
    v_add_f32 v166, v166, v174
    v_add_f32 v167, v167, v175
    v_add_f32 v64, v64, v96
    v_add_f32 v65, v65, v97
    v_add_f32 v66, v66, v98
    v_add_f32 v67, v67, v99
    v_add_f32 v68, v68, v100
    v_add_f32 v69, v69, v101
    v_add_f32 v70, v70, v102
    v_add_f32 v71, v71, v103
    v_add_f32 v72, v72, v104
    v_add_f32 v73, v73, v105
    v_add_f32 v74, v74, v106
    v_add_f32 v75, v75, v107
    v_add_f32 v76, v76, v108
    v_add_f32 v77, v77, v109
    v_add_f32 v78, v78, v110
    v_add_f32 v79, v79, v111
    v_add_f32 v160, v160, v176
    v_add_f32 v161, v161, v177
    v_add_f32 v162, v162, v178
    v_add_f32 v163, v163, v179
    v_add_f32 v164, v164, v180
    v_add_f32 v165, v165, v181
    v_add_f32 v166, v166, v182
    v_add_f32 v167, v167, v183
    v_add_f32 v64, v64, v112
    v_add_f32 v65, v65, v113
    v_add_f32 v66, v66, v114
    v_add_f32 v67, v67, v115
    v_add_f32 v68, v68, v116
    v_add_f32 v69, v69, v117
    v_add_f32 v70, v70, v118
    v_add_f32 v71, v71, v119
    v_add_f32 v72, v72, v120
    v_add_f32 v73, v73, v121
    v_add_f32 v74, v74, v122
    v_add_f32 v75, v75, v123
    v_add_f32 v76, v76, v124
    v_add_f32 v77, v77, v125
    v_add_f32 v78, v78, v126
    v_add_f32 v79, v79, v127
    v_add_f32 v160, v160, v184
    v_add_f32 v161, v161, v185
    v_add_f32 v162, v162, v186
    v_add_f32 v163, v163, v187
    v_add_f32 v164, v164, v188
    v_add_f32 v165, v165, v189
    v_add_f32 v166, v166, v190
    v_add_f32 v167, v167, v191
    v_lshlrev_b32 v2, 2, v5
    v_add_u32 v2, 0, v2
    v_cmp_gt_u32 vcc, 9, v2
    v_cvt_pk_bf16_f32 v3, v64, v72
    s_nop 0
    v_cndmask_b32 v22, 0, v3, vcc
    v_cvt_pk_bf16_f32 v3, v68, v76
    v_cndmask_b32 v26, 0, v3, vcc
    v_cvt_pk_bf16_f32 v3, v160, v164
    v_cndmask_b32 v30, 0, v3, vcc
    v_lshlrev_b32 v2, 2, v5
    v_add_u32 v2, 1, v2
    v_cmp_gt_u32 vcc, 9, v2
    v_cvt_pk_bf16_f32 v3, v65, v73
    s_nop 0
    v_cndmask_b32 v23, 0, v3, vcc
    v_cvt_pk_bf16_f32 v3, v69, v77
    v_cndmask_b32 v27, 0, v3, vcc
    v_cvt_pk_bf16_f32 v3, v161, v165
    v_cndmask_b32 v31, 0, v3, vcc
    v_lshlrev_b32 v2, 2, v5
    v_add_u32 v2, 2, v2
    v_cmp_gt_u32 vcc, 9, v2
    v_cvt_pk_bf16_f32 v3, v66, v74
    s_nop 0
    v_cndmask_b32 v24, 0, v3, vcc
    v_cvt_pk_bf16_f32 v3, v70, v78
    v_cndmask_b32 v28, 0, v3, vcc
    v_cvt_pk_bf16_f32 v3, v162, v166
    v_cndmask_b32 v32, 0, v3, vcc
    v_lshlrev_b32 v2, 2, v5
    v_add_u32 v2, 3, v2
    v_cmp_gt_u32 vcc, 9, v2
    v_cvt_pk_bf16_f32 v3, v67, v75
    s_nop 0
    v_cndmask_b32 v25, 0, v3, vcc
    v_cvt_pk_bf16_f32 v3, v71, v79
    v_cndmask_b32 v29, 0, v3, vcc
    v_cvt_pk_bf16_f32 v3, v163, v167
    v_cndmask_b32 v33, 0, v3, vcc
    s_mov_b32 s49, s39
    s_lshr_b32 s42, s49, 1
    s_and_b32 s50, s49, 1
    s_lshl_b32 s50, s50, 1
    s_sub_u32 s35, s49, 128
    s_lshr_b32 s36, s35, 2
    s_add_u32 s36, s36, 64
    s_and_b32 s35, s35, 3
    s_cmp_ge_u32 s49, 128
    s_cselect_b32 s42, s36, s42
    s_cselect_b32 s50, s35, s50
    s_cselect_b32 s51, 1, 0
    s_add_u32 s36, s39, 33
    s_lshl_b32 s36, s36, 2
    buffer_load_dword v2, off, s[20:23], s36 sc1
    s_waitcnt vmcnt(0)
    v_readfirstlane_b32 s36, v2
    s_nop 3
    s_cmp_lt_u32 s36, 32
    s_cbranch_scc1 L_xslow
    s_lshl_b32 s35, s42, 5
    s_add_u32 s35, s35, s32
    s_lshl_b32 s40, s35, 14
    s_lshl_b32 s41, s35, 13
    s_add_u32 s41, s41, 33554432
    s_lshl_b32 s43, s35, 11
    s_add_u32 s43, s43, 62914560
    s_lshl_b32 s38, s42, 7
    s_add_u32 s38, s38, 67108864
    buffer_load_dwordx4 v[64:67], v0, s[8:11], s40 offen offset:0 sc1
    buffer_load_dwordx4 v[68:71], v0, s[8:11], s40 offen offset:1024 sc1
    buffer_load_dwordx4 v[72:75], v0, s[8:11], s40 offen offset:2048 sc1
    buffer_load_dwordx4 v[76:79], v0, s[8:11], s40 offen offset:3072 sc1
    s_add_u32 s40, s40, 4096
    buffer_load_dwordx4 v[80:83], v0, s[8:11], s40 offen offset:0 sc1
    buffer_load_dwordx4 v[84:87], v0, s[8:11], s40 offen offset:1024 sc1
    buffer_load_dwordx4 v[88:91], v0, s[8:11], s40 offen offset:2048 sc1
    buffer_load_dwordx4 v[92:95], v0, s[8:11], s40 offen offset:3072 sc1
    s_add_u32 s40, s40, 4096
    buffer_load_dwordx4 v[96:99], v0, s[8:11], s40 offen offset:0 sc1
    buffer_load_dwordx4 v[100:103], v0, s[8:11], s40 offen offset:1024 sc1
    buffer_load_dwordx4 v[104:107], v0, s[8:11], s40 offen offset:2048 sc1
    buffer_load_dwordx4 v[108:111], v0, s[8:11], s40 offen offset:3072 sc1
    s_add_u32 s40, s40, 4096
    buffer_load_dwordx4 v[112:115], v0, s[8:11], s40 offen offset:0 sc1
    buffer_load_dwordx4 v[116:119], v0, s[8:11], s40 offen offset:1024 sc1
    buffer_load_dwordx4 v[120:123], v0, s[8:11], s40 offen offset:2048 sc1
    buffer_load_dwordx4 v[124:127], v0, s[8:11], s40 offen offset:3072 sc1
    s_mov_b64 exec, s[60:61]
    buffer_load_dwordx4 v[128:131], v6, s[8:11], s41 offen offset:0 sc1
    buffer_load_dwordx4 v[136:139], v6, s[8:11], s41 offen offset:2048 sc1
    s_add_u32 s36, s41, 4096
    buffer_load_dwordx4 v[144:147], v6, s[8:11], s36 offen offset:0 sc1
    buffer_load_dwordx4 v[152:155], v6, s[8:11], s36 offen offset:2048 sc1
    s_mov_b64 exec, s[62:63]
    buffer_load_dwordx4 v[132:135], v6, s[8:11], s41 offen offset:0 sc1
    buffer_load_dwordx4 v[140:143], v6, s[8:11], s41 offen offset:2048 sc1
    s_add_u32 s36, s41, 4096
    buffer_load_dwordx4 v[148:151], v6, s[8:11], s36 offen offset:0 sc1
    buffer_load_dwordx4 v[156:159], v6, s[8:11], s36 offen offset:2048 sc1
    s_mov_b64 exec, -1
    buffer_load_dwordx4 v[42:45], v6, s[8:11], s43 offen sc1
    buffer_load_dwordx2 v[46:47], v15, s[8:11], s38 offen sc1
    buffer_load_dword v48, v16, s[8:11], s38 offen sc1
    s_mov_b32 s57, 0
    s_mov_b32 s48, 0
L_xs_:
    s_lshl_b32 s35, s42, 5
    s_add_u32 s35, s35, s32
    s_lshl_b32 s44, s35, 12
    s_add_u32 s44, s44, 50331648
    s_and_b32 s35, s57, 1
    s_mul_i32 s45, s35, 1196032
    s_add_u32 s45, s45, s93
    s_bfe_u32 s95, s57, 0x10001
    s_mul_i32 s47, s32, 9344
    s_add_u32 s47, s47, s45
    s_lshl_b32 s36, s33, 11
    s_add_u32 s47, s47, s36
    s_lshl_b32 s36, s33, 10
    s_add_u32 s36, s36, s44
    s_add_u32 s37, s44, 131072
    s_mul_i32 s35, s50, 2560
    v_add_u32 v4, s35, v10
    v_add_u32 v5, s35, v11
    s_waitcnt vmcnt(0)
    v_mfma_f32_16x16x32_bf16 v[52:55], v[64:67], v[128:131], v[18:21]
    v_mfma_f32_16x16x32_bf16 v[52:55], v[68:71], v[132:135], v[52:55]
    v_mfma_f32_16x16x32_bf16 v[52:55], v[72:75], v[136:139], v[52:55]
    v_mfma_f32_16x16x32_bf16 v[52:55], v[76:79], v[140:143], v[52:55]
    v_mfma_f32_16x16x32_bf16 v[52:55], v[80:83], v[144:147], v[52:55]
    v_mfma_f32_16x16x32_bf16 v[52:55], v[84:87], v[148:151], v[52:55]
    v_mfma_f32_16x16x32_bf16 v[52:55], v[88:91], v[152:155], v[52:55]
    v_mfma_f32_16x16x32_bf16 v[52:55], v[92:95], v[156:159], v[52:55]
    v_mfma_f32_16x16x32_bf16 v[224:227], v[22:25], v[42:45], 0
    v_mfma_f32_16x16x32_bf16 v[228:231], v[26:29], v[42:45], 0
    v_mfma_f32_16x16x32_bf16 v[232:235], v[30:33], v[42:45], 0
    v_sub_f32 v48, 1.0, v48
    s_nop 6
    v_add_f32 v232, 0x358637bd, v232
    v_rcp_f32 v232, v232
    s_nop 0
    v_mul_f32 v232, v232, v48
    v_mul_f32 v224, v224, v232
    v_mul_f32 v228, v228, v232
    v_cvt_pk_bf16_f32 v42, v224, v228
    v_mul_f32 v225, v225, v232
    v_mul_f32 v229, v229, v232
    v_cvt_pk_bf16_f32 v43, v225, v229
    v_mul_f32 v226, v226, v232
    v_mul_f32 v230, v230, v232
    v_cvt_pk_bf16_f32 v44, v226, v230
    v_mul_f32 v227, v227, v232
    v_mul_f32 v231, v231, v232
    v_cvt_pk_bf16_f32 v45, v227, v231
    v_mov_b64 v[224:225], 0
    v_mov_b64 v[226:227], 0
    v_mov_b64 v[228:229], 0
    v_mov_b64 v[230:231], 0
    v_mov_b64 v[232:233], 0
    v_mov_b64 v[234:235], 0
    v_mov_b64 v[236:237], 0
    v_mov_b64 v[238:239], 0
    v_mov_b64 v[240:241], 0
    v_mov_b64 v[242:243], 0
    v_mov_b64 v[244:245], 0
    v_mov_b64 v[246:247], 0
    v_mov_b64 v[248:249], 0
    v_mov_b64 v[250:251], 0
    v_mov_b64 v[252:253], 0
    v_mov_b64 v[254:255], 0
    s_add_u32 s38, s42, 0
    s_cmp_le_u32 s38, s48
    s_cbranch_scc1 L_xp_
L_xg_:
    buffer_load_dword v2, off, s[20:23], 0 offset:96 sc1
    s_add_u32 s54, s54, 1
    s_waitcnt vmcnt(0)
    v_readfirstlane_b32 s48, v2
    s_cmp_gt_u32 s54, 300000
    s_cbranch_scc1 L_xp_
    s_cmp_le_u32 s38, s48
    s_cbranch_scc1 L_xp_
    s_sleep 4
    s_branch L_xg_
L_xp_:
    buffer_load_dwordx2 v[50:51], v0, s[8:11], s36 offen sc1
    buffer_load_dword v192, v0, s[8:11], s37 offen offset:8 sc1
    buffer_load_dword v196, v0, s[8:11], s37 offen offset:12 sc1
    buffer_load_dword v200, v0, s[8:11], s37 offen offset:1032 sc1
    buffer_load_dword v204, v0, s[8:11], s37 offen offset:1036 sc1
    buffer_load_dword v208, v0, s[8:11], s37 offen offset:2056 sc1
    buffer_load_dword v212, v0, s[8:11], s37 offen offset:2060 sc1
    buffer_load_dword v216, v0, s[8:11], s37 offen offset:3080 sc1
    buffer_load_dword v220, v0, s[8:11], s37 offen offset:3084 sc1
    s_add_u32 s54, s54, 1
    s_waitcnt vmcnt(0)
    v_max3_u32 v2, v50, v51, v192
    v_max3_u32 v2, v2, v196, v200
    v_max3_u32 v2, v2, v204, v208
    v_max3_u32 v2, v2, v212, v216
    v_max_u32 v2, v2, v220
    v_cmp_eq_u32 vcc, -1, v2
    s_cbranch_vccz L_xp_ok_
    s_cmp_gt_u32 s54, 300000
    s_cbranch_scc1 L_xp_ok_
    s_sleep 1
    s_branch L_xp_
L_xp_ok_:
    ds_write2_b32 v7, v50, v51 offset0:0 offset1:16
    s_waitcnt lgkmcnt(0)
    s_barrier
    ds_read_b128 v[160:163], v8 offset:0
    ds_read_b128 v[164:167], v8 offset:64
    ds_read_b128 v[168:171], v8 offset:512
    ds_read_b128 v[172:175], v8 offset:576
    ds_read_b128 v[176:179], v8 offset:1024
    ds_read_b128 v[180:183], v8 offset:1088
    ds_read_b128 v[184:187], v8 offset:1536
    ds_read_b128 v[188:191], v8 offset:1600
    s_mul_i32 s35, s33, 2560
    v_add_u32 v2, s35, v10
    ds_write_b128 v2, v[42:45] offset:2048
    s_waitcnt lgkmcnt(8)
    v_mfma_f32_16x16x32_bf16 v[56:59], v[160:163], v[128:131], 0
    s_waitcnt lgkmcnt(7)
    v_mfma_f32_16x16x32_bf16 v[56:59], v[164:167], v[132:135], v[56:59]
    s_waitcnt lgkmcnt(6)
    v_mfma_f32_16x16x32_bf16 v[56:59], v[168:171], v[136:139], v[56:59]
    s_waitcnt lgkmcnt(5)
    v_mfma_f32_16x16x32_bf16 v[56:59], v[172:175], v[140:143], v[56:59]
    s_waitcnt lgkmcnt(4)
    v_mfma_f32_16x16x32_bf16 v[56:59], v[176:179], v[144:147], v[56:59]
    s_waitcnt lgkmcnt(3)
    v_mfma_f32_16x16x32_bf16 v[56:59], v[180:183], v[148:151], v[56:59]
    s_waitcnt lgkmcnt(2)
    v_mfma_f32_16x16x32_bf16 v[56:59], v[184:187], v[152:155], v[56:59]
    s_waitcnt lgkmcnt(1)
    v_mfma_f32_16x16x32_bf16 v[56:59], v[188:191], v[156:159], v[56:59]
    v_max3_f32 v2, v52, v53, v54
    s_nop 6
    v_max3_f32 v2, v2, v55, v56
    s_nop 1
    v_max_f32_dpp v2, v2, v2 quad_perm:[2,3,0,1] row_mask:0xf bank_mask:0xf
    v_mov_b32 v3, v2
    s_nop 1
    v_permlane16_swap_b32 v3, v2
    v_max_f32 v2, v2, v3
    v_mov_b32 v3, v2
    s_nop 1
    v_permlane32_swap_b32 v3, v2
    v_max_f32 v2, v2, v3
    v_mul_f32 v2, s56, v2
    v_fma_f32 v52, v52, s56, -v2
    v_fma_f32 v53, v53, s56, -v2
    v_fma_f32 v54, v54, s56, -v2
    v_fma_f32 v55, v55, s56, -v2
    v_fma_f32 v56, v56, s56, -v2
    v_exp_f32 v52, v52
    v_exp_f32 v53, v53
    v_exp_f32 v54, v54
    v_exp_f32 v55, v55
    v_exp_f32 v56, v56
    v_mov_b32 v63, 0
    v_cvt_pk_bf16_f32 v60, v52, v53
    v_cvt_pk_bf16_f32 v61, v54, v55
    v_cvt_pk_bf16_f32 v62, v56, v63
    s_nop 1
    v_mfma_f32_16x16x32_bf16 v[56:59], v[60:63], v[38:41], 0
    v_smfmac_f32_16x16x32_bf16 v[224:227], v[60:61], v[96:99], v1
    v_smfmac_f32_16x16x32_bf16 v[228:231], v[60:61], v[100:103], v1
    v_smfmac_f32_16x16x32_bf16 v[232:235], v[60:61], v[104:107], v1
    v_smfmac_f32_16x16x32_bf16 v[236:239], v[60:61], v[108:111], v1
    v_smfmac_f32_16x16x32_bf16 v[240:243], v[60:61], v[112:115], v1
    v_smfmac_f32_16x16x32_bf16 v[244:247], v[60:61], v[116:119], v1
    v_smfmac_f32_16x16x32_bf16 v[248:251], v[60:61], v[120:123], v1
    v_smfmac_f32_16x16x32_bf16 v[252:255], v[60:61], v[124:127], v1
    v_smfmac_f32_16x16x32_bf16 v[224:227], v[62:63], v[192:195], v1 abid:2
    v_smfmac_f32_16x16x32_bf16 v[228:231], v[62:63], v[196:199], v1 abid:2
    v_smfmac_f32_16x16x32_bf16 v[232:235], v[62:63], v[200:203], v1 abid:2
    v_smfmac_f32_16x16x32_bf16 v[236:239], v[62:63], v[204:207], v1 abid:2
    v_smfmac_f32_16x16x32_bf16 v[240:243], v[62:63], v[208:211], v1 abid:2
    v_smfmac_f32_16x16x32_bf16 v[244:247], v[62:63], v[212:215], v1 abid:2
    v_smfmac_f32_16x16x32_bf16 v[248:251], v[62:63], v[216:219], v1 abid:2
    v_smfmac_f32_16x16x32_bf16 v[252:255], v[62:63], v[220:223], v1 abid:2
    v_add_f32 v56, v56, v58
    v_add_f32 v57, v57, v59
    v_rcp_f32 v56, v56
    v_rcp_f32 v57, v57
    v_mul_f32 v56, v56, v46
    v_mul_f32 v57, v57, v47
    v_add_f32 v224, v224, v226
    v_add_f32 v228, v228, v230
    v_mul_f32 v224, v224, v56
    v_mul_f32 v228, v228, v56
    v_cvt_pk_bf16_f32 v226, v224, v228
    v_add_f32 v225, v225, v227
    v_add_f32 v229, v229, v231
    v_mul_f32 v225, v225, v57
    v_mul_f32 v229, v229, v57
    v_cvt_pk_bf16_f32 v227, v225, v229
    ds_write2_b32 v9, v226, v227 offset0:0 offset1:4
    v_add_f32 v232, v232, v234
    v_add_f32 v236, v236, v238
    v_mul_f32 v232, v232, v56
    v_mul_f32 v236, v236, v56
    v_cvt_pk_bf16_f32 v234, v232, v236
    v_add_f32 v233, v233, v235
    v_add_f32 v237, v237, v239
    v_mul_f32 v233, v233, v57
    v_mul_f32 v237, v237, v57
    v_cvt_pk_bf16_f32 v235, v233, v237
    ds_write2_b32 v9, v234, v235 offset0:128 offset1:132
    v_add_f32 v240, v240, v242
    v_add_f32 v244, v244, v246
    v_mul_f32 v240, v240, v56
    v_mul_f32 v244, v244, v56
    v_cvt_pk_bf16_f32 v242, v240, v244
    v_add_f32 v241, v241, v243
    v_add_f32 v245, v245, v247
    v_mul_f32 v241, v241, v57
    v_mul_f32 v245, v245, v57
    v_cvt_pk_bf16_f32 v243, v241, v245
    ds_write_b32 v9, v242 offset:1024
    ds_write_b32 v9, v243 offset:1040
    v_add_f32 v248, v248, v250
    v_add_f32 v252, v252, v254
    v_mul_f32 v248, v248, v56
    v_mul_f32 v252, v252, v56
    v_cvt_pk_bf16_f32 v250, v248, v252
    v_add_f32 v249, v249, v251
    v_add_f32 v253, v253, v255
    v_mul_f32 v249, v249, v57
    v_mul_f32 v253, v253, v57
    v_cvt_pk_bf16_f32 v251, v249, v253
    ds_write_b32 v9, v250 offset:1536
    ds_write_b32 v9, v251 offset:1552
    s_waitcnt lgkmcnt(0)
    s_barrier
    ds_read_b128 a[184:187], v4 offset:0
    ds_read_b128 a[188:191], v4 offset:512
    ds_read_b128 a[192:195], v4 offset:1024
    ds_read_b128 a[196:199], v4 offset:1536
    ds_read_b128 a[200:203], v4 offset:2048
    ds_read_b128 a[204:207], v5 offset:0
    ds_read_b128 a[208:211], v5 offset:512
    v_mov_b64 v[160:161], 0
    v_mov_b64 v[162:163], 0
    v_mov_b64 v[164:165], 0
    v_mov_b64 v[166:167], 0
    v_mov_b64 v[168:169], 0
    v_mov_b64 v[170:171], 0
    v_mov_b64 v[172:173], 0
    v_mov_b64 v[174:175], 0
    v_mov_b64 v[176:177], 0
    v_mov_b64 v[178:179], 0
    s_waitcnt lgkmcnt(0)
    ds_read_b128 a[212:215], v4 offset:2560
    ds_read_b128 a[216:219], v4 offset:3072
    ds_read_b128 a[220:223], v4 offset:3584
    ds_read_b128 a[224:227], v4 offset:4096
    ds_read_b128 a[228:231], v4 offset:4608
    ds_read_b128 a[232:235], v5 offset:2560
    ds_read_b128 a[236:239], v5 offset:3072
    v_smfmac_f32_16x16x64_bf16 v[176:179], a[204:207], a[160:167], v1
    v_smfmac_f32_16x16x64_bf16 v[176:179], a[208:211], a[168:175], v1
    v_smfmac_f32_16x16x64_bf16 v[176:179], a[200:203], a[176:183], v1
    v_smfmac_f32_16x16x64_bf16 v[160:163], a[184:187], a[0:7], v1
    v_smfmac_f32_16x16x64_bf16 v[160:163], a[188:191], a[8:15], v1
    v_smfmac_f32_16x16x64_bf16 v[160:163], a[192:195], a[16:23], v1
    v_smfmac_f32_16x16x64_bf16 v[160:163], a[196:199], a[24:31], v1
    v_smfmac_f32_16x16x64_bf16 v[160:163], a[200:203], a[32:39], v1
    v_smfmac_f32_16x16x64_bf16 v[164:167], a[184:187], a[40:47], v1
    v_smfmac_f32_16x16x64_bf16 v[164:167], a[188:191], a[48:55], v1
    v_smfmac_f32_16x16x64_bf16 v[164:167], a[192:195], a[56:63], v1
    v_smfmac_f32_16x16x64_bf16 v[164:167], a[196:199], a[64:71], v1
    v_smfmac_f32_16x16x64_bf16 v[164:167], a[200:203], a[72:79], v1
    v_smfmac_f32_16x16x64_bf16 v[168:171], a[184:187], a[80:87], v1
    v_smfmac_f32_16x16x64_bf16 v[168:171], a[188:191], a[88:95], v1
    v_smfmac_f32_16x16x64_bf16 v[168:171], a[192:195], a[96:103], v1
    v_smfmac_f32_16x16x64_bf16 v[168:171], a[196:199], a[104:111], v1
    v_smfmac_f32_16x16x64_bf16 v[168:171], a[200:203], a[112:119], v1
    v_smfmac_f32_16x16x64_bf16 v[172:175], a[184:187], a[120:127], v1
    v_smfmac_f32_16x16x64_bf16 v[172:175], a[188:191], a[128:135], v1
    v_smfmac_f32_16x16x64_bf16 v[172:175], a[192:195], a[136:143], v1
    v_smfmac_f32_16x16x64_bf16 v[172:175], a[196:199], a[144:151], v1
    v_smfmac_f32_16x16x64_bf16 v[172:175], a[200:203], a[152:159], v1
    v_add_f32 v176, v176, v178
    v_add_f32 v177, v177, v179
    v_cndmask_b32 v178, v176, v177, s[58:59]
    s_nop 1
    v_mov_b32_dpp v179, v178 quad_perm:[1,0,3,2] row_mask:0xf bank_mask:0xf
    v_cndmask_b32 v176, v179, v176, s[58:59]
    v_cndmask_b32 v177, v177, v179, s[58:59]
    v_cvt_pk_bf16_f32 v176, v176, v177
    v_and_or_b32 v176, v176, -2, s95
    buffer_store_dword v176, v12, s[8:11], s47 offen
    v_cvt_pk_bf16_f32 v160, v160, v162
    v_cvt_pk_bf16_f32 v162, v161, v163
    v_cvt_pk_bf16_f32 v161, v164, v166
    v_cvt_pk_bf16_f32 v163, v165, v167
    v_and_or_b32 v160, v160, -2, s95
    v_and_or_b32 v162, v162, -2, s95
    buffer_store_dwordx4 v[160:163], v0, s[8:11], s47 offen offset:0
    v_cvt_pk_bf16_f32 v168, v168, v170
    v_cvt_pk_bf16_f32 v170, v169, v171
    v_cvt_pk_bf16_f32 v169, v172, v174
    v_cvt_pk_bf16_f32 v171, v173, v175
    v_and_or_b32 v168, v168, -2, s95
    v_and_or_b32 v170, v170, -2, s95
    buffer_store_dwordx4 v[168:171], v0, s[8:11], s47 offen offset:1024
    s_add_u32 s47, s47, 299008
    s_cmp_eq_u32 s51, 1
    s_cbranch_scc1 L_xq1_
    v_mov_b64 v[224:225], 0
    v_mov_b64 v[226:227], 0
    v_mov_b64 v[228:229], 0
    v_mov_b64 v[230:231], 0
    v_mov_b64 v[232:233], 0
    v_mov_b64 v[234:235], 0
    v_mov_b64 v[236:237], 0
    v_mov_b64 v[238:239], 0
    v_mov_b64 v[240:241], 0
    v_mov_b64 v[242:243], 0
    s_waitcnt lgkmcnt(0)
    s_nop 0
    v_smfmac_f32_16x16x64_bf16 v[240:243], a[232:235], a[160:167], v1
    v_smfmac_f32_16x16x64_bf16 v[240:243], a[236:239], a[168:175], v1
    v_smfmac_f32_16x16x64_bf16 v[240:243], a[228:231], a[176:183], v1
    v_smfmac_f32_16x16x64_bf16 v[224:227], a[212:215], a[0:7], v1
    v_smfmac_f32_16x16x64_bf16 v[224:227], a[216:219], a[8:15], v1
    v_smfmac_f32_16x16x64_bf16 v[224:227], a[220:223], a[16:23], v1
    v_smfmac_f32_16x16x64_bf16 v[224:227], a[224:227], a[24:31], v1
    v_smfmac_f32_16x16x64_bf16 v[224:227], a[228:231], a[32:39], v1
    v_smfmac_f32_16x16x64_bf16 v[228:231], a[212:215], a[40:47], v1
    v_smfmac_f32_16x16x64_bf16 v[228:231], a[216:219], a[48:55], v1
    v_smfmac_f32_16x16x64_bf16 v[228:231], a[220:223], a[56:63], v1
    v_smfmac_f32_16x16x64_bf16 v[228:231], a[224:227], a[64:71], v1
    v_smfmac_f32_16x16x64_bf16 v[228:231], a[228:231], a[72:79], v1
    v_smfmac_f32_16x16x64_bf16 v[232:235], a[212:215], a[80:87], v1
    v_smfmac_f32_16x16x64_bf16 v[232:235], a[216:219], a[88:95], v1
    v_smfmac_f32_16x16x64_bf16 v[232:235], a[220:223], a[96:103], v1
    v_smfmac_f32_16x16x64_bf16 v[232:235], a[224:227], a[104:111], v1
    v_smfmac_f32_16x16x64_bf16 v[232:235], a[228:231], a[112:119], v1
    v_smfmac_f32_16x16x64_bf16 v[236:239], a[212:215], a[120:127], v1
    v_smfmac_f32_16x16x64_bf16 v[236:239], a[216:219], a[128:135], v1
    v_smfmac_f32_16x16x64_bf16 v[236:239], a[220:223], a[136:143], v1
    v_smfmac_f32_16x16x64_bf16 v[236:239], a[224:227], a[144:151], v1
    v_smfmac_f32_16x16x64_bf16 v[236:239], a[228:231], a[152:159], v1
    v_add_f32 v240, v240, v242
    v_add_f32 v241, v241, v243
    v_cndmask_b32 v242, v240, v241, s[58:59]
    s_nop 1
    v_mov_b32_dpp v243, v242 quad_perm:[1,0,3,2] row_mask:0xf bank_mask:0xf
    v_cndmask_b32 v240, v243, v240, s[58:59]
    v_cndmask_b32 v241, v241, v243, s[58:59]
    v_cvt_pk_bf16_f32 v240, v240, v241
    v_and_or_b32 v240, v240, -2, s95
    buffer_store_dword v240, v12, s[8:11], s47 offen
    v_cvt_pk_bf16_f32 v224, v224, v226
    v_cvt_pk_bf16_f32 v226, v225, v227
    v_cvt_pk_bf16_f32 v225, v228, v230
    v_cvt_pk_bf16_f32 v227, v229, v231
    v_and_or_b32 v224, v224, -2, s95
    v_and_or_b32 v226, v226, -2, s95
    buffer_store_dwordx4 v[224:227], v0, s[8:11], s47 offen offset:0
    v_cvt_pk_bf16_f32 v232, v232, v234
    v_cvt_pk_bf16_f32 v234, v233, v235
    v_cvt_pk_bf16_f32 v233, v236, v238
    v_cvt_pk_bf16_f32 v235, v237, v239
    v_and_or_b32 v232, v232, -2, s95
    v_and_or_b32 v234, v234, -2, s95
    buffer_store_dwordx4 v[232:235], v0, s[8:11], s47 offen offset:1024
    s_add_u32 s47, s47, 299008
L_xq1_:
    s_waitcnt lgkmcnt(0)
    s_cmp_ge_u32 s46, 72
    s_cbranch_scc1 L_xs_next_
    s_lshl_b32 s36, s42, 2
    s_add_u32 s36, s36, s50
    s_mul_i32 s36, s36, 9216
L_xr_:
    s_mov_b32 s37, s45
    buffer_load_dwordx4 v[160:163], v13, s[8:11], s37 offen sc1
    s_add_u32 s37, s37, 74752
    buffer_load_dwordx4 v[164:167], v13, s[8:11], s37 offen sc1
    s_add_u32 s37, s37, 74752
    buffer_load_dwordx4 v[168:171], v13, s[8:11], s37 offen sc1
    s_add_u32 s37, s37, 74752
    buffer_load_dwordx4 v[172:175], v13, s[8:11], s37 offen sc1
    s_add_u32 s37, s37, 74752
    s_cmp_eq_u32 s51, 1
    s_cselect_b32 s37, s45, s37
    buffer_load_dwordx4 v[176:179], v13, s[8:11], s37 offen sc1
    s_add_u32 s37, s37, 74752
    buffer_load_dwordx4 v[180:183], v13, s[8:11], s37 offen sc1
    s_add_u32 s37, s37, 74752
    buffer_load_dwordx4 v[184:187], v13, s[8:11], s37 offen sc1
    s_add_u32 s37, s37, 74752
    buffer_load_dwordx4 v[188:191], v13, s[8:11], s37 offen sc1
    s_add_u32 s37, s37, 74752
    v_mov_b64 v[48:49], 0
    v_mov_b64 v[50:51], 0
    v_mov_b64 v[52:53], 0
    v_mov_b64 v[54:55], 0
    v_mov_b64 v[46:47], 0
    s_add_u32 s54, s54, 1
    s_waitcnt vmcnt(4)
    v_smfmac_f32_16x16x64_bf16 v[48:51], v[34:37], v[160:167], v1
    v_smfmac_f32_16x16x64_bf16 v[48:51], v[34:37], v[168:175], v1
    v_bitop3_b32 v46, v46, v160, s95 bitop3:0xf6
    v_bitop3_b32 v47, v47, v161, s95 bitop3:0xf6
    v_bitop3_b32 v46, v46, v162, s95 bitop3:0xf6
    v_bitop3_b32 v47, v47, v163, s95 bitop3:0xf6
    v_bitop3_b32 v46, v46, v164, s95 bitop3:0xf6
    v_bitop3_b32 v47, v47, v165, s95 bitop3:0xf6
    v_bitop3_b32 v46, v46, v166, s95 bitop3:0xf6
    v_bitop3_b32 v47, v47, v167, s95 bitop3:0xf6
    v_bitop3_b32 v46, v46, v168, s95 bitop3:0xf6
    v_bitop3_b32 v47, v47, v169, s95 bitop3:0xf6
    v_bitop3_b32 v46, v46, v170, s95 bitop3:0xf6
    v_bitop3_b32 v47, v47, v171, s95 bitop3:0xf6
    v_bitop3_b32 v46, v46, v172, s95 bitop3:0xf6
    v_bitop3_b32 v47, v47, v173, s95 bitop3:0xf6
    v_bitop3_b32 v46, v46, v174, s95 bitop3:0xf6
    v_bitop3_b32 v47, v47, v175, s95 bitop3:0xf6
    s_waitcnt vmcnt(0)
    v_smfmac_f32_16x16x64_bf16 v[52:55], v[34:37], v[176:183], v1
    v_smfmac_f32_16x16x64_bf16 v[52:55], v[34:37], v[184:191], v1
    v_bitop3_b32 v46, v46, v176, s95 bitop3:0xf6
    v_bitop3_b32 v47, v47, v177, s95 bitop3:0xf6
    v_bitop3_b32 v46, v46, v178, s95 bitop3:0xf6
    v_bitop3_b32 v47, v47, v179, s95 bitop3:0xf6
    v_bitop3_b32 v46, v46, v180, s95 bitop3:0xf6
    v_bitop3_b32 v47, v47, v181, s95 bitop3:0xf6
    v_bitop3_b32 v46, v46, v182, s95 bitop3:0xf6
    v_bitop3_b32 v47, v47, v183, s95 bitop3:0xf6
    v_bitop3_b32 v46, v46, v184, s95 bitop3:0xf6
    v_bitop3_b32 v47, v47, v185, s95 bitop3:0xf6
    v_bitop3_b32 v46, v46, v186, s95 bitop3:0xf6
    v_bitop3_b32 v47, v47, v187, s95 bitop3:0xf6
    v_bitop3_b32 v46, v46, v188, s95 bitop3:0xf6
    v_bitop3_b32 v47, v47, v189, s95 bitop3:0xf6
    v_bitop3_b32 v46, v46, v190, s95 bitop3:0xf6
    v_bitop3_b32 v47, v47, v191, s95 bitop3:0xf6
    v_and_or_b32 v46, v47, s94, v46
    v_and_b32 v46, 1, v46
    v_cmp_ne_u32 vcc, 0, v46
    s_cbranch_vccz L_xr_ok_
    s_cmp_gt_u32 s54, 300000
    s_cbranch_scc0 L_xr_
L_xr_ok_:
    v_add_f32_dpp v48, v48, v48 row_ror:8 row_mask:0xf bank_mask:0xf
    v_add_f32_dpp v49, v49, v49 row_ror:8 row_mask:0xf bank_mask:0xf
    v_add_f32_dpp v50, v50, v50 row_ror:8 row_mask:0xf bank_mask:0xf
    v_add_f32_dpp v51, v51, v51 row_ror:8 row_mask:0xf bank_mask:0xf
    v_cvt_pk_bf16_f32 v48, v48, v49
    v_cvt_pk_bf16_f32 v49, v50, v51
    buffer_store_dwordx2 v[48:49], v14, s[24:27], s36 offen
    s_add_u32 s36, s36, 9216
    s_cmp_eq_u32 s51, 1
    s_cbranch_scc1 L_xs_next_
    v_add_f32_dpp v52, v52, v52 row_ror:8 row_mask:0xf bank_mask:0xf
    v_add_f32_dpp v53, v53, v53 row_ror:8 row_mask:0xf bank_mask:0xf
    v_add_f32_dpp v54, v54, v54 row_ror:8 row_mask:0xf bank_mask:0xf
    v_add_f32_dpp v55, v55, v55 row_ror:8 row_mask:0xf bank_mask:0xf
    v_cvt_pk_bf16_f32 v52, v52, v53
    v_cvt_pk_bf16_f32 v53, v54, v55
    buffer_store_dwordx2 v[52:53], v14, s[24:27], s36 offen
    s_add_u32 s36, s36, 9216
L_xs_next_:
    s_add_u32 s49, s49, 7
    s_lshr_b32 s42, s49, 1
    s_and_b32 s50, s49, 1
    s_lshl_b32 s50, s50, 1
    s_sub_u32 s35, s49, 128
    s_lshr_b32 s36, s35, 2
    s_add_u32 s36, s36, 64
    s_and_b32 s35, s35, 3
    s_cmp_ge_u32 s49, 128
    s_cselect_b32 s42, s36, s42
    s_cselect_b32 s50, s35, s50
    s_cselect_b32 s51, 1, 0
    s_add_u32 s57, s57, 1
    s_cmp_ge_u32 s42, 64
    s_cbranch_scc1 L_xs_end_
    s_lshl_b32 s35, s42, 5
    s_add_u32 s35, s35, s32
    s_lshl_b32 s40, s35, 14
    s_lshl_b32 s41, s35, 13
    s_add_u32 s41, s41, 33554432
    s_lshl_b32 s43, s35, 11
    s_add_u32 s43, s43, 62914560
    s_lshl_b32 s38, s42, 7
    s_add_u32 s38, s38, 67108864
    buffer_load_dwordx4 v[64:67], v0, s[8:11], s40 offen offset:0 sc1
    buffer_load_dwordx4 v[68:71], v0, s[8:11], s40 offen offset:1024 sc1
    buffer_load_dwordx4 v[72:75], v0, s[8:11], s40 offen offset:2048 sc1
    buffer_load_dwordx4 v[76:79], v0, s[8:11], s40 offen offset:3072 sc1
    s_add_u32 s40, s40, 4096
    buffer_load_dwordx4 v[80:83], v0, s[8:11], s40 offen offset:0 sc1
    buffer_load_dwordx4 v[84:87], v0, s[8:11], s40 offen offset:1024 sc1
    buffer_load_dwordx4 v[88:91], v0, s[8:11], s40 offen offset:2048 sc1
    buffer_load_dwordx4 v[92:95], v0, s[8:11], s40 offen offset:3072 sc1
    s_add_u32 s40, s40, 4096
    buffer_load_dwordx4 v[96:99], v0, s[8:11], s40 offen offset:0 sc1
    buffer_load_dwordx4 v[100:103], v0, s[8:11], s40 offen offset:1024 sc1
    buffer_load_dwordx4 v[104:107], v0, s[8:11], s40 offen offset:2048 sc1
    buffer_load_dwordx4 v[108:111], v0, s[8:11], s40 offen offset:3072 sc1
    s_add_u32 s40, s40, 4096
    buffer_load_dwordx4 v[112:115], v0, s[8:11], s40 offen offset:0 sc1
    buffer_load_dwordx4 v[116:119], v0, s[8:11], s40 offen offset:1024 sc1
    buffer_load_dwordx4 v[120:123], v0, s[8:11], s40 offen offset:2048 sc1
    buffer_load_dwordx4 v[124:127], v0, s[8:11], s40 offen offset:3072 sc1
    s_mov_b64 exec, s[60:61]
    buffer_load_dwordx4 v[128:131], v6, s[8:11], s41 offen offset:0 sc1
    buffer_load_dwordx4 v[136:139], v6, s[8:11], s41 offen offset:2048 sc1
    s_add_u32 s36, s41, 4096
    buffer_load_dwordx4 v[144:147], v6, s[8:11], s36 offen offset:0 sc1
    buffer_load_dwordx4 v[152:155], v6, s[8:11], s36 offen offset:2048 sc1
    s_mov_b64 exec, s[62:63]
    buffer_load_dwordx4 v[132:135], v6, s[8:11], s41 offen offset:0 sc1
    buffer_load_dwordx4 v[140:143], v6, s[8:11], s41 offen offset:2048 sc1
    s_add_u32 s36, s41, 4096
    buffer_load_dwordx4 v[148:151], v6, s[8:11], s36 offen offset:0 sc1
    buffer_load_dwordx4 v[156:159], v6, s[8:11], s36 offen offset:2048 sc1
    s_mov_b64 exec, -1
    buffer_load_dwordx4 v[42:45], v6, s[8:11], s43 offen sc1
    buffer_load_dwordx2 v[46:47], v15, s[8:11], s38 offen sc1
    buffer_load_dword v48, v16, s[8:11], s38 offen sc1
    s_branch L_xs_
L_xs_end_:
    s_branch L_xall
L_xslow:
    s_lshl_b32 s35, s42, 5
    s_add_u32 s35, s35, s32
    s_lshl_b32 s40, s35, 14
    s_lshl_b32 s41, s35, 13
    s_add_u32 s41, s41, 33554432
    s_lshl_b32 s43, s35, 11
    s_add_u32 s43, s43, 62914560
    s_lshl_b32 s38, s42, 7
    s_add_u32 s38, s38, 67108864
    buffer_load_dwordx4 v[64:67], v0, s[8:11], s40 offen offset:0 sc1
    buffer_load_dwordx4 v[68:71], v0, s[8:11], s40 offen offset:1024 sc1
    buffer_load_dwordx4 v[72:75], v0, s[8:11], s40 offen offset:2048 sc1
    buffer_load_dwordx4 v[76:79], v0, s[8:11], s40 offen offset:3072 sc1
    s_add_u32 s40, s40, 4096
    buffer_load_dwordx4 v[80:83], v0, s[8:11], s40 offen offset:0 sc1
    buffer_load_dwordx4 v[84:87], v0, s[8:11], s40 offen offset:1024 sc1
    buffer_load_dwordx4 v[88:91], v0, s[8:11], s40 offen offset:2048 sc1
    buffer_load_dwordx4 v[92:95], v0, s[8:11], s40 offen offset:3072 sc1
    s_add_u32 s40, s40, 4096
    buffer_load_dwordx4 v[96:99], v0, s[8:11], s40 offen offset:0 sc1
    buffer_load_dwordx4 v[100:103], v0, s[8:11], s40 offen offset:1024 sc1
    buffer_load_dwordx4 v[104:107], v0, s[8:11], s40 offen offset:2048 sc1
    buffer_load_dwordx4 v[108:111], v0, s[8:11], s40 offen offset:3072 sc1
    s_add_u32 s40, s40, 4096
    buffer_load_dwordx4 v[112:115], v0, s[8:11], s40 offen offset:0 sc1
    buffer_load_dwordx4 v[116:119], v0, s[8:11], s40 offen offset:1024 sc1
    buffer_load_dwordx4 v[120:123], v0, s[8:11], s40 offen offset:2048 sc1
    buffer_load_dwordx4 v[124:127], v0, s[8:11], s40 offen offset:3072 sc1
    s_mov_b64 exec, s[60:61]
    buffer_load_dwordx4 v[128:131], v6, s[8:11], s41 offen offset:0 sc1
    buffer_load_dwordx4 v[136:139], v6, s[8:11], s41 offen offset:2048 sc1
    s_add_u32 s36, s41, 4096
    buffer_load_dwordx4 v[144:147], v6, s[8:11], s36 offen offset:0 sc1
    buffer_load_dwordx4 v[152:155], v6, s[8:11], s36 offen offset:2048 sc1
    s_mov_b64 exec, s[62:63]
    buffer_load_dwordx4 v[132:135], v6, s[8:11], s41 offen offset:0 sc1
    buffer_load_dwordx4 v[140:143], v6, s[8:11], s41 offen offset:2048 sc1
    s_add_u32 s36, s41, 4096
    buffer_load_dwordx4 v[148:151], v6, s[8:11], s36 offen offset:0 sc1
    buffer_load_dwordx4 v[156:159], v6, s[8:11], s36 offen offset:2048 sc1
    s_mov_b64 exec, -1
    buffer_load_dwordx4 v[42:45], v6, s[8:11], s43 offen sc1
    buffer_load_dwordx2 v[46:47], v15, s[8:11], s38 offen sc1
    buffer_load_dword v48, v16, s[8:11], s38 offen sc1
    s_mov_b32 s57, 0
    s_mov_b32 s48, 0
L_xs_sc1:
    s_lshl_b32 s35, s42, 5
    s_add_u32 s35, s35, s32
    s_lshl_b32 s44, s35, 12
    s_add_u32 s44, s44, 50331648
    s_and_b32 s35, s57, 1
    s_mul_i32 s45, s35, 1196032
    s_add_u32 s45, s45, s93
    s_bfe_u32 s95, s57, 0x10001
    s_mul_i32 s47, s32, 9344
    s_add_u32 s47, s47, s45
    s_lshl_b32 s36, s33, 11
    s_add_u32 s47, s47, s36
    s_lshl_b32 s36, s33, 10
    s_add_u32 s36, s36, s44
    s_add_u32 s37, s44, 131072
    s_mul_i32 s35, s50, 2560
    v_add_u32 v4, s35, v10
    v_add_u32 v5, s35, v11
    s_waitcnt vmcnt(0)
    v_mfma_f32_16x16x32_bf16 v[52:55], v[64:67], v[128:131], v[18:21]
    v_mfma_f32_16x16x32_bf16 v[52:55], v[68:71], v[132:135], v[52:55]
    v_mfma_f32_16x16x32_bf16 v[52:55], v[72:75], v[136:139], v[52:55]
    v_mfma_f32_16x16x32_bf16 v[52:55], v[76:79], v[140:143], v[52:55]
    v_mfma_f32_16x16x32_bf16 v[52:55], v[80:83], v[144:147], v[52:55]
    v_mfma_f32_16x16x32_bf16 v[52:55], v[84:87], v[148:151], v[52:55]
    v_mfma_f32_16x16x32_bf16 v[52:55], v[88:91], v[152:155], v[52:55]
    v_mfma_f32_16x16x32_bf16 v[52:55], v[92:95], v[156:159], v[52:55]
    v_mfma_f32_16x16x32_bf16 v[224:227], v[22:25], v[42:45], 0
    v_mfma_f32_16x16x32_bf16 v[228:231], v[26:29], v[42:45], 0
    v_mfma_f32_16x16x32_bf16 v[232:235], v[30:33], v[42:45], 0
    v_sub_f32 v48, 1.0, v48
    s_nop 6
    v_add_f32 v232, 0x358637bd, v232
    v_rcp_f32 v232, v232
    s_nop 0
    v_mul_f32 v232, v232, v48
    v_mul_f32 v224, v224, v232
    v_mul_f32 v228, v228, v232
    v_cvt_pk_bf16_f32 v42, v224, v228
    v_mul_f32 v225, v225, v232
    v_mul_f32 v229, v229, v232
    v_cvt_pk_bf16_f32 v43, v225, v229
    v_mul_f32 v226, v226, v232
    v_mul_f32 v230, v230, v232
    v_cvt_pk_bf16_f32 v44, v226, v230
    v_mul_f32 v227, v227, v232
    v_mul_f32 v231, v231, v232
    v_cvt_pk_bf16_f32 v45, v227, v231
    v_mov_b64 v[224:225], 0
    v_mov_b64 v[226:227], 0
    v_mov_b64 v[228:229], 0
    v_mov_b64 v[230:231], 0
    v_mov_b64 v[232:233], 0
    v_mov_b64 v[234:235], 0
    v_mov_b64 v[236:237], 0
    v_mov_b64 v[238:239], 0
    v_mov_b64 v[240:241], 0
    v_mov_b64 v[242:243], 0
    v_mov_b64 v[244:245], 0
    v_mov_b64 v[246:247], 0
    v_mov_b64 v[248:249], 0
    v_mov_b64 v[250:251], 0
    v_mov_b64 v[252:253], 0
    v_mov_b64 v[254:255], 0
    s_add_u32 s38, s42, 0
    s_cmp_le_u32 s38, s48
    s_cbranch_scc1 L_xp_sc1
L_xg_sc1:
    buffer_load_dword v2, off, s[20:23], 0 offset:96 sc1
    s_add_u32 s54, s54, 1
    s_waitcnt vmcnt(0)
    v_readfirstlane_b32 s48, v2
    s_cmp_gt_u32 s54, 300000
    s_cbranch_scc1 L_xp_sc1
    s_cmp_le_u32 s38, s48
    s_cbranch_scc1 L_xp_sc1
    s_sleep 4
    s_branch L_xg_sc1
L_xp_sc1:
    buffer_load_dwordx2 v[50:51], v0, s[8:11], s36 offen sc1
    buffer_load_dword v192, v0, s[8:11], s37 offen offset:8 sc1
    buffer_load_dword v196, v0, s[8:11], s37 offen offset:12 sc1
    buffer_load_dword v200, v0, s[8:11], s37 offen offset:1032 sc1
    buffer_load_dword v204, v0, s[8:11], s37 offen offset:1036 sc1
    buffer_load_dword v208, v0, s[8:11], s37 offen offset:2056 sc1
    buffer_load_dword v212, v0, s[8:11], s37 offen offset:2060 sc1
    buffer_load_dword v216, v0, s[8:11], s37 offen offset:3080 sc1
    buffer_load_dword v220, v0, s[8:11], s37 offen offset:3084 sc1
    s_add_u32 s54, s54, 1
    s_waitcnt vmcnt(0)
    v_max3_u32 v2, v50, v51, v192
    v_max3_u32 v2, v2, v196, v200
    v_max3_u32 v2, v2, v204, v208
    v_max3_u32 v2, v2, v212, v216
    v_max_u32 v2, v2, v220
    v_cmp_eq_u32 vcc, -1, v2
    s_cbranch_vccz L_xp_ok_sc1
    s_cmp_gt_u32 s54, 300000
    s_cbranch_scc1 L_xp_ok_sc1
    s_sleep 1
    s_branch L_xp_sc1
L_xp_ok_sc1:
    ds_write2_b32 v7, v50, v51 offset0:0 offset1:16
    s_waitcnt lgkmcnt(0)
    s_barrier
    ds_read_b128 v[160:163], v8 offset:0
    ds_read_b128 v[164:167], v8 offset:64
    ds_read_b128 v[168:171], v8 offset:512
    ds_read_b128 v[172:175], v8 offset:576
    ds_read_b128 v[176:179], v8 offset:1024
    ds_read_b128 v[180:183], v8 offset:1088
    ds_read_b128 v[184:187], v8 offset:1536
    ds_read_b128 v[188:191], v8 offset:1600
    s_mul_i32 s35, s33, 2560
    v_add_u32 v2, s35, v10
    ds_write_b128 v2, v[42:45] offset:2048
    s_waitcnt lgkmcnt(8)
    v_mfma_f32_16x16x32_bf16 v[56:59], v[160:163], v[128:131], 0
    s_waitcnt lgkmcnt(7)
    v_mfma_f32_16x16x32_bf16 v[56:59], v[164:167], v[132:135], v[56:59]
    s_waitcnt lgkmcnt(6)
    v_mfma_f32_16x16x32_bf16 v[56:59], v[168:171], v[136:139], v[56:59]
    s_waitcnt lgkmcnt(5)
    v_mfma_f32_16x16x32_bf16 v[56:59], v[172:175], v[140:143], v[56:59]
    s_waitcnt lgkmcnt(4)
    v_mfma_f32_16x16x32_bf16 v[56:59], v[176:179], v[144:147], v[56:59]
    s_waitcnt lgkmcnt(3)
    v_mfma_f32_16x16x32_bf16 v[56:59], v[180:183], v[148:151], v[56:59]
    s_waitcnt lgkmcnt(2)
    v_mfma_f32_16x16x32_bf16 v[56:59], v[184:187], v[152:155], v[56:59]
    s_waitcnt lgkmcnt(1)
    v_mfma_f32_16x16x32_bf16 v[56:59], v[188:191], v[156:159], v[56:59]
    v_max3_f32 v2, v52, v53, v54
    s_nop 6
    v_max3_f32 v2, v2, v55, v56
    s_nop 1
    v_max_f32_dpp v2, v2, v2 quad_perm:[2,3,0,1] row_mask:0xf bank_mask:0xf
    v_mov_b32 v3, v2
    s_nop 1
    v_permlane16_swap_b32 v3, v2
    v_max_f32 v2, v2, v3
    v_mov_b32 v3, v2
    s_nop 1
    v_permlane32_swap_b32 v3, v2
    v_max_f32 v2, v2, v3
    v_mul_f32 v2, s56, v2
    v_fma_f32 v52, v52, s56, -v2
    v_fma_f32 v53, v53, s56, -v2
    v_fma_f32 v54, v54, s56, -v2
    v_fma_f32 v55, v55, s56, -v2
    v_fma_f32 v56, v56, s56, -v2
    v_exp_f32 v52, v52
    v_exp_f32 v53, v53
    v_exp_f32 v54, v54
    v_exp_f32 v55, v55
    v_exp_f32 v56, v56
    v_mov_b32 v63, 0
    v_cvt_pk_bf16_f32 v60, v52, v53
    v_cvt_pk_bf16_f32 v61, v54, v55
    v_cvt_pk_bf16_f32 v62, v56, v63
    s_nop 1
    v_mfma_f32_16x16x32_bf16 v[56:59], v[60:63], v[38:41], 0
    v_smfmac_f32_16x16x32_bf16 v[224:227], v[60:61], v[96:99], v1
    v_smfmac_f32_16x16x32_bf16 v[228:231], v[60:61], v[100:103], v1
    v_smfmac_f32_16x16x32_bf16 v[232:235], v[60:61], v[104:107], v1
    v_smfmac_f32_16x16x32_bf16 v[236:239], v[60:61], v[108:111], v1
    v_smfmac_f32_16x16x32_bf16 v[240:243], v[60:61], v[112:115], v1
    v_smfmac_f32_16x16x32_bf16 v[244:247], v[60:61], v[116:119], v1
    v_smfmac_f32_16x16x32_bf16 v[248:251], v[60:61], v[120:123], v1
    v_smfmac_f32_16x16x32_bf16 v[252:255], v[60:61], v[124:127], v1
    v_smfmac_f32_16x16x32_bf16 v[224:227], v[62:63], v[192:195], v1 abid:2
    v_smfmac_f32_16x16x32_bf16 v[228:231], v[62:63], v[196:199], v1 abid:2
    v_smfmac_f32_16x16x32_bf16 v[232:235], v[62:63], v[200:203], v1 abid:2
    v_smfmac_f32_16x16x32_bf16 v[236:239], v[62:63], v[204:207], v1 abid:2
    v_smfmac_f32_16x16x32_bf16 v[240:243], v[62:63], v[208:211], v1 abid:2
    v_smfmac_f32_16x16x32_bf16 v[244:247], v[62:63], v[212:215], v1 abid:2
    v_smfmac_f32_16x16x32_bf16 v[248:251], v[62:63], v[216:219], v1 abid:2
    v_smfmac_f32_16x16x32_bf16 v[252:255], v[62:63], v[220:223], v1 abid:2
    v_add_f32 v56, v56, v58
    v_add_f32 v57, v57, v59
    v_rcp_f32 v56, v56
    v_rcp_f32 v57, v57
    v_mul_f32 v56, v56, v46
    v_mul_f32 v57, v57, v47
    v_add_f32 v224, v224, v226
    v_add_f32 v228, v228, v230
    v_mul_f32 v224, v224, v56
    v_mul_f32 v228, v228, v56
    v_cvt_pk_bf16_f32 v226, v224, v228
    v_add_f32 v225, v225, v227
    v_add_f32 v229, v229, v231
    v_mul_f32 v225, v225, v57
    v_mul_f32 v229, v229, v57
    v_cvt_pk_bf16_f32 v227, v225, v229
    ds_write2_b32 v9, v226, v227 offset0:0 offset1:4
    v_add_f32 v232, v232, v234
    v_add_f32 v236, v236, v238
    v_mul_f32 v232, v232, v56
    v_mul_f32 v236, v236, v56
    v_cvt_pk_bf16_f32 v234, v232, v236
    v_add_f32 v233, v233, v235
    v_add_f32 v237, v237, v239
    v_mul_f32 v233, v233, v57
    v_mul_f32 v237, v237, v57
    v_cvt_pk_bf16_f32 v235, v233, v237
    ds_write2_b32 v9, v234, v235 offset0:128 offset1:132
    v_add_f32 v240, v240, v242
    v_add_f32 v244, v244, v246
    v_mul_f32 v240, v240, v56
    v_mul_f32 v244, v244, v56
    v_cvt_pk_bf16_f32 v242, v240, v244
    v_add_f32 v241, v241, v243
    v_add_f32 v245, v245, v247
    v_mul_f32 v241, v241, v57
    v_mul_f32 v245, v245, v57
    v_cvt_pk_bf16_f32 v243, v241, v245
    ds_write_b32 v9, v242 offset:1024
    ds_write_b32 v9, v243 offset:1040
    v_add_f32 v248, v248, v250
    v_add_f32 v252, v252, v254
    v_mul_f32 v248, v248, v56
    v_mul_f32 v252, v252, v56
    v_cvt_pk_bf16_f32 v250, v248, v252
    v_add_f32 v249, v249, v251
    v_add_f32 v253, v253, v255
    v_mul_f32 v249, v249, v57
    v_mul_f32 v253, v253, v57
    v_cvt_pk_bf16_f32 v251, v249, v253
    ds_write_b32 v9, v250 offset:1536
    ds_write_b32 v9, v251 offset:1552
    s_waitcnt lgkmcnt(0)
    s_barrier
    ds_read_b128 a[184:187], v4 offset:0
    ds_read_b128 a[188:191], v4 offset:512
    ds_read_b128 a[192:195], v4 offset:1024
    ds_read_b128 a[196:199], v4 offset:1536
    ds_read_b128 a[200:203], v4 offset:2048
    ds_read_b128 a[204:207], v5 offset:0
    ds_read_b128 a[208:211], v5 offset:512
    v_mov_b64 v[160:161], 0
    v_mov_b64 v[162:163], 0
    v_mov_b64 v[164:165], 0
    v_mov_b64 v[166:167], 0
    v_mov_b64 v[168:169], 0
    v_mov_b64 v[170:171], 0
    v_mov_b64 v[172:173], 0
    v_mov_b64 v[174:175], 0
    v_mov_b64 v[176:177], 0
    v_mov_b64 v[178:179], 0
    s_waitcnt lgkmcnt(0)
    ds_read_b128 a[212:215], v4 offset:2560
    ds_read_b128 a[216:219], v4 offset:3072
    ds_read_b128 a[220:223], v4 offset:3584
    ds_read_b128 a[224:227], v4 offset:4096
    ds_read_b128 a[228:231], v4 offset:4608
    ds_read_b128 a[232:235], v5 offset:2560
    ds_read_b128 a[236:239], v5 offset:3072
    v_smfmac_f32_16x16x64_bf16 v[176:179], a[204:207], a[160:167], v1
    v_smfmac_f32_16x16x64_bf16 v[176:179], a[208:211], a[168:175], v1
    v_smfmac_f32_16x16x64_bf16 v[176:179], a[200:203], a[176:183], v1
    v_smfmac_f32_16x16x64_bf16 v[160:163], a[184:187], a[0:7], v1
    v_smfmac_f32_16x16x64_bf16 v[160:163], a[188:191], a[8:15], v1
    v_smfmac_f32_16x16x64_bf16 v[160:163], a[192:195], a[16:23], v1
    v_smfmac_f32_16x16x64_bf16 v[160:163], a[196:199], a[24:31], v1
    v_smfmac_f32_16x16x64_bf16 v[160:163], a[200:203], a[32:39], v1
    v_smfmac_f32_16x16x64_bf16 v[164:167], a[184:187], a[40:47], v1
    v_smfmac_f32_16x16x64_bf16 v[164:167], a[188:191], a[48:55], v1
    v_smfmac_f32_16x16x64_bf16 v[164:167], a[192:195], a[56:63], v1
    v_smfmac_f32_16x16x64_bf16 v[164:167], a[196:199], a[64:71], v1
    v_smfmac_f32_16x16x64_bf16 v[164:167], a[200:203], a[72:79], v1
    v_smfmac_f32_16x16x64_bf16 v[168:171], a[184:187], a[80:87], v1
    v_smfmac_f32_16x16x64_bf16 v[168:171], a[188:191], a[88:95], v1
    v_smfmac_f32_16x16x64_bf16 v[168:171], a[192:195], a[96:103], v1
    v_smfmac_f32_16x16x64_bf16 v[168:171], a[196:199], a[104:111], v1
    v_smfmac_f32_16x16x64_bf16 v[168:171], a[200:203], a[112:119], v1
    v_smfmac_f32_16x16x64_bf16 v[172:175], a[184:187], a[120:127], v1
    v_smfmac_f32_16x16x64_bf16 v[172:175], a[188:191], a[128:135], v1
    v_smfmac_f32_16x16x64_bf16 v[172:175], a[192:195], a[136:143], v1
    v_smfmac_f32_16x16x64_bf16 v[172:175], a[196:199], a[144:151], v1
    v_smfmac_f32_16x16x64_bf16 v[172:175], a[200:203], a[152:159], v1
    v_add_f32 v176, v176, v178
    v_add_f32 v177, v177, v179
    v_cndmask_b32 v178, v176, v177, s[58:59]
    s_nop 1
    v_mov_b32_dpp v179, v178 quad_perm:[1,0,3,2] row_mask:0xf bank_mask:0xf
    v_cndmask_b32 v176, v179, v176, s[58:59]
    v_cndmask_b32 v177, v177, v179, s[58:59]
    v_cvt_pk_bf16_f32 v176, v176, v177
    v_and_or_b32 v176, v176, -2, s95
    buffer_store_dword v176, v12, s[8:11], s47 offen sc1
    v_cvt_pk_bf16_f32 v160, v160, v162
    v_cvt_pk_bf16_f32 v162, v161, v163
    v_cvt_pk_bf16_f32 v161, v164, v166
    v_cvt_pk_bf16_f32 v163, v165, v167
    v_and_or_b32 v160, v160, -2, s95
    v_and_or_b32 v162, v162, -2, s95
    buffer_store_dwordx4 v[160:163], v0, s[8:11], s47 offen offset:0 sc1
    v_cvt_pk_bf16_f32 v168, v168, v170
    v_cvt_pk_bf16_f32 v170, v169, v171
    v_cvt_pk_bf16_f32 v169, v172, v174
    v_cvt_pk_bf16_f32 v171, v173, v175
    v_and_or_b32 v168, v168, -2, s95
    v_and_or_b32 v170, v170, -2, s95
    buffer_store_dwordx4 v[168:171], v0, s[8:11], s47 offen offset:1024 sc1
    s_add_u32 s47, s47, 299008
    s_cmp_eq_u32 s51, 1
    s_cbranch_scc1 L_xq1_sc1
    v_mov_b64 v[224:225], 0
    v_mov_b64 v[226:227], 0
    v_mov_b64 v[228:229], 0
    v_mov_b64 v[230:231], 0
    v_mov_b64 v[232:233], 0
    v_mov_b64 v[234:235], 0
    v_mov_b64 v[236:237], 0
    v_mov_b64 v[238:239], 0
    v_mov_b64 v[240:241], 0
    v_mov_b64 v[242:243], 0
    s_waitcnt lgkmcnt(0)
    s_nop 0
    v_smfmac_f32_16x16x64_bf16 v[240:243], a[232:235], a[160:167], v1
    v_smfmac_f32_16x16x64_bf16 v[240:243], a[236:239], a[168:175], v1
    v_smfmac_f32_16x16x64_bf16 v[240:243], a[228:231], a[176:183], v1
    v_smfmac_f32_16x16x64_bf16 v[224:227], a[212:215], a[0:7], v1
    v_smfmac_f32_16x16x64_bf16 v[224:227], a[216:219], a[8:15], v1
    v_smfmac_f32_16x16x64_bf16 v[224:227], a[220:223], a[16:23], v1
    v_smfmac_f32_16x16x64_bf16 v[224:227], a[224:227], a[24:31], v1
    v_smfmac_f32_16x16x64_bf16 v[224:227], a[228:231], a[32:39], v1
    v_smfmac_f32_16x16x64_bf16 v[228:231], a[212:215], a[40:47], v1
    v_smfmac_f32_16x16x64_bf16 v[228:231], a[216:219], a[48:55], v1
    v_smfmac_f32_16x16x64_bf16 v[228:231], a[220:223], a[56:63], v1
    v_smfmac_f32_16x16x64_bf16 v[228:231], a[224:227], a[64:71], v1
    v_smfmac_f32_16x16x64_bf16 v[228:231], a[228:231], a[72:79], v1
    v_smfmac_f32_16x16x64_bf16 v[232:235], a[212:215], a[80:87], v1
    v_smfmac_f32_16x16x64_bf16 v[232:235], a[216:219], a[88:95], v1
    v_smfmac_f32_16x16x64_bf16 v[232:235], a[220:223], a[96:103], v1
    v_smfmac_f32_16x16x64_bf16 v[232:235], a[224:227], a[104:111], v1
    v_smfmac_f32_16x16x64_bf16 v[232:235], a[228:231], a[112:119], v1
    v_smfmac_f32_16x16x64_bf16 v[236:239], a[212:215], a[120:127], v1
    v_smfmac_f32_16x16x64_bf16 v[236:239], a[216:219], a[128:135], v1
    v_smfmac_f32_16x16x64_bf16 v[236:239], a[220:223], a[136:143], v1
    v_smfmac_f32_16x16x64_bf16 v[236:239], a[224:227], a[144:151], v1
    v_smfmac_f32_16x16x64_bf16 v[236:239], a[228:231], a[152:159], v1
    v_add_f32 v240, v240, v242
    v_add_f32 v241, v241, v243
    v_cndmask_b32 v242, v240, v241, s[58:59]
    s_nop 1
    v_mov_b32_dpp v243, v242 quad_perm:[1,0,3,2] row_mask:0xf bank_mask:0xf
    v_cndmask_b32 v240, v243, v240, s[58:59]
    v_cndmask_b32 v241, v241, v243, s[58:59]
    v_cvt_pk_bf16_f32 v240, v240, v241
    v_and_or_b32 v240, v240, -2, s95
    buffer_store_dword v240, v12, s[8:11], s47 offen sc1
    v_cvt_pk_bf16_f32 v224, v224, v226
    v_cvt_pk_bf16_f32 v226, v225, v227
    v_cvt_pk_bf16_f32 v225, v228, v230
    v_cvt_pk_bf16_f32 v227, v229, v231
    v_and_or_b32 v224, v224, -2, s95
    v_and_or_b32 v226, v226, -2, s95
    buffer_store_dwordx4 v[224:227], v0, s[8:11], s47 offen offset:0 sc1
    v_cvt_pk_bf16_f32 v232, v232, v234
    v_cvt_pk_bf16_f32 v234, v233, v235
    v_cvt_pk_bf16_f32 v233, v236, v238
    v_cvt_pk_bf16_f32 v235, v237, v239
    v_and_or_b32 v232, v232, -2, s95
    v_and_or_b32 v234, v234, -2, s95
    buffer_store_dwordx4 v[232:235], v0, s[8:11], s47 offen offset:1024 sc1
    s_add_u32 s47, s47, 299008
L_xq1_sc1:
    s_waitcnt lgkmcnt(0)
    s_cmp_ge_u32 s46, 72
    s_cbranch_scc1 L_xs_next_sc1
    s_lshl_b32 s36, s42, 2
    s_add_u32 s36, s36, s50
    s_mul_i32 s36, s36, 9216
L_xr_sc1:
    s_mov_b32 s37, s45
    buffer_load_dwordx4 v[160:163], v13, s[8:11], s37 offen sc1
    s_add_u32 s37, s37, 74752
    buffer_load_dwordx4 v[164:167], v13, s[8:11], s37 offen sc1
    s_add_u32 s37, s37, 74752
    buffer_load_dwordx4 v[168:171], v13, s[8:11], s37 offen sc1
    s_add_u32 s37, s37, 74752
    buffer_load_dwordx4 v[172:175], v13, s[8:11], s37 offen sc1
    s_add_u32 s37, s37, 74752
    s_cmp_eq_u32 s51, 1
    s_cselect_b32 s37, s45, s37
    buffer_load_dwordx4 v[176:179], v13, s[8:11], s37 offen sc1
    s_add_u32 s37, s37, 74752
    buffer_load_dwordx4 v[180:183], v13, s[8:11], s37 offen sc1
    s_add_u32 s37, s37, 74752
    buffer_load_dwordx4 v[184:187], v13, s[8:11], s37 offen sc1
    s_add_u32 s37, s37, 74752
    buffer_load_dwordx4 v[188:191], v13, s[8:11], s37 offen sc1
    s_add_u32 s37, s37, 74752
    v_mov_b64 v[48:49], 0
    v_mov_b64 v[50:51], 0
    v_mov_b64 v[52:53], 0
    v_mov_b64 v[54:55], 0
    v_mov_b64 v[46:47], 0
    s_add_u32 s54, s54, 1
    s_waitcnt vmcnt(4)
    v_smfmac_f32_16x16x64_bf16 v[48:51], v[34:37], v[160:167], v1
    v_smfmac_f32_16x16x64_bf16 v[48:51], v[34:37], v[168:175], v1
    v_bitop3_b32 v46, v46, v160, s95 bitop3:0xf6
    v_bitop3_b32 v47, v47, v161, s95 bitop3:0xf6
    v_bitop3_b32 v46, v46, v162, s95 bitop3:0xf6
    v_bitop3_b32 v47, v47, v163, s95 bitop3:0xf6
    v_bitop3_b32 v46, v46, v164, s95 bitop3:0xf6
    v_bitop3_b32 v47, v47, v165, s95 bitop3:0xf6
    v_bitop3_b32 v46, v46, v166, s95 bitop3:0xf6
    v_bitop3_b32 v47, v47, v167, s95 bitop3:0xf6
    v_bitop3_b32 v46, v46, v168, s95 bitop3:0xf6
    v_bitop3_b32 v47, v47, v169, s95 bitop3:0xf6
    v_bitop3_b32 v46, v46, v170, s95 bitop3:0xf6
    v_bitop3_b32 v47, v47, v171, s95 bitop3:0xf6
    v_bitop3_b32 v46, v46, v172, s95 bitop3:0xf6
    v_bitop3_b32 v47, v47, v173, s95 bitop3:0xf6
    v_bitop3_b32 v46, v46, v174, s95 bitop3:0xf6
    v_bitop3_b32 v47, v47, v175, s95 bitop3:0xf6
    s_waitcnt vmcnt(0)
    v_smfmac_f32_16x16x64_bf16 v[52:55], v[34:37], v[176:183], v1
    v_smfmac_f32_16x16x64_bf16 v[52:55], v[34:37], v[184:191], v1
    v_bitop3_b32 v46, v46, v176, s95 bitop3:0xf6
    v_bitop3_b32 v47, v47, v177, s95 bitop3:0xf6
    v_bitop3_b32 v46, v46, v178, s95 bitop3:0xf6
    v_bitop3_b32 v47, v47, v179, s95 bitop3:0xf6
    v_bitop3_b32 v46, v46, v180, s95 bitop3:0xf6
    v_bitop3_b32 v47, v47, v181, s95 bitop3:0xf6
    v_bitop3_b32 v46, v46, v182, s95 bitop3:0xf6
    v_bitop3_b32 v47, v47, v183, s95 bitop3:0xf6
    v_bitop3_b32 v46, v46, v184, s95 bitop3:0xf6
    v_bitop3_b32 v47, v47, v185, s95 bitop3:0xf6
    v_bitop3_b32 v46, v46, v186, s95 bitop3:0xf6
    v_bitop3_b32 v47, v47, v187, s95 bitop3:0xf6
    v_bitop3_b32 v46, v46, v188, s95 bitop3:0xf6
    v_bitop3_b32 v47, v47, v189, s95 bitop3:0xf6
    v_bitop3_b32 v46, v46, v190, s95 bitop3:0xf6
    v_bitop3_b32 v47, v47, v191, s95 bitop3:0xf6
    v_and_or_b32 v46, v47, s94, v46
    v_and_b32 v46, 1, v46
    v_cmp_ne_u32 vcc, 0, v46
    s_cbranch_vccz L_xr_ok_sc1
    s_cmp_gt_u32 s54, 300000
    s_cbranch_scc0 L_xr_sc1
L_xr_ok_sc1:
    v_add_f32_dpp v48, v48, v48 row_ror:8 row_mask:0xf bank_mask:0xf
    v_add_f32_dpp v49, v49, v49 row_ror:8 row_mask:0xf bank_mask:0xf
    v_add_f32_dpp v50, v50, v50 row_ror:8 row_mask:0xf bank_mask:0xf
    v_add_f32_dpp v51, v51, v51 row_ror:8 row_mask:0xf bank_mask:0xf
    v_cvt_pk_bf16_f32 v48, v48, v49
    v_cvt_pk_bf16_f32 v49, v50, v51
    buffer_store_dwordx2 v[48:49], v14, s[24:27], s36 offen
    s_add_u32 s36, s36, 9216
    s_cmp_eq_u32 s51, 1
    s_cbranch_scc1 L_xs_next_sc1
    v_add_f32_dpp v52, v52, v52 row_ror:8 row_mask:0xf bank_mask:0xf
    v_add_f32_dpp v53, v53, v53 row_ror:8 row_mask:0xf bank_mask:0xf
    v_add_f32_dpp v54, v54, v54 row_ror:8 row_mask:0xf bank_mask:0xf
    v_add_f32_dpp v55, v55, v55 row_ror:8 row_mask:0xf bank_mask:0xf
    v_cvt_pk_bf16_f32 v52, v52, v53
    v_cvt_pk_bf16_f32 v53, v54, v55
    buffer_store_dwordx2 v[52:53], v14, s[24:27], s36 offen
    s_add_u32 s36, s36, 9216
L_xs_next_sc1:
    s_add_u32 s49, s49, 7
    s_lshr_b32 s42, s49, 1
    s_and_b32 s50, s49, 1
    s_lshl_b32 s50, s50, 1
    s_sub_u32 s35, s49, 128
    s_lshr_b32 s36, s35, 2
    s_add_u32 s36, s36, 64
    s_and_b32 s35, s35, 3
    s_cmp_ge_u32 s49, 128
    s_cselect_b32 s42, s36, s42
    s_cselect_b32 s50, s35, s50
    s_cselect_b32 s51, 1, 0
    s_add_u32 s57, s57, 1
    s_cmp_ge_u32 s42, 64
    s_cbranch_scc1 L_xs_end_sc1
    s_lshl_b32 s35, s42, 5
    s_add_u32 s35, s35, s32
    s_lshl_b32 s40, s35, 14
    s_lshl_b32 s41, s35, 13
    s_add_u32 s41, s41, 33554432
    s_lshl_b32 s43, s35, 11
    s_add_u32 s43, s43, 62914560
    s_lshl_b32 s38, s42, 7
    s_add_u32 s38, s38, 67108864
    buffer_load_dwordx4 v[64:67], v0, s[8:11], s40 offen offset:0 sc1
    buffer_load_dwordx4 v[68:71], v0, s[8:11], s40 offen offset:1024 sc1
    buffer_load_dwordx4 v[72:75], v0, s[8:11], s40 offen offset:2048 sc1
    buffer_load_dwordx4 v[76:79], v0, s[8:11], s40 offen offset:3072 sc1
    s_add_u32 s40, s40, 4096
    buffer_load_dwordx4 v[80:83], v0, s[8:11], s40 offen offset:0 sc1
    buffer_load_dwordx4 v[84:87], v0, s[8:11], s40 offen offset:1024 sc1
    buffer_load_dwordx4 v[88:91], v0, s[8:11], s40 offen offset:2048 sc1
    buffer_load_dwordx4 v[92:95], v0, s[8:11], s40 offen offset:3072 sc1
    s_add_u32 s40, s40, 4096
    buffer_load_dwordx4 v[96:99], v0, s[8:11], s40 offen offset:0 sc1
    buffer_load_dwordx4 v[100:103], v0, s[8:11], s40 offen offset:1024 sc1
    buffer_load_dwordx4 v[104:107], v0, s[8:11], s40 offen offset:2048 sc1
    buffer_load_dwordx4 v[108:111], v0, s[8:11], s40 offen offset:3072 sc1
    s_add_u32 s40, s40, 4096
    buffer_load_dwordx4 v[112:115], v0, s[8:11], s40 offen offset:0 sc1
    buffer_load_dwordx4 v[116:119], v0, s[8:11], s40 offen offset:1024 sc1
    buffer_load_dwordx4 v[120:123], v0, s[8:11], s40 offen offset:2048 sc1
    buffer_load_dwordx4 v[124:127], v0, s[8:11], s40 offen offset:3072 sc1
    s_mov_b64 exec, s[60:61]
    buffer_load_dwordx4 v[128:131], v6, s[8:11], s41 offen offset:0 sc1
    buffer_load_dwordx4 v[136:139], v6, s[8:11], s41 offen offset:2048 sc1
    s_add_u32 s36, s41, 4096
    buffer_load_dwordx4 v[144:147], v6, s[8:11], s36 offen offset:0 sc1
    buffer_load_dwordx4 v[152:155], v6, s[8:11], s36 offen offset:2048 sc1
    s_mov_b64 exec, s[62:63]
    buffer_load_dwordx4 v[132:135], v6, s[8:11], s41 offen offset:0 sc1
    buffer_load_dwordx4 v[140:143], v6, s[8:11], s41 offen offset:2048 sc1
    s_add_u32 s36, s41, 4096
    buffer_load_dwordx4 v[148:151], v6, s[8:11], s36 offen offset:0 sc1
    buffer_load_dwordx4 v[156:159], v6, s[8:11], s36 offen offset:2048 sc1
    s_mov_b64 exec, -1
    buffer_load_dwordx4 v[42:45], v6, s[8:11], s43 offen sc1
    buffer_load_dwordx2 v[46:47], v15, s[8:11], s38 offen sc1
    buffer_load_dword v48, v16, s[8:11], s38 offen sc1
    s_branch L_xs_sc1
L_xs_end_sc1:
L_xall:
L_end:
    s_endpgm
.section .rodata,"a"
.p2align 6
.amdhsa_kernel gated_mix__memory_aug_recurrent_mem_tr__linear_attn_block__prompt_kernel
  .amdhsa_next_free_vgpr 512
  .amdhsa_next_free_sgpr 102
  .amdhsa_accum_offset 256
  .amdhsa_group_segment_fixed_size 0
  .amdhsa_kernarg_size 112
  .amdhsa_user_sgpr_count 2
  .amdhsa_user_sgpr_kernarg_segment_ptr 1
  .amdhsa_system_sgpr_workgroup_id_x 1
.end_amdhsa_kernel
```
